```python
import torch

def _softmax(x, axis=-1):
    return torch.softmax(x, dim=axis)
def _gelu(x):
    return torch.nn.functional.gelu(x, approximate="tanh")
def _silu(x):
    return torch.nn.functional.silu(x)
def _sigmoid(x):
    return torch.sigmoid(x)
def _layernorm(x, axis=-1, eps=1e-5):
    m = x.mean(dim=axis, keepdim=True)
    v = x.var(dim=axis, keepdim=True, unbiased=False)
    return (x - m) / torch.sqrt(v + eps)
def _scatter_add(tgt, idx, src, axis=0):
    return tgt.clone().index_add_(axis, idx, src)
def _segment_sum(src, seg, n):
    out = torch.zeros((n,) + src.shape[1:], dtype=src.dtype)
    return out.index_add_(0, seg, src)
def _pad(x, pw):
    flat = tuple(v for pair in reversed(pw) for v in pair)
    return torch.nn.functional.pad(x, flat)

kernel_name = 'recurrent_scan__linear_kernel_hedgehog__mixer_s_mlp__prompt'

def setup_inputs():

    _w = (lambda a: (lambda t: t.to(torch.bfloat16) if t.is_floating_point() else t)(torch.as_tensor(a)))
    def _A_setup():
        B, S, D, H = 1, 2048, 448, 16
        Dh = D // H
        return {
            "x": _w((lambda *s: torch.randn(*s, dtype=torch.bfloat16) * 0.05)(B, S, D)),
            "wqkv": _w((lambda *s: torch.randn(*s, dtype=torch.bfloat16) * 0.2)(D, 3 * D)),
            "w_phi": _w((lambda *s: torch.randn(*s, dtype=torch.bfloat16) * 0.2)(H, Dh, Dh) * (Dh ** -0.5)),
            "wo": _w((lambda *s: torch.randn(*s, dtype=torch.bfloat16) * 0.05)(D, D)),
        }
    _A_in = _A_setup()

    def _B_setup():
        B, S, D, F = 1, 2048, 448, 1792
        return {
            "x":  _w((lambda *s: torch.randn(*s, dtype=torch.bfloat16) * 0.05)(B, S, D)),
            "w1": _w((lambda *s: torch.randn(*s, dtype=torch.bfloat16) * 0.8)(D, D) * (D ** -0.5)),
            "w2": _w((lambda *s: torch.randn(*s, dtype=torch.bfloat16) * 0.8)(D, D) * (D ** -0.5)),
            "w3": _w((lambda *s: torch.randn(*s, dtype=torch.bfloat16) * 0.8)(D, F) * (D ** -0.5)),
            "w4": _w((lambda *s: torch.randn(*s, dtype=torch.bfloat16) * 0.8)(F, D) * (F ** -0.5)),
        }
    _B_in = _B_setup()

    return {
        "A_x": _A_in["x"],
        "A_wqkv": _A_in["wqkv"],
        "A_w_phi": _A_in["w_phi"],
        "A_wo": _A_in["wo"],
        "B_x": _B_in["x"],
        "B_w1": _B_in["w1"],
        "B_w2": _B_in["w2"],
        "B_w3": _B_in["w3"],
        "B_w4": _B_in["w4"],
    }

def reference(A_x, A_wqkv, A_w_phi, A_wo, B_x, B_w1, B_w2, B_w3, B_w4):
    def _A_ref(x, wqkv, w_phi, wo):
        B, S, D = x.shape
        H = 16; Dh = D // H
        qkv = (lambda x, *d: x.permute(*d))((x @ wqkv).reshape(B, S, 3, H, Dh), 2, 0, 3, 1, 4)
        q, k, v = qkv[0], qkv[1], qkv[2]
        pq = torch.einsum("bhsd,hdf->bhsf", q, w_phi)
        pk = torch.einsum("bhsd,hdf->bhsf", k, w_phi)
        phi_q = torch.concatenate([_softmax(pq, axis=-1), _softmax(-pq, axis=-1)], axis=-1)
        phi_k = torch.concatenate([_softmax(pk, axis=-1), _softmax(-pk, axis=-1)], axis=-1)
        kv = torch.einsum("bhsf,bhsd->bhfd", phi_k, v)
        z  = torch.einsum("bhsf->bhf", phi_k)
        num = torch.einsum("bhqf,bhfd->bhqd", phi_q, kv)
        den = torch.einsum("bhqf,bhf->bhq", phi_q, z)[..., None] + 1e-6
        o = num / den
        return (lambda x, *d: x.permute(*d))(o, 0, 2, 1, 3).reshape(B, S, D) @ wo

    def _B_ref(x, w1, w2, w3, w4):
        B, S, D = x.shape
        h = _gelu(_layernorm(x, axis=-1) @ w1)
        c = D // 4
        g0 = _pad(h[:, :, 0*c:1*c], ((0, 0), (1, 0), (0, 0)))[:, :S, :]
        g1 = _pad(h[:, :, 1*c:2*c], ((0, 0), (0, 1), (0, 0)))[:, 1:, :]
        g2 = _pad(h[:, :, 2*c:3*c], ((0, 0), (2, 0), (0, 0)))[:, :S, :]
        g3 = _pad(h[:, :, 3*c:   ], ((0, 0), (0, 2), (0, 0)))[:, 2:, :]
        hs = torch.concatenate([g0, g1, g2, g3], axis=-1) @ w2
        x1 = x + hs
        h2 = _gelu(_layernorm(x1, axis=-1) @ w3) @ w4
        return x1 + h2

    x = A_x
    xn = _layernorm(x, axis=-1)
    s = _A_ref(xn, A_wqkv, A_w_phi, A_wo)
    g = _silu(_B_ref(xn, B_w1, B_w2, B_w3, B_w4))
    return x + s * g
```

```asm
; @launch grid=(256,1,1) block=(256,1,1) lds=163840
.amdgcn_target "amdgcn-amd-amdhsa--gfx950"
.text
.globl recurrent_scan__linear_kernel_hedgehog__mixer_s_mlp__prompt_kernel
.p2align 8
.type recurrent_scan__linear_kernel_hedgehog__mixer_s_mlp__prompt_kernel,@function
recurrent_scan__linear_kernel_hedgehog__mixer_s_mlp__prompt_kernel:
    s_load_dwordx16 s[60:75], s[0:1], 0
    s_load_dwordx8 s[76:83], s[0:1], 64
    s_cmp_ge_u32 s2, 256
    s_cbranch_scc1 recurrent_scan__linear_kernel_hedgehog__mixer_s_mlp__prompt_kernel_done
    v_lshrrev_b32 v5, 6, v0
    v_and_b32 v1, 63, v0
    v_readfirstlane_b32 s3, v5
    s_lshr_b32 s29, s2, 3
    s_getpc_b64 s[24:25]
.Lpc0:
    s_mov_b32 s26, recurrent_scan__linear_kernel_hedgehog__mixer_s_mlp__prompt_kernel_end-.Lpc0
    s_mov_b32 s27, 0x00020000
    s_lshl_b32 s31, s29, 11
    v_lshlrev_b32 v4, 7, v0
    v_cmp_gt_u32_e64 vcc, 16, v0
    v_mov_b32 v5, 0x7fff0000
    s_and_b32 s28, s2, 7
    v_cndmask_b32 v4, v5, v4, vcc
    buffer_load_dword v2, v4, s[24:27], s31 offen
    s_or_b32 s31, s2, s3
    s_cmp_lg_u32 s31, 0
    s_cbranch_scc1 .Llead1
    s_waitcnt lgkmcnt(0)
    s_mov_b32 s16, s80
    s_mov_b32 s17, s81
    s_mov_b32 s18, 0x100
    s_mov_b32 s19, 0x00020000
    s_memrealtime s[36:37]
    s_waitcnt lgkmcnt(0)
    s_or_b32 s31, s36, 1
    v_mov_b32 v6, s31
    v_mov_b32_e64 v5, 0
    s_mov_b64 exec, 1
    buffer_store_dword v6, v5, s[16:19], 0 offen sc1
    s_mov_b64 exec, -1
.Llead1:
    s_cmp_ge_u32 s29, 14
    s_cbranch_scc1 .LteamA2
    s_and_b32 s31, s29, 1
    s_lshl_b32 s35, s28, 1
    s_add_u32 s35, s35, s31
    s_lshr_b32 s36, s29, 1
    s_add_u32 s37, s36, 1
    s_cmp_eq_u32 s37, 7
    s_cselect_b32 s37, 0, s37
    s_lshl_b32 s44, s35, 2
    s_add_u32 s44, s44, s3
    s_mul_i32 s38, s44, 28672
    s_mul_i32 s42, s3, 12288
    s_add_u32 s42, s42, 57344
    v_lshrrev_b32_e64 v4, 3, v1
    v_mul_u32_u24 v4, 896, v4
    v_lshrrev_b32 v5, 4, v1
    v_and_b32 v6, 7, v1
    v_xor_b32_e64 v5, v5, v6
    v_lshl_add_u32 v18, v5, 4, v4
    v_xor_b32 v19, 64, v18
    s_waitcnt lgkmcnt(0)
    s_mov_b32 s4, s60
    s_mov_b32 s5, s61
    s_mov_b32 s6, 0x1c0000
    s_mov_b32 s7, 0x00020000
    s_add_u32 m0, s42, 0
    s_lshl_b32 s39, s37, 7
    s_add_u32 s39, s39, s38
    s_nop 0
    buffer_load_dwordx4 v18, s[4:7], s39 offen lds
    s_add_u32 m0, s42, 1024
    s_add_u32 s39, s39, 7168
    buffer_load_dwordx4 v19, s[4:7], s39 offen lds
    s_add_u32 m0, s42, 2048
    s_add_u32 s39, s39, 7168
    buffer_load_dwordx4 v18, s[4:7], s39 offen lds
    s_add_u32 m0, s42, 3072
    s_add_u32 s39, s39, 7168
    buffer_load_dwordx4 v19, s[4:7], s39 offen lds
    s_mov_b32 s31, 0
    v_lshrrev_b32 v4, 3, v1
    v_mul_u32_u24 v4, 896, v4
    v_bfe_u32 v5, v1, 4, 1
    v_lshlrev_b32 v5, 2, v5
    v_and_b32 v6, 7, v1
    v_xor_b32_e64 v5, v5, v6
    v_lshl_add_u32 v4, v5, 4, v4
    v_add_u32_e64 v14, s31, v4
    s_mov_b32 s8, s70
    s_mov_b32 s9, s71
    s_mov_b32 s10, 0x62000
    s_mov_b32 s11, 0x00020000
    s_mul_i32 s41, s3, 14336
    s_lshl_b32 s31, s36, 7
    s_add_u32 s41, s41, s31
    s_lshl_b32 s43, s3, 11
    s_add_u32 m0, s43, 0
    s_mul_i32 s40, s37, 57344
    s_add_u32 s40, s40, s41
    buffer_load_dwordx4 v14, s[8:11], s40 offen lds
    s_add_u32 m0, s43, 1024
    s_add_u32 s40, s40, 7168
    buffer_load_dwordx4 v14, s[8:11], s40 offen lds
    s_add_u32 s37, s37, 1
    s_cmp_eq_u32 s37, 7
    s_cselect_b32 s37, 0, s37
    s_add_u32 m0, s42, 4096
    s_lshl_b32 s39, s37, 7
    s_add_u32 s39, s39, s38
    buffer_load_dwordx4 v18, s[4:7], s39 offen lds
    s_add_u32 m0, s42, 5120
    s_add_u32 s39, s39, 7168
    buffer_load_dwordx4 v19, s[4:7], s39 offen lds
    s_add_u32 m0, s42, 6144
    s_add_u32 s39, s39, 7168
    buffer_load_dwordx4 v18, s[4:7], s39 offen lds
    s_add_u32 m0, s42, 7168
    s_add_u32 s39, s39, 7168
    buffer_load_dwordx4 v19, s[4:7], s39 offen lds
    s_add_u32 m0, s43, 8192
    s_mul_i32 s40, s37, 57344
    s_add_u32 s40, s40, s41
    buffer_load_dwordx4 v14, s[8:11], s40 offen lds
    s_add_u32 m0, s43, 9216
    s_add_u32 s40, s40, 7168
    buffer_load_dwordx4 v14, s[8:11], s40 offen lds
    s_add_u32 s37, s37, 1
    s_cmp_eq_u32 s37, 7
    s_cselect_b32 s37, 0, s37
    v_lshlrev_b32 v3, 4, v1
    v_and_b32 v12, 31, v1
    v_lshrrev_b32_e64 v13, 5, v1
    s_mov_b32 s12, s82
    s_mov_b32 s13, s83
    s_mov_b32 s14, 0x3000000
    s_mov_b32 s15, 0x00020000
    v_bfe_u32 v4, v1, 1, 3
    v_xor_b32 v4, v4, v13
    v_lshlrev_b32 v5, 7, v12
    v_add_u32 v5, s42, v5
    v_xor_b32 v6, 0, v4
    v_lshl_add_u32 v52, v6, 4, v5
    v_xor_b32_e64 v6, 2, v4
    v_lshl_add_u32 v53, v6, 4, v5
    v_xor_b32_e64 v6, 4, v4
    v_lshl_add_u32 v54, v6, 4, v5
    v_xor_b32_e64 v6, 6, v4
    v_lshl_add_u32 v55, v6, 4, v5
    v_bfe_u32 v4, v1, 2, 2
    v_lshrrev_b32_e64 v5, 5, v1
    v_lshl_add_u32 v4, v5, 2, v4
    v_lshlrev_b32_e64 v4, 7, v4
    v_bfe_u32 v5, v1, 3, 1
    v_lshl_add_u32 v4, v5, 6, v4
    v_bfe_u32 v5, v1, 4, 1
    v_lshl_add_u32 v4, v5, 5, v4
    v_and_b32_e64 v5, 3, v1
    v_lshl_add_u32 v60, v5, 3, v4
    v_lshl_add_u32 v56, v13, 9, v60
    v_xor_b32 v57, 64, v56
    v_add_u32 v58, s43, v56
    v_add_u32 v59, s43, v57
    v_lshrrev_b32 v4, 2, v1
    v_lshrrev_b32 v5, 4, v1
    v_xor_b32 v4, v4, v5
    v_and_b32 v4, 1, v4
    v_and_b32 v5, 3, v1
    v_or_b32 v4, v4, v5
    v_cmp_eq_u32 vcc, 0, v4
    v_mov_b32 v5, 0x3f803f80
    s_nop 0
    v_cndmask_b32 v64, 0, v5, vcc
    v_mov_b32 v65, v64
    v_mov_b32 v66, v64
    v_mov_b32 v67, v64
    v_mov_b32 v4, 0
    v_lshlrev_b32_e64 v5, 2, v0
    v_add_u32 v5, 157696, v5
    ds_write_b32 v5, v4
    s_lshl_b32 s31, s3, 2
    s_add_u32 s31, s31, 163824
    v_mov_b32 v5, s31
    ds_write_b32 v5, v4
    s_lshl_b32 s45, s35, 3
    s_add_u32 s45, s45, s36
    s_lshl_b32 s46, s44, 5
    s_add_u32 s46, s46, -1
    v_add_u32_e64 v4, s46, v12
    v_cmp_gt_u32 vcc, 2048, v4
    v_bfe_u32 v5, v4, 5, 6
    v_mul_u32_u24 v5, 28672, v5
    v_and_b32_e64 v4, 31, v4
    v_lshl_add_u32 v4, v13, 5, v4
    v_lshl_add_u32 v4, v4, 4, v5
    v_mov_b32 v5, 0x7fff0000
    v_cndmask_b32 v61, v5, v4, vcc
    s_lshl_b32 s46, s44, 5
    s_add_u32 s46, s46, 1
    v_add_u32 v4, s46, v12
    v_cmp_gt_u32 vcc, 2048, v4
    v_bfe_u32 v5, v4, 5, 6
    v_mul_u32_u24 v5, 28672, v5
    v_and_b32_e64 v4, 31, v4
    v_lshl_add_u32 v4, v13, 5, v4
    v_lshl_add_u32 v4, v4, 4, v5
    v_mov_b32 v5, 0x7fff0000
    v_cndmask_b32 v62, v5, v4, vcc
    s_lshl_b32 s46, s44, 5
    s_add_u32 s46, s46, -2
    v_add_u32 v4, s46, v12
    v_cmp_gt_u32 vcc, 2048, v4
    v_bfe_u32 v5, v4, 5, 6
    v_mul_u32_u24 v5, 28672, v5
    v_and_b32_e64 v4, 31, v4
    v_lshl_add_u32 v4, v13, 5, v4
    v_lshl_add_u32 v4, v4, 4, v5
    v_mov_b32 v5, 0x7fff0000
    v_cndmask_b32 v63, v5, v4, vcc
    s_lshl_b32 s46, s44, 5
    s_add_u32 s46, s46, 2
    v_add_u32 v4, s46, v12
    v_cmp_gt_u32 vcc, 2048, v4
    v_bfe_u32 v5, v4, 5, 6
    v_mul_u32_u24 v5, 28672, v5
    v_and_b32_e64 v4, 31, v4
    v_lshl_add_u32 v4, v13, 5, v4
    v_lshl_add_u32 v4, v4, 4, v5
    v_mov_b32 v5, 0x7fff0000
    v_cndmask_b32_e64 v68, v5, v4, vcc
    s_mul_i32 s47, s44, 28672
    s_lshl_b32 s31, s36, 12
    s_add_u32 s47, s47, s31
    s_mov_b32 s20, s72
    s_mov_b32 s21, s73
    s_mov_b32 s22, 0x62000
    s_mov_b32 s23, 0x00020000
    s_mov_b32 s31, s36
    s_lshl_b32 s31, s31, 7
    s_mul_i32 s88, s3, 7168
    s_add_u32 s88, s88, s31
    s_lshl_b32 s89, s3, 10
    s_add_u32 s89, s89, 100352
    s_mov_b32 s24, s74
    s_mov_b32 s25, s75
    s_mov_b32 s26, 0x188000
    s_mov_b32 s27, 0x00020000
    s_and_b32 s31, s28, 1
    s_lshl_b32 s31, s31, 3
    s_and_b32 s32, s28, 6
    s_add_u32 s32, s32, s29
    s_and_b32 s32, s32, 7
    s_add_u32 s93, s32, s31
    s_mul_i32 s32, s93, 224
    v_lshrrev_b32_e64 v4, 3, v1
    v_mul_u32_u24 v4, 3584, v4
    v_bfe_u32 v5, v1, 4, 1
    v_lshlrev_b32 v5, 2, v5
    v_and_b32 v6, 7, v1
    v_xor_b32_e64 v5, v5, v6
    v_lshl_add_u32 v15, v5, 4, v4
    v_mul_u32_u24 v4, 43, v1
    v_lshrrev_b32 v4, 8, v4
    v_mul_u32_u24 v5, 6, v4
    v_sub_u32 v5, v1, v5
    v_lshrrev_b32 v6, 1, v4
    v_and_b32 v4, 1, v4
    v_lshl_add_u32 v4, v4, 2, v6
    v_mul_u32_u24 v4, 3584, v4
    v_lshl_add_u32 v4, v5, 4, v4
    v_add_u32 v16, 128, v4
    s_mul_i32 s86, s3, 28672
    s_add_u32 s86, s86, s32
    s_lshl_b32 s87, s3, 10
    s_mul_i32 s92, s3, 768
    s_add_u32 s92, s92, 57344
    v_lshlrev_b32_e64 v69, 3, v0
    v_add_u32 v69, 158720, v69
    v_lshlrev_b32_e64 v70, 3, v1
    v_add_u32 v70, 158720, v70
    s_lshl_b32 s31, s44, 12
    s_add_u32 s31, s31, 8650752
    v_add_u32 v72, s31, v3
    s_lshl_b32 s32, s36, 9
    s_add_u32 s31, s31, s32
    v_lshl_add_u32 v71, v12, 4, s31
    s_mov_b32 s56, -1
    s_mov_b32 s57, 0
    s_add_u32 m0, s42, 8192
    s_lshl_b32 s39, s37, 7
    s_add_u32 s39, s39, s38
    buffer_load_dwordx4 v18, s[4:7], s39 offen lds
    s_add_u32 m0, s42, 9216
    s_add_u32 s39, s39, 7168
    buffer_load_dwordx4 v19, s[4:7], s39 offen lds
    s_add_u32 m0, s42, 10240
    s_add_u32 s39, s39, 7168
    buffer_load_dwordx4 v18, s[4:7], s39 offen lds
    s_add_u32 m0, s42, 11264
    s_add_u32 s39, s39, 7168
    buffer_load_dwordx4 v19, s[4:7], s39 offen lds
    s_add_u32 m0, s43, 16384
    s_mul_i32 s40, s37, 57344
    s_add_u32 s40, s40, s41
    buffer_load_dwordx4 v14, s[8:11], s40 offen lds
    s_add_u32 m0, s43, 17408
    s_add_u32 s40, s40, 7168
    buffer_load_dwordx4 v14, s[8:11], s40 offen lds
    s_add_u32 s37, s37, 1
    s_cmp_eq_u32 s37, 7
    s_cselect_b32 s37, 0, s37
    s_mov_b32 s16, s80
    s_mov_b32 s17, s81
    s_mov_b32 s18, 0x100
    s_mov_b32 s19, 0x00020000
    v_mov_b32_e64 v11, 0
    buffer_load_dword v17, v11, s[16:19], 0 offen sc1
    s_mov_b32 s46, 0x3f803f80
    s_waitcnt vmcnt(13)
    s_waitcnt lgkmcnt(0)
    s_barrier
    s_nop 0
    ds_read_b128 v[116:119], v52 offset:0
    ds_read_b128 v[120:123], v53 offset:0
    ds_read_b128 v[124:127], v54 offset:0
    ds_read_b128 v[128:131], v55 offset:0
    ds_read_b64_tr_b16 v[148:149], v56 offset:0
    ds_read_b64_tr_b16 v[150:151], v56 offset:512
    ds_read_b64_tr_b16 v[164:165], v57 offset:0
    ds_read_b64_tr_b16 v[166:167], v57 offset:512
    ds_read_b64_tr_b16 v[152:153], v56 offset:2048
    ds_read_b64_tr_b16 v[154:155], v56 offset:2560
    ds_read_b64_tr_b16 v[168:169], v57 offset:2048
    ds_read_b64_tr_b16 v[170:171], v57 offset:2560
    ds_read_b64_tr_b16 v[156:157], v56 offset:4096
    ds_read_b64_tr_b16 v[158:159], v56 offset:4608
    ds_read_b64_tr_b16 v[172:173], v57 offset:4096
    ds_read_b64_tr_b16 v[174:175], v57 offset:4608
    ds_read_b64_tr_b16 v[160:161], v56 offset:6144
    ds_read_b64_tr_b16 v[162:163], v56 offset:6656
    ds_read_b64_tr_b16 v[176:177], v57 offset:6144
    ds_read_b64_tr_b16 v[178:179], v57 offset:6656
    ds_read_b64_tr_b16 v[212:213], v58 offset:0
    ds_read_b64_tr_b16 v[214:215], v58 offset:512
    ds_read_b64_tr_b16 v[216:217], v59 offset:0
    ds_read_b64_tr_b16 v[218:219], v59 offset:512
    s_waitcnt lgkmcnt(15)
    s_nop 0
    v_dot2_f32_bf16 v228, v116, s46, 0
    v_dot2_f32_bf16 v230, v116, v116, 0
    v_dot2_f32_bf16 v229, v117, s46, 0
    v_dot2_f32_bf16 v231, v117, v117, 0
    v_dot2_f32_bf16 v228, v118, s46, v228
    v_dot2_f32_bf16 v230, v118, v118, v230
    v_dot2_f32_bf16 v229, v119, s46, v229
    v_dot2_f32_bf16 v231, v119, v119, v231
    v_dot2_f32_bf16 v228, v120, s46, v228
    v_dot2_f32_bf16 v230, v120, v120, v230
    v_dot2_f32_bf16 v229, v121, s46, v229
    v_dot2_f32_bf16 v231, v121, v121, v231
    v_dot2_f32_bf16 v228, v122, s46, v228
    v_dot2_f32_bf16 v230, v122, v122, v230
    v_dot2_f32_bf16 v229, v123, s46, v229
    v_dot2_f32_bf16 v231, v123, v123, v231
    v_dot2_f32_bf16 v228, v124, s46, v228
    v_dot2_f32_bf16 v230, v124, v124, v230
    v_dot2_f32_bf16 v229, v125, s46, v229
    v_dot2_f32_bf16 v231, v125, v125, v231
    v_dot2_f32_bf16 v228, v126, s46, v228
    v_dot2_f32_bf16 v230, v126, v126, v230
    v_dot2_f32_bf16 v229, v127, s46, v229
    v_dot2_f32_bf16 v231, v127, v127, v231
    v_dot2_f32_bf16 v228, v128, s46, v228
    v_dot2_f32_bf16 v230, v128, v128, v230
    v_dot2_f32_bf16 v229, v129, s46, v229
    v_dot2_f32_bf16 v231, v129, v129, v231
    v_dot2_f32_bf16 v228, v130, s46, v228
    v_dot2_f32_bf16 v230, v130, v130, v230
    v_dot2_f32_bf16 v229, v131, s46, v229
    v_dot2_f32_bf16 v231, v131, v131, v231
    s_nop 1
    v_add_f32 v228, v228, v229
    v_add_f32 v230, v230, v231
    v_mov_b32 v229, v228
    v_mov_b32 v231, v230
    s_nop 0
    v_permlane32_swap_b32 v228, v229
    v_permlane32_swap_b32 v230, v231
    v_add_f32 v228, v228, v229
    v_add_f32 v230, v230, v231
    v_mfma_f32_32x32x16_bf16 v[76:91], v[148:151], v[116:119], 0
    s_add_u32 m0, s42, 0
    s_lshl_b32 s39, s37, 7
    s_add_u32 s39, s39, s38
    buffer_load_dwordx4 v18, s[4:7], s39 offen lds
    v_mfma_f32_32x32x16_bf16 v[92:107], v[164:167], v[116:119], 0
    s_waitcnt vmcnt(8)
    s_barrier
    s_nop 0
    ds_read_b128 v[132:135], v52 offset:4096
    ds_read_b128 v[136:139], v53 offset:4096
    ds_read_b128 v[140:143], v54 offset:4096
    ds_read_b128 v[144:147], v55 offset:4096
    s_add_u32 m0, s42, 1024
    s_add_u32 s39, s39, 7168
    buffer_load_dwordx4 v19, s[4:7], s39 offen lds
    s_waitcnt lgkmcnt(15)
    s_nop 0
    v_mfma_f32_32x32x16_bf16 v[76:91], v[152:155], v[120:123], v[76:91]
    ds_read_b64_tr_b16 v[180:181], v56 offset:8192
    ds_read_b64_tr_b16 v[182:183], v56 offset:8704
    ds_read_b64_tr_b16 v[196:197], v57 offset:8192
    ds_read_b64_tr_b16 v[198:199], v57 offset:8704
    s_add_u32 m0, s42, 2048
    s_add_u32 s39, s39, 7168
    buffer_load_dwordx4 v18, s[4:7], s39 offen lds
    v_mfma_f32_32x32x16_bf16 v[92:107], v[168:171], v[120:123], v[92:107]
    ds_read_b64_tr_b16 v[184:185], v56 offset:10240
    ds_read_b64_tr_b16 v[186:187], v56 offset:10752
    ds_read_b64_tr_b16 v[200:201], v57 offset:10240
    ds_read_b64_tr_b16 v[202:203], v57 offset:10752
    s_add_u32 m0, s42, 3072
    s_add_u32 s39, s39, 7168
    buffer_load_dwordx4 v19, s[4:7], s39 offen lds
    s_waitcnt lgkmcnt(15)
    s_nop 0
    v_mfma_f32_32x32x16_bf16 v[76:91], v[156:159], v[124:127], v[76:91]
    ds_read_b64_tr_b16 v[188:189], v56 offset:12288
    ds_read_b64_tr_b16 v[190:191], v56 offset:12800
    ds_read_b64_tr_b16 v[204:205], v57 offset:12288
    ds_read_b64_tr_b16 v[206:207], v57 offset:12800
    s_add_u32 m0, s43, 24576
    s_mul_i32 s40, s37, 57344
    s_add_u32 s40, s40, s41
    s_nop 0
    buffer_load_dwordx4 v14, s[8:11], s40 offen lds
    v_mfma_f32_32x32x16_bf16 v[92:107], v[172:175], v[124:127], v[92:107]
    ds_read_b64_tr_b16 v[192:193], v56 offset:14336
    ds_read_b64_tr_b16 v[194:195], v56 offset:14848
    ds_read_b64_tr_b16 v[208:209], v57 offset:14336
    ds_read_b64_tr_b16 v[210:211], v57 offset:14848
    s_add_u32 m0, s43, 25600
    s_add_u32 s40, s40, 7168
    buffer_load_dwordx4 v14, s[8:11], s40 offen lds
    s_add_u32 s37, s37, 1
    s_cmp_eq_u32 s37, 7
    s_cselect_b32 s37, 0, s37
    s_nop 0
    v_mfma_f32_32x32x16_bf16 v[76:91], v[160:163], v[128:131], v[76:91]
    ds_read_b64_tr_b16 v[220:221], v58 offset:8192
    ds_read_b64_tr_b16 v[222:223], v58 offset:8704
    ds_read_b64_tr_b16 v[224:225], v59 offset:8192
    ds_read_b64_tr_b16 v[226:227], v59 offset:8704
    v_mfma_f32_32x32x16_bf16 v[92:107], v[176:179], v[128:131], v[92:107]
    s_waitcnt lgkmcnt(15)
    v_mfma_f32_16x16x32_bf16 v[108:111], v[64:67], v[212:215], 0
    v_mfma_f32_16x16x32_bf16 v[112:115], v[64:67], v[216:219], 0
    v_mfma_f32_32x32x16_bf16 v[76:91], v[180:183], v[132:135], v[76:91]
    s_add_u32 m0, s42, 4096
    s_lshl_b32 s39, s37, 7
    s_add_u32 s39, s39, s38
    buffer_load_dwordx4 v18, s[4:7], s39 offen lds
    v_mfma_f32_32x32x16_bf16 v[92:107], v[196:199], v[132:135], v[92:107]
    s_waitcnt vmcnt(8)
    s_barrier
    s_nop 0
    ds_read_b128 v[116:119], v52 offset:8192
    ds_read_b128 v[120:123], v53 offset:8192
    ds_read_b128 v[124:127], v54 offset:8192
    ds_read_b128 v[128:131], v55 offset:8192
    s_add_u32 m0, s42, 5120
    s_add_u32 s39, s39, 7168
    buffer_load_dwordx4 v19, s[4:7], s39 offen lds
    s_waitcnt lgkmcnt(15)
    v_mfma_f32_32x32x16_bf16 v[76:91], v[184:187], v[136:139], v[76:91]
    ds_read_b64_tr_b16 v[148:149], v56 offset:16384
    ds_read_b64_tr_b16 v[150:151], v56 offset:16896
    ds_read_b64_tr_b16 v[164:165], v57 offset:16384
    ds_read_b64_tr_b16 v[166:167], v57 offset:16896
    s_waitcnt vmcnt(8)
    v_readfirstlane_b32 s30, v17
    s_nop 1
    s_cmp_lg_u32 s30, 0
    s_cbranch_scc1 .Lnonce5
    v_mov_b32_e64 v11, 0
    s_waitcnt vmcnt(0) lgkmcnt(0)
    s_mov_b32 s34, 0
.Lspin6:
    buffer_load_dword v17, v11, s[16:19], 0 offen sc1
    s_add_u32 s34, s34, 1
    s_waitcnt vmcnt(0)
    v_cmp_eq_u32_e64 vcc, 0, v17
    s_cmp_ge_u32 s34, 200000
    s_cbranch_scc1 .Lspun7
    s_cbranch_vccnz .Lspin6
.Lspun7:
    s_nop 1
    v_readfirstlane_b32 s30, v17
    s_nop 3
.Lnonce5:
    v_mov_b32 v229, s30
    v_mov_b32_e64 v231, s30
    buffer_store_dwordx4 v[228:231], v71, s[12:15], 0 offen sc1
    v_mfma_f32_32x32x16_bf16 v[92:107], v[200:203], v[136:139], v[92:107]
    ds_read_b64_tr_b16 v[152:153], v56 offset:18432
    ds_read_b64_tr_b16 v[154:155], v56 offset:18944
    ds_read_b64_tr_b16 v[168:169], v57 offset:18432
    ds_read_b64_tr_b16 v[170:171], v57 offset:18944
    s_add_u32 m0, s42, 6144
    s_add_u32 s39, s39, 7168
    buffer_load_dwordx4 v18, s[4:7], s39 offen lds
    s_waitcnt lgkmcnt(15)
    s_nop 0
    v_mfma_f32_32x32x16_bf16 v[76:91], v[188:191], v[140:143], v[76:91]
    ds_read_b64_tr_b16 v[156:157], v56 offset:20480
    ds_read_b64_tr_b16 v[158:159], v56 offset:20992
    ds_read_b64_tr_b16 v[172:173], v57 offset:20480
    ds_read_b64_tr_b16 v[174:175], v57 offset:20992
    s_add_u32 m0, s42, 7168
    s_add_u32 s39, s39, 7168
    buffer_load_dwordx4 v19, s[4:7], s39 offen lds
    v_mfma_f32_32x32x16_bf16 v[92:107], v[204:207], v[140:143], v[92:107]
    ds_read_b64_tr_b16 v[160:161], v56 offset:22528
    ds_read_b64_tr_b16 v[162:163], v56 offset:23040
    ds_read_b64_tr_b16 v[176:177], v57 offset:22528
    ds_read_b64_tr_b16 v[178:179], v57 offset:23040
    s_add_u32 m0, s43, 32768
    s_mul_i32 s40, s37, 57344
    s_add_u32 s40, s40, s41
    s_nop 0
    buffer_load_dwordx4 v14, s[8:11], s40 offen lds
    v_mfma_f32_32x32x16_bf16 v[76:91], v[192:195], v[144:147], v[76:91]
    ds_read_b64_tr_b16 v[212:213], v58 offset:16384
    ds_read_b64_tr_b16 v[214:215], v58 offset:16896
    ds_read_b64_tr_b16 v[216:217], v59 offset:16384
    ds_read_b64_tr_b16 v[218:219], v59 offset:16896
    s_add_u32 m0, s43, 33792
    s_add_u32 s40, s40, 7168
    buffer_load_dwordx4 v14, s[8:11], s40 offen lds
    s_add_u32 s37, s37, 1
    s_cmp_eq_u32 s37, 7
    s_cselect_b32 s37, 0, s37
    v_mfma_f32_32x32x16_bf16 v[92:107], v[208:211], v[144:147], v[92:107]
    s_waitcnt lgkmcnt(15)
    v_mfma_f32_16x16x32_bf16 v[108:111], v[64:67], v[220:223], v[108:111]
    v_mfma_f32_16x16x32_bf16 v[112:115], v[64:67], v[224:227], v[112:115]
    v_mfma_f32_32x32x16_bf16 v[76:91], v[148:151], v[116:119], v[76:91]
    s_add_u32 m0, s42, 8192
    s_lshl_b32 s39, s37, 7
    s_add_u32 s39, s39, s38
    buffer_load_dwordx4 v18, s[4:7], s39 offen lds
    v_mfma_f32_32x32x16_bf16 v[92:107], v[164:167], v[116:119], v[92:107]
    s_waitcnt vmcnt(8)
    s_barrier
    ds_read_b128 v[132:135], v52 offset:0
    ds_read_b128 v[136:139], v53 offset:0
    ds_read_b128 v[140:143], v54 offset:0
    ds_read_b128 v[144:147], v55 offset:0
    s_add_u32 m0, s42, 9216
    s_add_u32 s39, s39, 7168
    buffer_load_dwordx4 v19, s[4:7], s39 offen lds
    s_waitcnt lgkmcnt(15)
    s_nop 0
    v_mfma_f32_32x32x16_bf16 v[76:91], v[152:155], v[120:123], v[76:91]
    ds_read_b64_tr_b16 v[180:181], v56 offset:24576
    ds_read_b64_tr_b16 v[182:183], v56 offset:25088
    ds_read_b64_tr_b16 v[196:197], v57 offset:24576
    ds_read_b64_tr_b16 v[198:199], v57 offset:25088
    s_add_u32 m0, s42, 10240
    s_add_u32 s39, s39, 7168
    buffer_load_dwordx4 v18, s[4:7], s39 offen lds
    v_mfma_f32_32x32x16_bf16 v[92:107], v[168:171], v[120:123], v[92:107]
    ds_read_b64_tr_b16 v[184:185], v56 offset:26624
    ds_read_b64_tr_b16 v[186:187], v56 offset:27136
    ds_read_b64_tr_b16 v[200:201], v57 offset:26624
    ds_read_b64_tr_b16 v[202:203], v57 offset:27136
    s_add_u32 m0, s42, 11264
    s_add_u32 s39, s39, 7168
    buffer_load_dwordx4 v19, s[4:7], s39 offen lds
    s_waitcnt lgkmcnt(15)
    s_nop 0
    v_mfma_f32_32x32x16_bf16 v[76:91], v[156:159], v[124:127], v[76:91]
    ds_read_b64_tr_b16 v[188:189], v56 offset:28672
    ds_read_b64_tr_b16 v[190:191], v56 offset:29184
    ds_read_b64_tr_b16 v[204:205], v57 offset:28672
    ds_read_b64_tr_b16 v[206:207], v57 offset:29184
    s_add_u32 m0, s43, 40960
    s_mul_i32 s40, s37, 57344
    s_add_u32 s40, s40, s41
    s_nop 0
    buffer_load_dwordx4 v14, s[8:11], s40 offen lds
    v_mfma_f32_32x32x16_bf16 v[92:107], v[172:175], v[124:127], v[92:107]
    ds_read_b64_tr_b16 v[192:193], v56 offset:30720
    ds_read_b64_tr_b16 v[194:195], v56 offset:31232
    ds_read_b64_tr_b16 v[208:209], v57 offset:30720
    ds_read_b64_tr_b16 v[210:211], v57 offset:31232
    s_add_u32 m0, s43, 41984
    s_add_u32 s40, s40, 7168
    buffer_load_dwordx4 v14, s[8:11], s40 offen lds
    s_add_u32 s37, s37, 1
    s_cmp_eq_u32 s37, 7
    s_cselect_b32 s37, 0, s37
    s_nop 0
    v_mfma_f32_32x32x16_bf16 v[76:91], v[160:163], v[128:131], v[76:91]
    ds_read_b64_tr_b16 v[220:221], v58 offset:24576
    ds_read_b64_tr_b16 v[222:223], v58 offset:25088
    ds_read_b64_tr_b16 v[224:225], v59 offset:24576
    ds_read_b64_tr_b16 v[226:227], v59 offset:25088
    v_mfma_f32_32x32x16_bf16 v[92:107], v[176:179], v[128:131], v[92:107]
    s_waitcnt lgkmcnt(15)
    v_mfma_f32_16x16x32_bf16 v[108:111], v[64:67], v[212:215], v[108:111]
    v_mfma_f32_16x16x32_bf16 v[112:115], v[64:67], v[216:219], v[112:115]
    v_mfma_f32_32x32x16_bf16 v[76:91], v[180:183], v[132:135], v[76:91]
    s_add_u32 m0, s42, 0
    s_lshl_b32 s39, s37, 7
    s_add_u32 s39, s39, s38
    buffer_load_dwordx4 v18, s[4:7], s39 offen lds
    v_mfma_f32_32x32x16_bf16 v[92:107], v[196:199], v[132:135], v[92:107]
    s_waitcnt vmcnt(7)
    s_barrier
    ds_read_b128 v[116:119], v52 offset:4096
    ds_read_b128 v[120:123], v53 offset:4096
    ds_read_b128 v[124:127], v54 offset:4096
    ds_read_b128 v[128:131], v55 offset:4096
    s_add_u32 m0, s42, 1024
    s_add_u32 s39, s39, 7168
    buffer_load_dwordx4 v19, s[4:7], s39 offen lds
    s_waitcnt lgkmcnt(15)
    s_nop 0
    v_mfma_f32_32x32x16_bf16 v[76:91], v[184:187], v[136:139], v[76:91]
    ds_read_b64_tr_b16 v[148:149], v56 offset:32768
    ds_read_b64_tr_b16 v[150:151], v56 offset:33280
    ds_read_b64_tr_b16 v[164:165], v57 offset:32768
    ds_read_b64_tr_b16 v[166:167], v57 offset:33280
    s_add_u32 m0, s42, 2048
    s_add_u32 s39, s39, 7168
    buffer_load_dwordx4 v18, s[4:7], s39 offen lds
    v_mfma_f32_32x32x16_bf16 v[92:107], v[200:203], v[136:139], v[92:107]
    ds_read_b64_tr_b16 v[152:153], v56 offset:34816
    ds_read_b64_tr_b16 v[154:155], v56 offset:35328
    ds_read_b64_tr_b16 v[168:169], v57 offset:34816
    ds_read_b64_tr_b16 v[170:171], v57 offset:35328
    s_add_u32 m0, s42, 3072
    s_add_u32 s39, s39, 7168
    buffer_load_dwordx4 v19, s[4:7], s39 offen lds
    s_waitcnt lgkmcnt(15)
    s_nop 0
    v_mfma_f32_32x32x16_bf16 v[76:91], v[188:191], v[140:143], v[76:91]
    ds_read_b64_tr_b16 v[156:157], v56 offset:36864
    ds_read_b64_tr_b16 v[158:159], v56 offset:37376
    ds_read_b64_tr_b16 v[172:173], v57 offset:36864
    ds_read_b64_tr_b16 v[174:175], v57 offset:37376
    s_add_u32 m0, s43, 49152
    s_mul_i32 s40, s37, 57344
    s_add_u32 s40, s40, s41
    s_nop 0
    buffer_load_dwordx4 v14, s[8:11], s40 offen lds
    v_mfma_f32_32x32x16_bf16 v[92:107], v[204:207], v[140:143], v[92:107]
    ds_read_b64_tr_b16 v[160:161], v56 offset:38912
    ds_read_b64_tr_b16 v[162:163], v56 offset:39424
    ds_read_b64_tr_b16 v[176:177], v57 offset:38912
    ds_read_b64_tr_b16 v[178:179], v57 offset:39424
    s_add_u32 m0, s43, 50176
    s_add_u32 s40, s40, 7168
    buffer_load_dwordx4 v14, s[8:11], s40 offen lds
    s_add_u32 s37, s37, 1
    s_cmp_eq_u32 s37, 7
    s_cselect_b32 s37, 0, s37
    s_nop 0
    v_mfma_f32_32x32x16_bf16 v[76:91], v[192:195], v[144:147], v[76:91]
    ds_read_b64_tr_b16 v[212:213], v58 offset:32768
    ds_read_b64_tr_b16 v[214:215], v58 offset:33280
    ds_read_b64_tr_b16 v[216:217], v59 offset:32768
    ds_read_b64_tr_b16 v[218:219], v59 offset:33280
    v_mfma_f32_32x32x16_bf16 v[92:107], v[208:211], v[144:147], v[92:107]
    s_waitcnt lgkmcnt(15)
    s_nop 0
    v_mfma_f32_16x16x32_bf16 v[108:111], v[64:67], v[220:223], v[108:111]
    v_mfma_f32_16x16x32_bf16 v[112:115], v[64:67], v[224:227], v[112:115]
    v_mfma_f32_32x32x16_bf16 v[76:91], v[148:151], v[116:119], v[76:91]
    s_add_u32 m0, s89, 8192
    s_add_u32 s33, s88, 57344
    buffer_load_dwordx4 v14, s[20:23], s33 offen lds
    v_mfma_f32_32x32x16_bf16 v[92:107], v[164:167], v[116:119], v[92:107]
    s_waitcnt vmcnt(7)
    s_barrier
    ds_read_b128 v[132:135], v52 offset:8192
    ds_read_b128 v[136:139], v53 offset:8192
    ds_read_b128 v[140:143], v54 offset:8192
    ds_read_b128 v[144:147], v55 offset:8192
    s_add_u32 m0, s89, 12288
    s_add_u32 s33, s88, 86016
    buffer_load_dwordx4 v14, s[20:23], s33 offen lds
    s_waitcnt lgkmcnt(15)
    s_nop 0
    v_mfma_f32_32x32x16_bf16 v[76:91], v[152:155], v[120:123], v[76:91]
    ds_read_b64_tr_b16 v[180:181], v56 offset:40960
    ds_read_b64_tr_b16 v[182:183], v56 offset:41472
    ds_read_b64_tr_b16 v[196:197], v57 offset:40960
    ds_read_b64_tr_b16 v[198:199], v57 offset:41472
    s_add_u32 m0, s89, 16384
    s_add_u32 s33, s88, 114688
    buffer_load_dwordx4 v14, s[20:23], s33 offen lds
    v_mfma_f32_32x32x16_bf16 v[92:107], v[168:171], v[120:123], v[92:107]
    ds_read_b64_tr_b16 v[184:185], v56 offset:43008
    ds_read_b64_tr_b16 v[186:187], v56 offset:43520
    ds_read_b64_tr_b16 v[200:201], v57 offset:43008
    ds_read_b64_tr_b16 v[202:203], v57 offset:43520
    s_add_u32 m0, s89, 20480
    s_add_u32 s33, s88, 143360
    buffer_load_dwordx4 v14, s[20:23], s33 offen lds
    s_waitcnt lgkmcnt(15)
    s_nop 0
    v_mfma_f32_32x32x16_bf16 v[76:91], v[156:159], v[124:127], v[76:91]
    ds_read_b64_tr_b16 v[188:189], v56 offset:45056
    ds_read_b64_tr_b16 v[190:191], v56 offset:45568
    ds_read_b64_tr_b16 v[204:205], v57 offset:45056
    ds_read_b64_tr_b16 v[206:207], v57 offset:45568
    s_add_u32 m0, s89, 24576
    s_add_u32 s33, s88, 172032
    buffer_load_dwordx4 v14, s[20:23], s33 offen lds
    v_mfma_f32_32x32x16_bf16 v[92:107], v[172:175], v[124:127], v[92:107]
    ds_read_b64_tr_b16 v[192:193], v56 offset:47104
    ds_read_b64_tr_b16 v[194:195], v56 offset:47616
    ds_read_b64_tr_b16 v[208:209], v57 offset:47104
    ds_read_b64_tr_b16 v[210:211], v57 offset:47616
    s_add_u32 m0, s89, 28672
    s_add_u32 s33, s88, 200704
    buffer_load_dwordx4 v14, s[20:23], s33 offen lds
    v_mfma_f32_32x32x16_bf16 v[76:91], v[160:163], v[128:131], v[76:91]
    ds_read_b64_tr_b16 v[220:221], v58 offset:40960
    ds_read_b64_tr_b16 v[222:223], v58 offset:41472
    ds_read_b64_tr_b16 v[224:225], v59 offset:40960
    ds_read_b64_tr_b16 v[226:227], v59 offset:41472
    s_add_u32 m0, s89, 32768
    s_add_u32 s33, s88, 229376
    buffer_load_dwordx4 v14, s[20:23], s33 offen lds
    v_mfma_f32_32x32x16_bf16 v[92:107], v[176:179], v[128:131], v[92:107]
    buffer_load_dwordx4 v[20:23], v72, s[12:15], 0 offen offset:0 sc1
    buffer_load_dwordx4 v[24:27], v72, s[12:15], 0 offen offset:1024 sc1
    buffer_load_dwordx4 v[28:31], v72, s[12:15], 0 offen offset:2048 sc1
    buffer_load_dwordx4 v[32:35], v72, s[12:15], 0 offen offset:3072 sc1
    s_waitcnt lgkmcnt(15)
    s_nop 0
    v_mfma_f32_16x16x32_bf16 v[108:111], v[64:67], v[212:215], v[108:111]
    v_mfma_f32_16x16x32_bf16 v[112:115], v[64:67], v[216:219], v[112:115]
    v_mfma_f32_32x32x16_bf16 v[76:91], v[180:183], v[132:135], v[76:91]
    s_add_u32 m0, s89, 36864
    s_add_u32 s33, s88, 258048
    buffer_load_dwordx4 v14, s[20:23], s33 offen lds
    v_mfma_f32_32x32x16_bf16 v[92:107], v[196:199], v[132:135], v[92:107]
    s_waitcnt vmcnt(12)
    s_barrier
    ds_read_b128 v[116:119], v52 offset:0
    ds_read_b128 v[120:123], v53 offset:0
    ds_read_b128 v[124:127], v54 offset:0
    ds_read_b128 v[128:131], v55 offset:0
    s_add_u32 m0, s89, 40960
    s_add_u32 s33, s88, 286720
    buffer_load_dwordx4 v14, s[20:23], s33 offen lds
    s_waitcnt lgkmcnt(15)
    s_nop 0
    v_mfma_f32_32x32x16_bf16 v[76:91], v[184:187], v[136:139], v[76:91]
    ds_read_b64_tr_b16 v[148:149], v56 offset:49152
    ds_read_b64_tr_b16 v[150:151], v56 offset:49664
    ds_read_b64_tr_b16 v[164:165], v57 offset:49152
    ds_read_b64_tr_b16 v[166:167], v57 offset:49664
    s_add_u32 m0, s89, 45056
    s_add_u32 s33, s88, 315392
    buffer_load_dwordx4 v14, s[20:23], s33 offen lds
    v_mfma_f32_32x32x16_bf16 v[92:107], v[200:203], v[136:139], v[92:107]
    ds_read_b64_tr_b16 v[152:153], v56 offset:51200
    ds_read_b64_tr_b16 v[154:155], v56 offset:51712
    ds_read_b64_tr_b16 v[168:169], v57 offset:51200
    ds_read_b64_tr_b16 v[170:171], v57 offset:51712
    s_add_u32 m0, s89, 49152
    s_add_u32 s33, s88, 344064
    buffer_load_dwordx4 v14, s[20:23], s33 offen lds
    s_waitcnt lgkmcnt(15)
    s_nop 0
    v_mfma_f32_32x32x16_bf16 v[76:91], v[188:191], v[140:143], v[76:91]
    ds_read_b64_tr_b16 v[156:157], v56 offset:53248
    ds_read_b64_tr_b16 v[158:159], v56 offset:53760
    ds_read_b64_tr_b16 v[172:173], v57 offset:53248
    ds_read_b64_tr_b16 v[174:175], v57 offset:53760
    s_add_u32 m0, s89, 53248
    s_add_u32 s33, s88, 372736
    buffer_load_dwordx4 v14, s[20:23], s33 offen lds
    v_mfma_f32_32x32x16_bf16 v[92:107], v[204:207], v[140:143], v[92:107]
    ds_read_b64_tr_b16 v[160:161], v56 offset:55296
    ds_read_b64_tr_b16 v[162:163], v56 offset:55808
    ds_read_b64_tr_b16 v[176:177], v57 offset:55296
    ds_read_b64_tr_b16 v[178:179], v57 offset:55808
    v_mfma_f32_32x32x16_bf16 v[76:91], v[192:195], v[144:147], v[76:91]
    ds_read_b64_tr_b16 v[212:213], v58 offset:49152
    ds_read_b64_tr_b16 v[214:215], v58 offset:49664
    ds_read_b64_tr_b16 v[216:217], v59 offset:49152
    ds_read_b64_tr_b16 v[218:219], v59 offset:49664
    s_lshl_b32 s31, s2, 2
    s_add_u32 s31, s31, s3
    s_mul_i32 s31, s31, 3584
    v_lshlrev_b32 v10, 7, v1
    v_cmp_gt_u32 vcc, 28, v1
    v_mov_b32 v11, 0x7fff0000
    s_nop 0
    v_cndmask_b32 v10, v11, v10, vcc
    buffer_load_dword v2, v10, s[24:27], s31 offen
    v_mfma_f32_32x32x16_bf16 v[92:107], v[208:211], v[144:147], v[92:107]
    s_waitcnt lgkmcnt(15)
    v_mfma_f32_16x16x32_bf16 v[108:111], v[64:67], v[220:223], v[108:111]
    v_mfma_f32_16x16x32_bf16 v[112:115], v[64:67], v[224:227], v[112:115]
    s_waitcnt lgkmcnt(2)
    v_mfma_f32_16x16x32_bf16 v[108:111], v[64:67], v[212:215], v[108:111]
    s_waitcnt lgkmcnt(0)
    v_mfma_f32_16x16x32_bf16 v[112:115], v[64:67], v[216:219], v[112:115]
    v_mfma_f32_32x32x16_bf16 v[76:91], v[148:151], v[116:119], v[76:91]
    s_nop 6
    v_mov_b32_e64 v109, v112
    ds_write_b64 v69, v[108:109]
    v_mfma_f32_32x32x16_bf16 v[92:107], v[164:167], v[116:119], v[92:107]
    s_waitcnt vmcnt(6)
    v_cndmask_b32 v33, v21, v33, s[56:57]
    v_cndmask_b32 v35, v21, v35, s[56:57]
    v_xor_b32 v4, s30, v21
    v_xor_b32 v5, s30, v23
    v_or_b32 v4, v4, v5
    v_xor_b32 v5, s30, v25
    v_or_b32 v4, v4, v5
    v_xor_b32 v5, s30, v27
    v_or_b32 v4, v4, v5
    v_xor_b32 v5, s30, v29
    v_or_b32 v4, v4, v5
    v_xor_b32 v5, s30, v31
    v_or_b32 v4, v4, v5
    v_xor_b32 v5, s30, v33
    v_or_b32 v4, v4, v5
    v_xor_b32 v5, s30, v35
    v_or_b32 v4, v4, v5
    v_cmp_ne_u32_e64 vcc, 0, v4
    s_nop 1
    s_cbranch_vccz .Lstok8
    s_waitcnt vmcnt(0) lgkmcnt(0)
    s_mov_b32 s34, 0
.Lspin9:
    buffer_load_dwordx4 v[20:23], v72, s[12:15], 0 offen offset:0 sc1
    buffer_load_dwordx4 v[24:27], v72, s[12:15], 0 offen offset:1024 sc1
    buffer_load_dwordx4 v[28:31], v72, s[12:15], 0 offen offset:2048 sc1
    buffer_load_dwordx4 v[32:35], v72, s[12:15], 0 offen offset:3072 sc1
    s_add_u32 s34, s34, 1
    s_waitcnt vmcnt(0)
    v_cndmask_b32 v33, v21, v33, s[56:57]
    v_cndmask_b32 v35, v21, v35, s[56:57]
    v_xor_b32 v4, s30, v21
    v_xor_b32 v5, s30, v23
    v_or_b32 v4, v4, v5
    v_xor_b32 v5, s30, v25
    v_or_b32 v4, v4, v5
    v_xor_b32 v5, s30, v27
    v_or_b32 v4, v4, v5
    v_xor_b32 v5, s30, v29
    v_or_b32 v4, v4, v5
    v_xor_b32 v5, s30, v31
    v_or_b32 v4, v4, v5
    v_xor_b32 v5, s30, v33
    v_or_b32 v4, v4, v5
    v_xor_b32 v5, s30, v35
    v_or_b32 v4, v4, v5
    v_cmp_ne_u32 vcc, 0, v4
    s_cmp_ge_u32 s34, 200000
    s_cbranch_scc1 .Lspun10
    s_cbranch_vccnz .Lspin9
.Lspun10:
    s_nop 1
.Lstok8:
    v_mfma_f32_32x32x16_bf16 v[76:91], v[152:155], v[120:123], v[76:91]
    s_waitcnt lgkmcnt(0)
    s_barrier
    s_nop 0
    ds_read_b64 v[180:181], v70 offset:0
    ds_read_b64 v[182:183], v70 offset:512
    ds_read_b64 v[184:185], v70 offset:1024
    ds_read_b64 v[186:187], v70 offset:1536
    v_mfma_f32_32x32x16_bf16 v[92:107], v[168:171], v[120:123], v[92:107]
    v_cndmask_b32 v32, 0, v32, s[56:57]
    v_cndmask_b32 v34, 0, v34, s[56:57]
    v_add_f32 v20, v20, v24
    v_add_f32 v28, v28, v32
    v_add_f32 v20, v20, v28
    v_add_f32 v22, v22, v26
    v_mfma_f32_32x32x16_bf16 v[76:91], v[156:159], v[124:127], v[76:91]
    v_add_f32 v30, v30, v34
    v_add_f32 v22, v22, v30
    v_mov_b32 v21, v20
    v_mov_b32_e64 v23, v22
    s_nop 0
    v_permlane32_swap_b32 v20, v21
    v_permlane32_swap_b32 v22, v23
    v_mfma_f32_32x32x16_bf16 v[92:107], v[172:175], v[124:127], v[92:107]
    v_add_f32 v20, v20, v21
    v_add_f32 v22, v22, v23
    v_mul_f32 v228, 0x3b124925, v20
    v_mul_f32 v229, 0x3b124925, v22
    v_fma_f32 v229, -v228, v228, v229
    v_max_f32_e64 v229, 0, v229
    v_mfma_f32_32x32x16_bf16 v[76:91], v[160:163], v[128:131], v[76:91]
    v_cvt_pk_bf16_f32 v196, -v228, -v228
    v_and_b32 v5, 0xffff0000, v196
    v_add_f32_e64 v5, v228, v5
    v_cvt_pk_bf16_f32 v197, -v5, 0
    v_mov_b32 v198, 0
    v_mov_b32 v199, 0
    v_mfma_f32_32x32x16_bf16 v[92:107], v[176:179], v[128:131], v[92:107]
    s_waitcnt lgkmcnt(2)
    v_add_f32 v180, v180, v182
    s_waitcnt lgkmcnt(0)
    v_add_f32 v184, v184, v186
    v_add_f32 v180, v180, v184
    v_add_f32 v181, v181, v183
    v_add_f32 v185, v185, v187
    v_add_f32 v181, v181, v185
    v_cndmask_b32 v5, 0, v180, s[56:57]
    v_cvt_pk_bf16_f32 v201, v5, 0
    v_lshlrev_b32 v202, 16, v201
    v_sub_f32 v202, v5, v202
    v_cvt_pk_bf16_f32 v200, v5, v202
    v_mov_b32 v202, 0
    v_mov_b32_e64 v203, 0
    s_nop 1
    v_mfma_f32_32x32x16_bf16 v[76:91], v[200:203], v[196:199], v[76:91]
    v_cndmask_b32 v5, 0, v181, s[56:57]
    v_cvt_pk_bf16_f32 v205, v5, 0
    v_lshlrev_b32 v206, 16, v205
    v_sub_f32 v206, v5, v206
    v_cvt_pk_bf16_f32 v204, v5, v206
    v_mov_b32 v206, 0
    v_mov_b32_e64 v207, 0
    s_nop 1
    v_mfma_f32_32x32x16_bf16 v[92:107], v[204:207], v[196:199], v[92:107]
    v_add_f32 v4, 0x3727c5ac, v229
    v_rsq_f32_e64 v231, v4
    v_mov_b32 v5, 0x3727c5ac
    v_mul_f32_e64 v4, v231, v231
    v_fma_f32 v4, v4, v229, v5
    v_rsq_f32 v4, v4
    v_mul_f32 v230, v228, v231
    v_mul_f32 v4, v4, v231
    v_rcp_f32 v232, v4
    v_mul_f32 v74, 0xc0135761, v4
    v_mul_f32_e64 v5, v4, v4
    v_mul_f32 v5, 0x3d372713, v5
    v_mul_f32_e64 v75, v5, v74
    v_pk_mul_f32 v[148:149], v[76:77], v[76:77]
    v_pk_mul_f32 v[150:151], v[78:79], v[78:79]
    v_pk_mul_f32 v[152:153], v[80:81], v[80:81]
    v_pk_mul_f32 v[154:155], v[82:83], v[82:83]
    v_pk_mul_f32 v[156:157], v[84:85], v[84:85]
    v_pk_mul_f32 v[158:159], v[86:87], v[86:87]
    v_pk_mul_f32 v[160:161], v[88:89], v[88:89]
    v_pk_mul_f32 v[162:163], v[90:91], v[90:91]
    v_pk_fma_f32 v[148:149], v[148:149], v[74:75], v[74:75] op_sel:[0,1,0] op_sel_hi:[1,1,0]
    v_pk_fma_f32 v[150:151], v[150:151], v[74:75], v[74:75] op_sel:[0,1,0] op_sel_hi:[1,1,0]
    v_pk_fma_f32 v[152:153], v[152:153], v[74:75], v[74:75] op_sel:[0,1,0] op_sel_hi:[1,1,0]
    v_pk_fma_f32 v[154:155], v[154:155], v[74:75], v[74:75] op_sel:[0,1,0] op_sel_hi:[1,1,0]
    v_pk_fma_f32 v[156:157], v[156:157], v[74:75], v[74:75] op_sel:[0,1,0] op_sel_hi:[1,1,0]
    v_pk_fma_f32 v[158:159], v[158:159], v[74:75], v[74:75] op_sel:[0,1,0] op_sel_hi:[1,1,0]
    v_pk_fma_f32 v[160:161], v[160:161], v[74:75], v[74:75] op_sel:[0,1,0] op_sel_hi:[1,1,0]
    v_pk_fma_f32 v[162:163], v[162:163], v[74:75], v[74:75] op_sel:[0,1,0] op_sel_hi:[1,1,0]
    v_pk_mul_f32 v[148:149], v[148:149], v[76:77]
    v_pk_mul_f32 v[150:151], v[150:151], v[78:79]
    v_pk_mul_f32 v[152:153], v[152:153], v[80:81]
    v_pk_mul_f32 v[154:155], v[154:155], v[82:83]
    v_pk_mul_f32 v[156:157], v[156:157], v[84:85]
    v_pk_mul_f32 v[158:159], v[158:159], v[86:87]
    v_pk_mul_f32 v[160:161], v[160:161], v[88:89]
    v_pk_mul_f32 v[162:163], v[162:163], v[90:91]
    v_exp_f32 v148, v148
    v_exp_f32 v149, v149
    v_exp_f32 v150, v150
    v_exp_f32 v151, v151
    v_exp_f32 v152, v152
    v_exp_f32 v153, v153
    v_exp_f32 v154, v154
    v_exp_f32 v155, v155
    v_exp_f32 v156, v156
    v_exp_f32 v157, v157
    v_exp_f32 v158, v158
    v_exp_f32 v159, v159
    v_exp_f32 v160, v160
    v_exp_f32 v161, v161
    v_exp_f32 v162, v162
    v_exp_f32 v163, v163
    v_pk_fma_f32 v[148:149], v[148:149], v[232:233], v[232:233] op_sel_hi:[1,0,0]
    v_pk_fma_f32 v[150:151], v[150:151], v[232:233], v[232:233] op_sel_hi:[1,0,0]
    v_pk_fma_f32 v[152:153], v[152:153], v[232:233], v[232:233] op_sel_hi:[1,0,0]
    v_pk_fma_f32 v[154:155], v[154:155], v[232:233], v[232:233] op_sel_hi:[1,0,0]
    v_pk_fma_f32 v[156:157], v[156:157], v[232:233], v[232:233] op_sel_hi:[1,0,0]
    v_pk_fma_f32 v[158:159], v[158:159], v[232:233], v[232:233] op_sel_hi:[1,0,0]
    v_pk_fma_f32 v[160:161], v[160:161], v[232:233], v[232:233] op_sel_hi:[1,0,0]
    v_pk_fma_f32 v[162:163], v[162:163], v[232:233], v[232:233] op_sel_hi:[1,0,0]
    v_rcp_f32 v148, v148
    v_rcp_f32 v149, v149
    v_rcp_f32 v150, v150
    v_rcp_f32 v151, v151
    v_rcp_f32 v152, v152
    v_rcp_f32 v153, v153
    v_rcp_f32 v154, v154
    v_rcp_f32 v155, v155
    v_rcp_f32 v156, v156
    v_rcp_f32 v157, v157
    v_rcp_f32 v158, v158
    v_rcp_f32 v159, v159
    v_rcp_f32 v160, v160
    v_rcp_f32 v161, v161
    v_rcp_f32 v162, v162
    v_rcp_f32 v163, v163
    v_pk_mul_f32 v[148:149], v[148:149], v[76:77]
    v_pk_mul_f32 v[150:151], v[150:151], v[78:79]
    v_pk_mul_f32 v[152:153], v[152:153], v[80:81]
    v_pk_mul_f32 v[154:155], v[154:155], v[82:83]
    v_pk_mul_f32 v[156:157], v[156:157], v[84:85]
    v_pk_mul_f32 v[158:159], v[158:159], v[86:87]
    v_pk_mul_f32 v[160:161], v[160:161], v[88:89]
    v_pk_mul_f32 v[162:163], v[162:163], v[90:91]
    v_cvt_pk_bf16_f32 v164, v148, v149
    v_cvt_pk_bf16_f32 v165, v150, v151
    v_cvt_pk_bf16_f32 v166, v152, v153
    v_cvt_pk_bf16_f32 v167, v154, v155
    v_cvt_pk_bf16_f32 v168, v156, v157
    v_cvt_pk_bf16_f32 v169, v158, v159
    v_cvt_pk_bf16_f32 v170, v160, v161
    v_cvt_pk_bf16_f32 v171, v162, v163
    buffer_store_dwordx4 v[164:167], v3, s[12:15], s47 offen offset:0 sc1
    buffer_store_dwordx4 v[168:171], v3, s[12:15], s47 offen offset:1024 sc1
    v_pk_mul_f32 v[148:149], v[92:93], v[92:93]
    v_pk_mul_f32 v[150:151], v[94:95], v[94:95]
    v_pk_mul_f32 v[152:153], v[96:97], v[96:97]
    v_pk_mul_f32 v[154:155], v[98:99], v[98:99]
    v_pk_mul_f32 v[156:157], v[100:101], v[100:101]
    v_pk_mul_f32 v[158:159], v[102:103], v[102:103]
    v_pk_mul_f32 v[160:161], v[104:105], v[104:105]
    v_pk_mul_f32 v[162:163], v[106:107], v[106:107]
    v_pk_fma_f32 v[148:149], v[148:149], v[74:75], v[74:75] op_sel:[0,1,0] op_sel_hi:[1,1,0]
    v_pk_fma_f32 v[150:151], v[150:151], v[74:75], v[74:75] op_sel:[0,1,0] op_sel_hi:[1,1,0]
    v_pk_fma_f32 v[152:153], v[152:153], v[74:75], v[74:75] op_sel:[0,1,0] op_sel_hi:[1,1,0]
    v_pk_fma_f32 v[154:155], v[154:155], v[74:75], v[74:75] op_sel:[0,1,0] op_sel_hi:[1,1,0]
    v_pk_fma_f32 v[156:157], v[156:157], v[74:75], v[74:75] op_sel:[0,1,0] op_sel_hi:[1,1,0]
    v_pk_fma_f32 v[158:159], v[158:159], v[74:75], v[74:75] op_sel:[0,1,0] op_sel_hi:[1,1,0]
    v_pk_fma_f32 v[160:161], v[160:161], v[74:75], v[74:75] op_sel:[0,1,0] op_sel_hi:[1,1,0]
    v_pk_fma_f32 v[162:163], v[162:163], v[74:75], v[74:75] op_sel:[0,1,0] op_sel_hi:[1,1,0]
    v_pk_mul_f32 v[148:149], v[148:149], v[92:93]
    v_pk_mul_f32 v[150:151], v[150:151], v[94:95]
    v_pk_mul_f32 v[152:153], v[152:153], v[96:97]
    v_pk_mul_f32 v[154:155], v[154:155], v[98:99]
    v_pk_mul_f32 v[156:157], v[156:157], v[100:101]
    v_pk_mul_f32 v[158:159], v[158:159], v[102:103]
    v_pk_mul_f32 v[160:161], v[160:161], v[104:105]
    v_pk_mul_f32 v[162:163], v[162:163], v[106:107]
    v_exp_f32 v148, v148
    v_exp_f32 v149, v149
    v_exp_f32 v150, v150
    v_exp_f32 v151, v151
    v_exp_f32 v152, v152
    v_exp_f32 v153, v153
    v_exp_f32 v154, v154
    v_exp_f32 v155, v155
    v_exp_f32 v156, v156
    v_exp_f32 v157, v157
    v_exp_f32 v158, v158
    v_exp_f32 v159, v159
    v_exp_f32 v160, v160
    v_exp_f32 v161, v161
    v_exp_f32 v162, v162
    v_exp_f32 v163, v163
    v_pk_fma_f32 v[148:149], v[148:149], v[232:233], v[232:233] op_sel_hi:[1,0,0]
    v_pk_fma_f32 v[150:151], v[150:151], v[232:233], v[232:233] op_sel_hi:[1,0,0]
    v_pk_fma_f32 v[152:153], v[152:153], v[232:233], v[232:233] op_sel_hi:[1,0,0]
    v_pk_fma_f32 v[154:155], v[154:155], v[232:233], v[232:233] op_sel_hi:[1,0,0]
    v_pk_fma_f32 v[156:157], v[156:157], v[232:233], v[232:233] op_sel_hi:[1,0,0]
    v_pk_fma_f32 v[158:159], v[158:159], v[232:233], v[232:233] op_sel_hi:[1,0,0]
    v_pk_fma_f32 v[160:161], v[160:161], v[232:233], v[232:233] op_sel_hi:[1,0,0]
    v_pk_fma_f32 v[162:163], v[162:163], v[232:233], v[232:233] op_sel_hi:[1,0,0]
    v_rcp_f32 v148, v148
    v_rcp_f32 v149, v149
    v_rcp_f32 v150, v150
    v_rcp_f32 v151, v151
    v_rcp_f32 v152, v152
    v_rcp_f32 v153, v153
    v_rcp_f32 v154, v154
    v_rcp_f32 v155, v155
    v_rcp_f32 v156, v156
    v_rcp_f32 v157, v157
    v_rcp_f32 v158, v158
    v_rcp_f32 v159, v159
    v_rcp_f32 v160, v160
    v_rcp_f32 v161, v161
    v_rcp_f32 v162, v162
    v_rcp_f32 v163, v163
    v_pk_mul_f32 v[148:149], v[148:149], v[92:93]
    v_pk_mul_f32 v[150:151], v[150:151], v[94:95]
    v_pk_mul_f32 v[152:153], v[152:153], v[96:97]
    v_pk_mul_f32 v[154:155], v[154:155], v[98:99]
    v_pk_mul_f32 v[156:157], v[156:157], v[100:101]
    v_pk_mul_f32 v[158:159], v[158:159], v[102:103]
    v_pk_mul_f32 v[160:161], v[160:161], v[104:105]
    v_pk_mul_f32 v[162:163], v[162:163], v[106:107]
    v_cvt_pk_bf16_f32 v172, v148, v149
    v_cvt_pk_bf16_f32 v173, v150, v151
    v_cvt_pk_bf16_f32 v174, v152, v153
    v_cvt_pk_bf16_f32 v175, v154, v155
    v_cvt_pk_bf16_f32 v176, v156, v157
    v_cvt_pk_bf16_f32 v177, v158, v159
    v_cvt_pk_bf16_f32 v178, v160, v161
    v_cvt_pk_bf16_f32 v179, v162, v163
    buffer_store_dwordx4 v[172:175], v3, s[12:15], s47 offen offset:2048 sc1
    buffer_store_dwordx4 v[176:179], v3, s[12:15], s47 offen offset:3072 sc1
    s_add_u32 m0, s89, 0
    s_add_u32 s33, s88, 0
    buffer_load_dwordx4 v14, s[20:23], s33 offen lds
    s_add_u32 m0, s89, 4096
    s_add_u32 s33, s88, 28672
    buffer_load_dwordx4 v14, s[20:23], s33 offen lds
    s_add_u32 m0, s87, 0
    s_add_u32 s33, s86, 0
    buffer_load_dwordx4 v15, s[24:27], s33 offen lds
    s_add_u32 m0, s92, 0
    s_add_u32 s33, s86, 0
    s_mov_b32 exec_hi, 0xffff
    buffer_load_dwordx4 v16, s[24:27], s33 offen lds
    s_mov_b32 exec_hi, -1
    s_nop 0
    s_add_u32 m0, s87, 4096
    s_add_u32 s33, s86, 114688
    buffer_load_dwordx4 v15, s[24:27], s33 offen lds
    s_add_u32 m0, s92, 3072
    s_add_u32 s33, s86, 114688
    s_mov_b32 exec_hi, 0xffff
    buffer_load_dwordx4 v16, s[24:27], s33 offen lds
    s_mov_b32 exec_hi, -1
    s_nop 0
    s_add_u32 m0, s87, 8192
    s_add_u32 s33, s86, 229376
    buffer_load_dwordx4 v15, s[24:27], s33 offen lds
    s_add_u32 m0, s92, 6144
    s_add_u32 s33, s86, 229376
    s_mov_b32 exec_hi, 0xffff
    buffer_load_dwordx4 v16, s[24:27], s33 offen lds
    s_mov_b32 exec_hi, -1
    v_permlane32_swap_b32 v116, v118
    v_permlane32_swap_b32 v117, v119
    v_permlane32_swap_b32 v120, v122
    v_permlane32_swap_b32 v121, v123
    v_lshlrev_b32 v20, 16, v116
    v_and_b32 v21, 0xffff0000, v116
    v_lshlrev_b32_e64 v22, 16, v117
    v_and_b32 v23, 0xffff0000, v117
    v_lshlrev_b32_e64 v24, 16, v118
    v_and_b32 v25, 0xffff0000, v118
    v_lshlrev_b32_e64 v26, 16, v119
    v_and_b32 v27, 0xffff0000, v119
    v_lshlrev_b32_e64 v28, 16, v120
    v_and_b32 v29, 0xffff0000, v120
    v_lshlrev_b32_e64 v30, 16, v121
    v_and_b32 v31, 0xffff0000, v121
    v_lshlrev_b32_e64 v32, 16, v122
    v_and_b32 v33, 0xffff0000, v122
    v_lshlrev_b32_e64 v34, 16, v123
    v_and_b32 v35, 0xffff0000, v123
    v_permlane32_swap_b32 v124, v126
    v_permlane32_swap_b32 v125, v127
    v_permlane32_swap_b32 v128, v130
    v_permlane32_swap_b32 v129, v131
    v_lshlrev_b32_e64 v36, 16, v124
    v_and_b32 v37, 0xffff0000, v124
    v_lshlrev_b32_e64 v38, 16, v125
    v_and_b32 v39, 0xffff0000, v125
    v_lshlrev_b32_e64 v40, 16, v126
    v_and_b32 v41, 0xffff0000, v126
    v_lshlrev_b32_e64 v42, 16, v127
    v_and_b32 v43, 0xffff0000, v127
    v_lshlrev_b32_e64 v44, 16, v128
    v_and_b32 v45, 0xffff0000, v128
    v_lshlrev_b32_e64 v46, 16, v129
    v_and_b32 v47, 0xffff0000, v129
    v_lshlrev_b32_e64 v48, 16, v130
    v_and_b32 v49, 0xffff0000, v130
    v_lshlrev_b32_e64 v50, 16, v131
    v_and_b32 v51, 0xffff0000, v131
    v_pk_fma_f32 v[20:21], v[20:21], v[230:231], v[230:231] op_sel:[0,1,0] op_sel_hi:[1,1,0] neg_lo:[0,0,1] neg_hi:[0,0,1]
    v_pk_fma_f32 v[22:23], v[22:23], v[230:231], v[230:231] op_sel:[0,1,0] op_sel_hi:[1,1,0] neg_lo:[0,0,1] neg_hi:[0,0,1]
    v_pk_fma_f32 v[24:25], v[24:25], v[230:231], v[230:231] op_sel:[0,1,0] op_sel_hi:[1,1,0] neg_lo:[0,0,1] neg_hi:[0,0,1]
    v_pk_fma_f32 v[26:27], v[26:27], v[230:231], v[230:231] op_sel:[0,1,0] op_sel_hi:[1,1,0] neg_lo:[0,0,1] neg_hi:[0,0,1]
    v_pk_fma_f32 v[28:29], v[28:29], v[230:231], v[230:231] op_sel:[0,1,0] op_sel_hi:[1,1,0] neg_lo:[0,0,1] neg_hi:[0,0,1]
    v_pk_fma_f32 v[30:31], v[30:31], v[230:231], v[230:231] op_sel:[0,1,0] op_sel_hi:[1,1,0] neg_lo:[0,0,1] neg_hi:[0,0,1]
    v_pk_fma_f32 v[32:33], v[32:33], v[230:231], v[230:231] op_sel:[0,1,0] op_sel_hi:[1,1,0] neg_lo:[0,0,1] neg_hi:[0,0,1]
    v_pk_fma_f32 v[34:35], v[34:35], v[230:231], v[230:231] op_sel:[0,1,0] op_sel_hi:[1,1,0] neg_lo:[0,0,1] neg_hi:[0,0,1]
    v_pk_fma_f32 v[36:37], v[36:37], v[230:231], v[230:231] op_sel:[0,1,0] op_sel_hi:[1,1,0] neg_lo:[0,0,1] neg_hi:[0,0,1]
    v_pk_fma_f32 v[38:39], v[38:39], v[230:231], v[230:231] op_sel:[0,1,0] op_sel_hi:[1,1,0] neg_lo:[0,0,1] neg_hi:[0,0,1]
    v_pk_fma_f32 v[40:41], v[40:41], v[230:231], v[230:231] op_sel:[0,1,0] op_sel_hi:[1,1,0] neg_lo:[0,0,1] neg_hi:[0,0,1]
    v_pk_fma_f32 v[42:43], v[42:43], v[230:231], v[230:231] op_sel:[0,1,0] op_sel_hi:[1,1,0] neg_lo:[0,0,1] neg_hi:[0,0,1]
    v_pk_fma_f32 v[44:45], v[44:45], v[230:231], v[230:231] op_sel:[0,1,0] op_sel_hi:[1,1,0] neg_lo:[0,0,1] neg_hi:[0,0,1]
    v_pk_fma_f32 v[46:47], v[46:47], v[230:231], v[230:231] op_sel:[0,1,0] op_sel_hi:[1,1,0] neg_lo:[0,0,1] neg_hi:[0,0,1]
    v_pk_fma_f32 v[48:49], v[48:49], v[230:231], v[230:231] op_sel:[0,1,0] op_sel_hi:[1,1,0] neg_lo:[0,0,1] neg_hi:[0,0,1]
    v_pk_fma_f32 v[50:51], v[50:51], v[230:231], v[230:231] op_sel:[0,1,0] op_sel_hi:[1,1,0] neg_lo:[0,0,1] neg_hi:[0,0,1]
    s_add_u32 s47, s47, 2359296
    s_waitcnt vmcnt(8)
    s_barrier
    s_cmp_lg_u32 s3, 0
    s_cbranch_scc1 .Lpub11
    s_lshl_b32 s31, s45, 7
    s_add_u32 s31, s31, 6356992
    v_mov_b32 v10, s30
    v_mov_b32 v11, s31
    s_mov_b64 exec, 1
    buffer_store_dword v10, v11, s[12:15], 0 offen sc1
    s_mov_b64 exec, -1
    s_nop 0
.Lpub11:
    s_add_u32 m0, s87, 12288
    s_add_u32 s33, s86, 344064
    buffer_load_dwordx4 v15, s[24:27], s33 offen lds
    s_add_u32 m0, s92, 9216
    s_add_u32 s33, s86, 344064
    s_mov_b32 exec_hi, 0xffff
    buffer_load_dwordx4 v16, s[24:27], s33 offen lds
    s_mov_b32 exec_hi, -1
    s_nop 0
    s_add_u32 m0, s87, 16384
    s_add_u32 s33, s86, 458752
    buffer_load_dwordx4 v15, s[24:27], s33 offen lds
    s_add_u32 m0, s92, 12288
    s_add_u32 s33, s86, 458752
    s_mov_b32 exec_hi, 0xffff
    buffer_load_dwordx4 v16, s[24:27], s33 offen lds
    s_mov_b32 exec_hi, -1
    s_nop 0
    s_add_u32 m0, s87, 20480
    s_add_u32 s33, s86, 573440
    buffer_load_dwordx4 v15, s[24:27], s33 offen lds
    s_add_u32 m0, s92, 15360
    s_add_u32 s33, s86, 573440
    s_mov_b32 exec_hi, 0xffff
    buffer_load_dwordx4 v16, s[24:27], s33 offen lds
    s_mov_b32 exec_hi, -1
    s_nop 0
    s_add_u32 m0, s87, 24576
    s_add_u32 s33, s86, 688128
    buffer_load_dwordx4 v15, s[24:27], s33 offen lds
    s_add_u32 m0, s92, 18432
    s_add_u32 s33, s86, 688128
    s_mov_b32 exec_hi, 0xffff
    buffer_load_dwordx4 v16, s[24:27], s33 offen lds
    s_mov_b32 exec_hi, -1
    s_nop 0
    s_add_u32 m0, s87, 28672
    s_add_u32 s33, s86, 802816
    buffer_load_dwordx4 v15, s[24:27], s33 offen lds
    s_add_u32 m0, s92, 21504
    s_add_u32 s33, s86, 802816
    s_mov_b32 exec_hi, 0xffff
    buffer_load_dwordx4 v16, s[24:27], s33 offen lds
    s_mov_b32 exec_hi, -1
    s_nop 0
    s_add_u32 m0, s87, 32768
    s_add_u32 s33, s86, 917504
    buffer_load_dwordx4 v15, s[24:27], s33 offen lds
    s_add_u32 m0, s92, 24576
    s_add_u32 s33, s86, 917504
    s_mov_b32 exec_hi, 0xffff
    buffer_load_dwordx4 v16, s[24:27], s33 offen lds
    s_mov_b32 exec_hi, -1
    s_nop 0
    s_add_u32 m0, s87, 36864
    s_add_u32 s33, s86, 1032192
    buffer_load_dwordx4 v15, s[24:27], s33 offen lds
    s_add_u32 m0, s92, 27648
    s_add_u32 s33, s86, 1032192
    s_mov_b32 exec_hi, 0xffff
    buffer_load_dwordx4 v16, s[24:27], s33 offen lds
    s_mov_b32 exec_hi, -1
    v_mul_u32_u24 v9, 37, v1
    v_lshrrev_b32 v9, 8, v9
    v_add_u32 v8, v1, v9
    s_lshl_b32 s32, s35, 3
    s_sub_u32 s32, s32, 8
    v_add_u32_e64 v8, s32, v8
    v_and_b32 v8, 127, v8
    v_lshlrev_b32_e64 v8, 7, v8
    v_add_u32 v8, 6356992, v8
    v_cmp_gt_u32_e64 vcc, 21, v0
    v_mov_b32 v73, 0x7fff0000
    s_nop 0
    v_cndmask_b32 v73, v73, v8, vcc
    buffer_load_dword v234, v73, s[12:15], 0 offen sc1
    buffer_store_dwordx4 v[116:119], v3, s[12:15], s47 offen offset:0 sc1
    buffer_store_dwordx4 v[120:123], v3, s[12:15], s47 offen offset:1024 sc1
    buffer_store_dwordx4 v[124:127], v3, s[12:15], s47 offen offset:2048 sc1
    buffer_store_dwordx4 v[128:131], v3, s[12:15], s47 offen offset:3072 sc1
    v_add_u32 v56, 100352, v60
    v_xor_b32 v57, 64, v56
    s_mov_b32 s46, 0
    s_add_u32 s47, s47, 4194304
    s_lshl_b32 s31, s44, 3
    s_add_u32 s31, s31, s36
    s_lshl_b32 s31, s31, 8
    s_add_u32 s31, s31, 8388608
    v_lshl_add_u32 v71, v12, 3, s31
    s_waitcnt vmcnt(25)
    s_cmp_lg_u32 s3, 0
    s_cbranch_scc1 .Lpoll12
    s_mov_b32 exec_lo, 0x1fffff
    s_mov_b32 exec_hi, 0
    s_waitcnt vmcnt(4)
    v_cmp_ne_u32_e64 vcc, s30, v234
    s_nop 1
    s_cbranch_vccz .Lpollx13
    s_waitcnt vmcnt(0)
    s_mov_b32 s34, 0
.Lspin14:
    buffer_load_dword v234, v73, s[12:15], 0 offen sc1
    s_add_u32 s34, s34, 1
    s_waitcnt vmcnt(0)
    v_cmp_ne_u32_e64 vcc, s30, v234
    s_cmp_ge_u32 s34, 200000
    s_cbranch_scc1 .Lspun15
    s_cbranch_vccnz .Lspin14
.Lspun15:
    s_nop 1
.Lpollx13:
    s_mov_b64 exec, -1
.Lpoll12:
    s_barrier
    s_nop 0
    buffer_load_dwordx4 a[0:3], v61, s[12:15], s46 offen offset:0 sc1
    buffer_load_dwordx4 a[4:7], v61, s[12:15], s46 offen offset:1024 sc1
    buffer_load_dwordx4 a[8:11], v61, s[12:15], s46 offen offset:2048 sc1
    buffer_load_dwordx4 a[12:15], v61, s[12:15], s46 offen offset:3072 sc1
    s_add_u32 s46, s46, 4096
    buffer_load_dwordx4 a[16:19], v61, s[12:15], s46 offen offset:0 sc1
    buffer_load_dwordx4 a[20:23], v61, s[12:15], s46 offen offset:1024 sc1
    buffer_load_dwordx4 a[24:27], v61, s[12:15], s46 offen offset:2048 sc1
    buffer_load_dwordx4 a[28:31], v62, s[12:15], s46 offen offset:3072 sc1
    s_add_u32 s46, s46, 4096
    buffer_load_dwordx4 a[32:35], v62, s[12:15], s46 offen offset:0 sc1
    buffer_load_dwordx4 a[36:39], v62, s[12:15], s46 offen offset:1024 sc1
    buffer_load_dwordx4 a[40:43], v62, s[12:15], s46 offen offset:2048 sc1
    buffer_load_dwordx4 a[44:47], v62, s[12:15], s46 offen offset:3072 sc1
    ds_read_b64_tr_b16 v[180:181], v56 offset:0
    ds_read_b64_tr_b16 v[182:183], v56 offset:1024
    ds_read_b64_tr_b16 v[184:185], v57 offset:0
    ds_read_b64_tr_b16 v[186:187], v57 offset:1024
    ds_read_b64_tr_b16 v[188:189], v56 offset:2048
    ds_read_b64_tr_b16 v[190:191], v56 offset:3072
    ds_read_b64_tr_b16 v[192:193], v57 offset:2048
    ds_read_b64_tr_b16 v[194:195], v57 offset:3072
    s_waitcnt vmcnt(11) lgkmcnt(4)
    s_nop 0
    v_mfma_f32_32x32x16_bf16 v[76:91], v[180:183], a[0:3], v[20:35]
    ds_read_b64_tr_b16 v[196:197], v56 offset:4096
    ds_read_b64_tr_b16 v[198:199], v56 offset:5120
    v_mfma_f32_32x32x16_bf16 v[92:107], v[184:187], a[0:3], v[36:51]
    ds_read_b64_tr_b16 v[200:201], v57 offset:4096
    ds_read_b64_tr_b16 v[202:203], v57 offset:5120
    s_add_u32 s46, s46, 4096
    buffer_load_dwordx4 a[48:51], v62, s[12:15], s46 offen offset:0 sc1
    s_waitcnt vmcnt(11) lgkmcnt(4)
    s_nop 0
    v_mfma_f32_32x32x16_bf16 v[76:91], v[188:191], a[4:7], v[76:91]
    ds_read_b64_tr_b16 v[180:181], v56 offset:6144
    ds_read_b64_tr_b16 v[182:183], v56 offset:7168
    v_mfma_f32_32x32x16_bf16 v[92:107], v[192:195], a[4:7], v[92:107]
    ds_read_b64_tr_b16 v[184:185], v57 offset:6144
    ds_read_b64_tr_b16 v[186:187], v57 offset:7168
    buffer_load_dwordx4 a[52:55], v62, s[12:15], s46 offen offset:1024 sc1
    s_waitcnt vmcnt(11) lgkmcnt(4)
    s_nop 0
    v_mfma_f32_32x32x16_bf16 v[76:91], v[196:199], a[8:11], v[76:91]
    ds_read_b64_tr_b16 v[188:189], v56 offset:8192
    ds_read_b64_tr_b16 v[190:191], v56 offset:9216
    v_mfma_f32_32x32x16_bf16 v[92:107], v[200:203], a[8:11], v[92:107]
    ds_read_b64_tr_b16 v[192:193], v57 offset:8192
    ds_read_b64_tr_b16 v[194:195], v57 offset:9216
    buffer_load_dwordx4 a[56:59], v63, s[12:15], s46 offen offset:2048 sc1
    s_waitcnt vmcnt(11) lgkmcnt(4)
    s_nop 0
    v_mfma_f32_32x32x16_bf16 v[76:91], v[180:183], a[12:15], v[76:91]
    ds_read_b64_tr_b16 v[196:197], v56 offset:10240
    ds_read_b64_tr_b16 v[198:199], v56 offset:11264
    v_mfma_f32_32x32x16_bf16 v[92:107], v[184:187], a[12:15], v[92:107]
    ds_read_b64_tr_b16 v[200:201], v57 offset:10240
    ds_read_b64_tr_b16 v[202:203], v57 offset:11264
    buffer_load_dwordx4 a[60:63], v63, s[12:15], s46 offen offset:3072 sc1
    s_waitcnt vmcnt(11) lgkmcnt(4)
    s_nop 0
    v_mfma_f32_32x32x16_bf16 v[76:91], v[188:191], a[16:19], v[76:91]
    ds_read_b64_tr_b16 v[180:181], v56 offset:12288
    ds_read_b64_tr_b16 v[182:183], v56 offset:13312
    v_mfma_f32_32x32x16_bf16 v[92:107], v[192:195], a[16:19], v[92:107]
    ds_read_b64_tr_b16 v[184:185], v57 offset:12288
    ds_read_b64_tr_b16 v[186:187], v57 offset:13312
    s_add_u32 s46, s46, 4096
    buffer_load_dwordx4 a[64:67], v63, s[12:15], s46 offen offset:0 sc1
    s_waitcnt vmcnt(11) lgkmcnt(4)
    s_nop 0
    v_mfma_f32_32x32x16_bf16 v[76:91], v[196:199], a[20:23], v[76:91]
    ds_read_b64_tr_b16 v[188:189], v56 offset:14336
    ds_read_b64_tr_b16 v[190:191], v56 offset:15360
    v_mfma_f32_32x32x16_bf16 v[92:107], v[200:203], a[20:23], v[92:107]
    ds_read_b64_tr_b16 v[192:193], v57 offset:14336
    ds_read_b64_tr_b16 v[194:195], v57 offset:15360
    buffer_load_dwordx4 a[68:71], v63, s[12:15], s46 offen offset:1024 sc1
    s_waitcnt vmcnt(11) lgkmcnt(4)
    s_nop 0
    v_mfma_f32_32x32x16_bf16 v[76:91], v[180:183], a[24:27], v[76:91]
    ds_read_b64_tr_b16 v[196:197], v56 offset:16384
    ds_read_b64_tr_b16 v[198:199], v56 offset:17408
    v_mfma_f32_32x32x16_bf16 v[92:107], v[184:187], a[24:27], v[92:107]
    ds_read_b64_tr_b16 v[200:201], v57 offset:16384
    ds_read_b64_tr_b16 v[202:203], v57 offset:17408
    buffer_load_dwordx4 a[72:75], v63, s[12:15], s46 offen offset:2048 sc1
    s_waitcnt vmcnt(11) lgkmcnt(4)
    s_nop 0
    v_mfma_f32_32x32x16_bf16 v[76:91], v[188:191], a[28:31], v[76:91]
    ds_read_b64_tr_b16 v[180:181], v56 offset:18432
    ds_read_b64_tr_b16 v[182:183], v56 offset:19456
    v_mfma_f32_32x32x16_bf16 v[92:107], v[192:195], a[28:31], v[92:107]
    ds_read_b64_tr_b16 v[184:185], v57 offset:18432
    ds_read_b64_tr_b16 v[186:187], v57 offset:19456
    buffer_load_dwordx4 a[76:79], v63, s[12:15], s46 offen offset:3072 sc1
    s_waitcnt vmcnt(11) lgkmcnt(4)
    s_nop 0
    v_mfma_f32_32x32x16_bf16 v[76:91], v[196:199], a[32:35], v[76:91]
    ds_read_b64_tr_b16 v[188:189], v56 offset:20480
    ds_read_b64_tr_b16 v[190:191], v56 offset:21504
    v_mfma_f32_32x32x16_bf16 v[92:107], v[200:203], a[32:35], v[92:107]
    ds_read_b64_tr_b16 v[192:193], v57 offset:20480
    ds_read_b64_tr_b16 v[194:195], v57 offset:21504
    s_add_u32 s46, s46, 4096
    buffer_load_dwordx4 a[80:83], v63, s[12:15], s46 offen offset:0 sc1
    s_waitcnt vmcnt(11) lgkmcnt(4)
    s_nop 0
    v_mfma_f32_32x32x16_bf16 v[76:91], v[180:183], a[36:39], v[76:91]
    ds_read_b64_tr_b16 v[196:197], v56 offset:22528
    ds_read_b64_tr_b16 v[198:199], v56 offset:23552
    v_mfma_f32_32x32x16_bf16 v[92:107], v[184:187], a[36:39], v[92:107]
    ds_read_b64_tr_b16 v[200:201], v57 offset:22528
    ds_read_b64_tr_b16 v[202:203], v57 offset:23552
    buffer_load_dwordx4 a[84:87], v68, s[12:15], s46 offen offset:1024 sc1
    s_waitcnt vmcnt(11) lgkmcnt(4)
    s_nop 0
    v_mfma_f32_32x32x16_bf16 v[76:91], v[188:191], a[40:43], v[76:91]
    ds_read_b64_tr_b16 v[180:181], v56 offset:24576
    ds_read_b64_tr_b16 v[182:183], v56 offset:25600
    v_mfma_f32_32x32x16_bf16 v[92:107], v[192:195], a[40:43], v[92:107]
    ds_read_b64_tr_b16 v[184:185], v57 offset:24576
    ds_read_b64_tr_b16 v[186:187], v57 offset:25600
    buffer_load_dwordx4 a[88:91], v68, s[12:15], s46 offen offset:2048 sc1
    s_waitcnt vmcnt(11) lgkmcnt(4)
    s_nop 0
    v_mfma_f32_32x32x16_bf16 v[76:91], v[196:199], a[44:47], v[76:91]
    ds_read_b64_tr_b16 v[188:189], v56 offset:26624
    ds_read_b64_tr_b16 v[190:191], v56 offset:27648
    v_mfma_f32_32x32x16_bf16 v[92:107], v[200:203], a[44:47], v[92:107]
    ds_read_b64_tr_b16 v[192:193], v57 offset:26624
    ds_read_b64_tr_b16 v[194:195], v57 offset:27648
    buffer_load_dwordx4 a[92:95], v68, s[12:15], s46 offen offset:3072 sc1
    s_waitcnt vmcnt(11) lgkmcnt(4)
    s_nop 0
    v_mfma_f32_32x32x16_bf16 v[76:91], v[180:183], a[48:51], v[76:91]
    ds_read_b64_tr_b16 v[196:197], v56 offset:28672
    ds_read_b64_tr_b16 v[198:199], v56 offset:29696
    v_mfma_f32_32x32x16_bf16 v[92:107], v[184:187], a[48:51], v[92:107]
    ds_read_b64_tr_b16 v[200:201], v57 offset:28672
    ds_read_b64_tr_b16 v[202:203], v57 offset:29696
    s_add_u32 s46, s46, 4096
    buffer_load_dwordx4 a[96:99], v68, s[12:15], s46 offen offset:0 sc1
    s_waitcnt vmcnt(11) lgkmcnt(4)
    s_nop 0
    v_mfma_f32_32x32x16_bf16 v[76:91], v[188:191], a[52:55], v[76:91]
    ds_read_b64_tr_b16 v[180:181], v56 offset:30720
    ds_read_b64_tr_b16 v[182:183], v56 offset:31744
    v_mfma_f32_32x32x16_bf16 v[92:107], v[192:195], a[52:55], v[92:107]
    ds_read_b64_tr_b16 v[184:185], v57 offset:30720
    ds_read_b64_tr_b16 v[186:187], v57 offset:31744
    buffer_load_dwordx4 a[100:103], v68, s[12:15], s46 offen offset:1024 sc1
    s_waitcnt vmcnt(11) lgkmcnt(4)
    s_nop 0
    v_mfma_f32_32x32x16_bf16 v[76:91], v[196:199], a[56:59], v[76:91]
    ds_read_b64_tr_b16 v[188:189], v56 offset:32768
    ds_read_b64_tr_b16 v[190:191], v56 offset:33792
    v_mfma_f32_32x32x16_bf16 v[92:107], v[200:203], a[56:59], v[92:107]
    ds_read_b64_tr_b16 v[192:193], v57 offset:32768
    ds_read_b64_tr_b16 v[194:195], v57 offset:33792
    buffer_load_dwordx4 a[104:107], v68, s[12:15], s46 offen offset:2048 sc1
    s_waitcnt vmcnt(11) lgkmcnt(4)
    s_nop 0
    v_mfma_f32_32x32x16_bf16 v[76:91], v[180:183], a[60:63], v[76:91]
    ds_read_b64_tr_b16 v[196:197], v56 offset:34816
    ds_read_b64_tr_b16 v[198:199], v56 offset:35840
    v_mfma_f32_32x32x16_bf16 v[92:107], v[184:187], a[60:63], v[92:107]
    ds_read_b64_tr_b16 v[200:201], v57 offset:34816
    ds_read_b64_tr_b16 v[202:203], v57 offset:35840
    buffer_load_dwordx4 a[108:111], v68, s[12:15], s46 offen offset:3072 sc1
    s_waitcnt vmcnt(11) lgkmcnt(4)
    s_nop 0
    v_mfma_f32_32x32x16_bf16 v[76:91], v[188:191], a[64:67], v[76:91]
    ds_read_b64_tr_b16 v[180:181], v56 offset:36864
    ds_read_b64_tr_b16 v[182:183], v56 offset:37888
    v_mfma_f32_32x32x16_bf16 v[92:107], v[192:195], a[64:67], v[92:107]
    ds_read_b64_tr_b16 v[184:185], v57 offset:36864
    ds_read_b64_tr_b16 v[186:187], v57 offset:37888
    s_add_u32 m0, s87, 40960
    s_add_u32 s33, s86, 1146880
    buffer_load_dwordx4 v15, s[24:27], s33 offen lds
    s_waitcnt vmcnt(11) lgkmcnt(4)
    s_nop 0
    v_mfma_f32_32x32x16_bf16 v[76:91], v[196:199], a[68:71], v[76:91]
    ds_read_b64_tr_b16 v[188:189], v56 offset:38912
    ds_read_b64_tr_b16 v[190:191], v56 offset:39936
    v_mfma_f32_32x32x16_bf16 v[92:107], v[200:203], a[68:71], v[92:107]
    ds_read_b64_tr_b16 v[192:193], v57 offset:38912
    ds_read_b64_tr_b16 v[194:195], v57 offset:39936
    s_waitcnt vmcnt(10) lgkmcnt(4)
    s_nop 0
    v_mfma_f32_32x32x16_bf16 v[76:91], v[180:183], a[72:75], v[76:91]
    ds_read_b64_tr_b16 v[196:197], v56 offset:40960
    ds_read_b64_tr_b16 v[198:199], v56 offset:41984
    v_mfma_f32_32x32x16_bf16 v[92:107], v[184:187], a[72:75], v[92:107]
    ds_read_b64_tr_b16 v[200:201], v57 offset:40960
    ds_read_b64_tr_b16 v[202:203], v57 offset:41984
    s_add_u32 m0, s92, 30720
    s_add_u32 s33, s86, 1146880
    s_mov_b32 exec_hi, 0xffff
    buffer_load_dwordx4 v16, s[24:27], s33 offen lds
    s_mov_b32 exec_hi, -1
    s_waitcnt vmcnt(10) lgkmcnt(4)
    v_mfma_f32_32x32x16_bf16 v[76:91], v[188:191], a[76:79], v[76:91]
    ds_read_b64_tr_b16 v[180:181], v56 offset:43008
    ds_read_b64_tr_b16 v[182:183], v56 offset:44032
    v_mfma_f32_32x32x16_bf16 v[92:107], v[192:195], a[76:79], v[92:107]
    ds_read_b64_tr_b16 v[184:185], v57 offset:43008
    ds_read_b64_tr_b16 v[186:187], v57 offset:44032
    s_waitcnt vmcnt(9) lgkmcnt(4)
    s_nop 0
    v_mfma_f32_32x32x16_bf16 v[76:91], v[196:199], a[80:83], v[76:91]
    ds_read_b64_tr_b16 v[188:189], v56 offset:45056
    ds_read_b64_tr_b16 v[190:191], v56 offset:46080
    v_mfma_f32_32x32x16_bf16 v[92:107], v[200:203], a[80:83], v[92:107]
    ds_read_b64_tr_b16 v[192:193], v57 offset:45056
    ds_read_b64_tr_b16 v[194:195], v57 offset:46080
    s_add_u32 m0, s87, 45056
    s_add_u32 s33, s86, 1261568
    buffer_load_dwordx4 v15, s[24:27], s33 offen lds
    s_waitcnt vmcnt(9) lgkmcnt(4)
    s_nop 0
    v_mfma_f32_32x32x16_bf16 v[76:91], v[180:183], a[84:87], v[76:91]
    ds_read_b64_tr_b16 v[196:197], v56 offset:47104
    ds_read_b64_tr_b16 v[198:199], v56 offset:48128
    v_mfma_f32_32x32x16_bf16 v[92:107], v[184:187], a[84:87], v[92:107]
    ds_read_b64_tr_b16 v[200:201], v57 offset:47104
    ds_read_b64_tr_b16 v[202:203], v57 offset:48128
    s_waitcnt vmcnt(8) lgkmcnt(4)
    s_nop 0
    v_mfma_f32_32x32x16_bf16 v[76:91], v[188:191], a[88:91], v[76:91]
    ds_read_b64_tr_b16 v[180:181], v56 offset:49152
    ds_read_b64_tr_b16 v[182:183], v56 offset:50176
    v_mfma_f32_32x32x16_bf16 v[92:107], v[192:195], a[88:91], v[92:107]
    ds_read_b64_tr_b16 v[184:185], v57 offset:49152
    ds_read_b64_tr_b16 v[186:187], v57 offset:50176
    s_add_u32 m0, s92, 33792
    s_add_u32 s33, s86, 1261568
    s_mov_b32 exec_hi, 0xffff
    buffer_load_dwordx4 v16, s[24:27], s33 offen lds
    s_mov_b32 exec_hi, -1
    s_waitcnt vmcnt(8) lgkmcnt(4)
    v_mfma_f32_32x32x16_bf16 v[76:91], v[196:199], a[92:95], v[76:91]
    ds_read_b64_tr_b16 v[188:189], v56 offset:51200
    ds_read_b64_tr_b16 v[190:191], v56 offset:52224
    v_mfma_f32_32x32x16_bf16 v[92:107], v[200:203], a[92:95], v[92:107]
    ds_read_b64_tr_b16 v[192:193], v57 offset:51200
    ds_read_b64_tr_b16 v[194:195], v57 offset:52224
    s_waitcnt vmcnt(7) lgkmcnt(4)
    s_nop 0
    v_mfma_f32_32x32x16_bf16 v[76:91], v[180:183], a[96:99], v[76:91]
    ds_read_b64_tr_b16 v[196:197], v56 offset:53248
    ds_read_b64_tr_b16 v[198:199], v56 offset:54272
    v_mfma_f32_32x32x16_bf16 v[92:107], v[184:187], a[96:99], v[92:107]
    ds_read_b64_tr_b16 v[200:201], v57 offset:53248
    ds_read_b64_tr_b16 v[202:203], v57 offset:54272
    s_add_u32 m0, s87, 49152
    s_add_u32 s33, s86, 1376256
    buffer_load_dwordx4 v15, s[24:27], s33 offen lds
    s_waitcnt vmcnt(7) lgkmcnt(4)
    s_nop 0
    v_mfma_f32_32x32x16_bf16 v[76:91], v[188:191], a[100:103], v[76:91]
    ds_read_b64_tr_b16 v[180:181], v56 offset:55296
    ds_read_b64_tr_b16 v[182:183], v56 offset:56320
    v_mfma_f32_32x32x16_bf16 v[92:107], v[192:195], a[100:103], v[92:107]
    ds_read_b64_tr_b16 v[184:185], v57 offset:55296
    ds_read_b64_tr_b16 v[186:187], v57 offset:56320
    s_waitcnt vmcnt(6) lgkmcnt(4)
    s_nop 0
    v_mfma_f32_32x32x16_bf16 v[76:91], v[196:199], a[104:107], v[76:91]
    v_mfma_f32_32x32x16_bf16 v[92:107], v[200:203], a[104:107], v[92:107]
    s_add_u32 m0, s92, 36864
    s_add_u32 s33, s86, 1376256
    s_mov_b32 exec_hi, 0xffff
    buffer_load_dwordx4 v16, s[24:27], s33 offen lds
    s_mov_b32 exec_hi, -1
    s_waitcnt vmcnt(6) lgkmcnt(0)
    v_mfma_f32_32x32x16_bf16 v[76:91], v[180:183], a[108:111], v[76:91]
    v_mfma_f32_32x32x16_bf16 v[92:107], v[184:187], a[108:111], v[92:107]
    s_nop 10
    s_nop 0
    v_cvt_pk_bf16_f32 v148, v76, v77
    v_cvt_pk_bf16_f32 v149, v78, v79
    v_cvt_pk_bf16_f32 v150, v80, v81
    v_cvt_pk_bf16_f32 v151, v82, v83
    v_cvt_pk_bf16_f32 v152, v84, v85
    v_cvt_pk_bf16_f32 v153, v86, v87
    v_cvt_pk_bf16_f32 v154, v88, v89
    v_cvt_pk_bf16_f32 v155, v90, v91
    buffer_store_dwordx4 v[148:151], v3, s[12:15], s47 offen offset:0 sc1
    buffer_store_dwordx4 v[152:155], v3, s[12:15], s47 offen offset:1024 sc1
    v_cvt_pk_bf16_f32 v156, v92, v93
    v_cvt_pk_bf16_f32 v157, v94, v95
    v_cvt_pk_bf16_f32 v158, v96, v97
    v_cvt_pk_bf16_f32 v159, v98, v99
    v_cvt_pk_bf16_f32 v160, v100, v101
    v_cvt_pk_bf16_f32 v161, v102, v103
    v_cvt_pk_bf16_f32 v162, v104, v105
    v_cvt_pk_bf16_f32 v163, v106, v107
    buffer_store_dwordx4 v[156:159], v3, s[12:15], s47 offen offset:2048 sc1
    buffer_store_dwordx4 v[160:163], v3, s[12:15], s47 offen offset:3072 sc1
    v_pk_add_f32 v[228:229], v[76:77], v[78:79]
    v_pk_mul_f32 v[230:231], v[76:77], v[76:77]
    v_pk_fma_f32 v[230:231], v[78:79], v[78:79], v[230:231]
    v_pk_add_f32 v[228:229], v[228:229], v[80:81]
    v_pk_fma_f32 v[230:231], v[80:81], v[80:81], v[230:231]
    v_pk_add_f32 v[228:229], v[228:229], v[82:83]
    v_pk_fma_f32 v[230:231], v[82:83], v[82:83], v[230:231]
    v_pk_add_f32 v[228:229], v[228:229], v[84:85]
    v_pk_fma_f32 v[230:231], v[84:85], v[84:85], v[230:231]
    v_pk_add_f32 v[228:229], v[228:229], v[86:87]
    v_pk_fma_f32 v[230:231], v[86:87], v[86:87], v[230:231]
    v_pk_add_f32 v[228:229], v[228:229], v[88:89]
    v_pk_fma_f32 v[230:231], v[88:89], v[88:89], v[230:231]
    v_pk_add_f32 v[228:229], v[228:229], v[90:91]
    v_pk_fma_f32 v[230:231], v[90:91], v[90:91], v[230:231]
    v_pk_add_f32 v[228:229], v[228:229], v[92:93]
    v_pk_fma_f32 v[230:231], v[92:93], v[92:93], v[230:231]
    v_pk_add_f32 v[228:229], v[228:229], v[94:95]
    v_pk_fma_f32 v[230:231], v[94:95], v[94:95], v[230:231]
    v_pk_add_f32 v[228:229], v[228:229], v[96:97]
    v_pk_fma_f32 v[230:231], v[96:97], v[96:97], v[230:231]
    v_pk_add_f32 v[228:229], v[228:229], v[98:99]
    v_pk_fma_f32 v[230:231], v[98:99], v[98:99], v[230:231]
    v_pk_add_f32 v[228:229], v[228:229], v[100:101]
    v_pk_fma_f32 v[230:231], v[100:101], v[100:101], v[230:231]
    v_pk_add_f32 v[228:229], v[228:229], v[102:103]
    v_pk_fma_f32 v[230:231], v[102:103], v[102:103], v[230:231]
    v_pk_add_f32 v[228:229], v[228:229], v[104:105]
    v_pk_fma_f32 v[230:231], v[104:105], v[104:105], v[230:231]
    v_pk_add_f32 v[228:229], v[228:229], v[106:107]
    v_pk_fma_f32 v[230:231], v[106:107], v[106:107], v[230:231]
    v_add_f32 v228, v228, v229
    v_add_f32 v229, v230, v231
    v_mov_b32 v230, v228
    v_mov_b32_e64 v231, v229
    s_nop 0
    v_permlane32_swap_b32 v228, v230
    v_permlane32_swap_b32 v229, v231
    v_pk_add_f32 v[228:229], v[228:229], v[230:231]
    buffer_store_dwordx2 v[228:229], v71, s[12:15], 0 offen sc1
    s_add_u32 m0, s87, 53248
    s_add_u32 s33, s86, 1490944
    buffer_load_dwordx4 v15, s[24:27], s33 offen lds
    s_add_u32 m0, s92, 39936
    s_add_u32 s33, s86, 1490944
    s_mov_b32 exec_hi, 0xffff
    buffer_load_dwordx4 v16, s[24:27], s33 offen lds
    s_mov_b32 exec_hi, -1
    s_mov_b32 s20, s66
    s_mov_b32 s21, s67
    s_mov_b32 s22, 0x62000
    s_mov_b32 s23, 0x00020000
    s_lshr_b32 s31, s29, 2
    s_lshl_b32 s31, s31, 7
    s_mul_i32 s88, s3, 7168
    s_add_u32 s88, s88, s31
    s_lshl_b32 s89, s3, 10
    s_add_u32 s89, s89, 100352
    s_waitcnt vmcnt(0)
    s_barrier
    s_cmp_lg_u32 s3, 0
    s_cbranch_scc1 .Lpub16
    s_lshl_b32 s31, s45, 7
    s_add_u32 s31, s31, 6389760
    v_mov_b32 v10, s30
    v_mov_b32_e64 v11, s31
    s_mov_b64 exec, 1
    buffer_store_dword v10, v11, s[12:15], 0 offen sc1
    s_mov_b64 exec, -1
.Lpub16:
    s_add_u32 m0, s89, 0
    s_add_u32 s33, s88, 0
    s_nop 0
    buffer_load_dwordx4 v14, s[20:23], s33 offen lds
    s_add_u32 m0, s89, 4096
    s_add_u32 s33, s88, 28672
    buffer_load_dwordx4 v14, s[20:23], s33 offen lds
    s_add_u32 m0, s89, 8192
    s_add_u32 s33, s88, 57344
    buffer_load_dwordx4 v14, s[20:23], s33 offen lds
    s_add_u32 m0, s89, 12288
    s_add_u32 s33, s88, 86016
    buffer_load_dwordx4 v14, s[20:23], s33 offen lds
    s_add_u32 m0, s89, 16384
    s_add_u32 s33, s88, 114688
    buffer_load_dwordx4 v14, s[20:23], s33 offen lds
    s_add_u32 m0, s89, 20480
    s_add_u32 s33, s88, 143360
    buffer_load_dwordx4 v14, s[20:23], s33 offen lds
    s_add_u32 m0, s89, 24576
    s_add_u32 s33, s88, 172032
    buffer_load_dwordx4 v14, s[20:23], s33 offen lds
    s_add_u32 m0, s89, 28672
    s_add_u32 s33, s88, 200704
    buffer_load_dwordx4 v14, s[20:23], s33 offen lds
    s_add_u32 m0, s89, 32768
    s_add_u32 s33, s88, 229376
    buffer_load_dwordx4 v14, s[20:23], s33 offen lds
    s_add_u32 m0, s89, 36864
    s_add_u32 s33, s88, 258048
    buffer_load_dwordx4 v14, s[20:23], s33 offen lds
    s_add_u32 m0, s89, 40960
    s_add_u32 s33, s88, 286720
    buffer_load_dwordx4 v14, s[20:23], s33 offen lds
    s_add_u32 m0, s89, 45056
    s_add_u32 s33, s88, 315392
    buffer_load_dwordx4 v14, s[20:23], s33 offen lds
    s_add_u32 m0, s89, 49152
    s_add_u32 s33, s88, 344064
    buffer_load_dwordx4 v14, s[20:23], s33 offen lds
    s_add_u32 m0, s89, 53248
    s_add_u32 s33, s88, 372736
    buffer_load_dwordx4 v14, s[20:23], s33 offen lds
    s_branch .Ls34
.LteamA2:
    s_cmp_ge_u32 s29, 30
    s_cbranch_scc1 .Lspare3
    s_sub_u32 s32, s29, 14
    s_and_b32 s31, s32, 3
    s_and_b32 s90, s28, 6
    s_lshl_b32 s90, s90, 1
    s_add_u32 s90, s90, s31
    s_lshr_b32 s91, s32, 2
    s_and_b32 s31, s28, 1
    s_lshl_b32 s31, s31, 2
    s_add_u32 s91, s91, s31
    s_add_u32 s37, s91, s90
    s_lshl_b32 s37, s37, 1
    s_mul_i32 s31, s37, 37
    s_lshr_b32 s31, s31, 8
    s_mul_i32 s31, s31, 7
    s_sub_u32 s37, s37, s31
    s_and_b32 s35, s3, 1
    s_lshl_b32 s38, s90, 4
    s_add_u32 s38, s38, s3
    s_mul_i32 s38, s38, 7168
    s_lshl_b32 s42, s3, 10
    v_lshrrev_b32_e64 v4, 3, v1
    v_mul_u32_u24 v4, 896, v4
    v_lshrrev_b32 v5, 4, v1
    s_lshl_b32 s31, s35, 2
    v_or_b32 v5, s31, v5
    v_and_b32 v6, 7, v1
    v_xor_b32_e64 v5, v5, v6
    v_lshl_add_u32 v18, v5, 4, v4
    s_waitcnt lgkmcnt(0)
    s_mov_b32 s4, s60
    s_mov_b32 s5, s61
    s_mov_b32 s6, 0x1c0000
    s_mov_b32 s7, 0x00020000
    s_add_u32 m0, s42, 100352
    s_lshl_b32 s39, s37, 7
    s_add_u32 s39, s39, s38
    s_nop 0
    buffer_load_dwordx4 v18, s[4:7], s39 offen lds
    s_add_u32 m0, s42, 104448
    s_add_u32 s39, s39, 28672
    buffer_load_dwordx4 v18, s[4:7], s39 offen lds
    s_add_u32 m0, s42, 108544
    s_add_u32 s39, s39, 28672
    buffer_load_dwordx4 v18, s[4:7], s39 offen lds
    s_add_u32 m0, s42, 112640
    s_add_u32 s39, s39, 28672
    buffer_load_dwordx4 v18, s[4:7], s39 offen lds
    v_mul_u32_u24 v4, 37, v1
    v_lshrrev_b32 v4, 8, v4
    v_mul_u32_u24 v5, 7, v4
    v_sub_u32 v5, v1, v5
    v_and_b32 v6, 3, v4
    v_lshrrev_b32 v4, 2, v4
    v_lshl_add_u32 v4, v6, 2, v4
    v_mul_u32_u24 v4, 2688, v4
    v_lshl_add_u32 v19, v5, 4, v4
    s_mov_b32 s8, s62
    s_mov_b32 s9, s63
    s_mov_b32 s10, 0x126000
    s_mov_b32 s11, 0x00020000
    s_mul_i32 s41, s3, 43008
    s_mul_i32 s31, s91, 112
    s_add_u32 s41, s41, s31
    s_mul_i32 s43, s3, 1792
    s_add_u32 s43, s43, 16384
    s_mov_b32 exec_hi, 0x00ffffff
    s_add_u32 m0, s43, 100352
    s_mul_i32 s40, s37, 172032
    s_add_u32 s40, s40, s41
    buffer_load_dwordx4 v19, s[8:11], s40 offen lds
    s_add_u32 m0, s43, 101248
    s_add_u32 s40, s40, 5376
    buffer_load_dwordx4 v19, s[8:11], s40 offen lds
    s_add_u32 m0, s43, 107520
    s_sub_u32 s40, s40, 4480
    buffer_load_dwordx4 v19, s[8:11], s40 offen lds
    s_add_u32 m0, s43, 108416
    s_add_u32 s40, s40, 5376
    buffer_load_dwordx4 v19, s[8:11], s40 offen lds
    s_add_u32 m0, s43, 114688
    s_sub_u32 s40, s40, 4480
    buffer_load_dwordx4 v19, s[8:11], s40 offen lds
    s_add_u32 m0, s43, 115584
    s_add_u32 s40, s40, 5376
    buffer_load_dwordx4 v19, s[8:11], s40 offen lds
    s_add_u32 s37, s37, 1
    s_cmp_eq_u32 s37, 7
    s_cselect_b32 s37, 0, s37
    s_mov_b32 exec_hi, -1
    v_lshlrev_b32 v3, 4, v1
    v_and_b32 v12, 31, v1
    v_lshrrev_b32_e64 v13, 5, v1
    s_mov_b32 s12, s82
    s_mov_b32 s13, s83
    s_mov_b32 s14, 0x3000000
    s_mov_b32 s15, 0x00020000
    s_lshr_b32 s36, s3, 1
    v_bfe_u32 v4, v1, 1, 3
    v_xor_b32 v4, v4, v13
    s_lshl_b32 s44, s90, 2
    s_lshl_b32 s31, s35, 1
    s_add_u32 s44, s44, s31
    s_lshl_b32 s31, s35, 13
    v_lshlrev_b32 v5, 7, v12
    v_add_u32 v5, s31, v5
    v_xor_b32_e64 v6, 0, v4
    v_lshl_add_u32 v52, v6, 4, v5
    v_xor_b32_e64 v6, 2, v4
    v_lshl_add_u32 v53, v6, 4, v5
    v_xor_b32_e64 v6, 4, v4
    v_lshl_add_u32 v54, v6, 4, v5
    v_xor_b32_e64 v6, 6, v4
    v_lshl_add_u32 v55, v6, 4, v5
    v_bfe_u32 v4, v1, 2, 2
    v_lshl_add_u32 v4, v4, 1, v13
    v_mul_u32_u24 v4, 224, v4
    v_add_u32 v4, 16384, v4
    v_bfe_u32 v5, v1, 4, 1
    v_lshlrev_b32 v5, 5, v5
    v_and_b32 v6, 3, v1
    v_lshl_add_u32 v5, v6, 3, v5
    s_mul_i32 s31, s36, 56
    v_add_u32 v6, s31, v5
    v_min_u32 v6, 104, v6
    v_add_u32_e64 v56, v4, v6
    v_add_u32 v57, 100352, v52
    v_add_u32 v58, 100352, v53
    v_add_u32 v59, 100352, v54
    v_add_u32 v60, 100352, v55
    v_add_u32 v61, 100352, v56
    v_bfe_u32 v4, v1, 2, 2
    v_lshl_add_u32 v4, v13, 2, v4
    v_mul_u32_u24 v4, 56, v4
    v_cmp_eq_u32 vcc, 56, v5
    v_mov_b32 v6, 4144
    s_mul_i32 s31, s36, 1568
    s_add_u32 s31, s31, 138240
    v_cndmask_b32_e64 v5, v5, v6, vcc
    v_add3_u32 v62, v4, v5, s31
    v_mov_b32 v4, 0
    v_lshlrev_b32 v5, 2, v0
    v_add_u32 v5, 157696, v5
    ds_write_b32 v5, v4
    s_lshl_b32 s31, s3, 2
    s_add_u32 s31, s31, 163824
    v_mov_b32 v5, s31
    ds_write_b32 v5, v4
    s_mov_b32 s31, 0
    v_lshrrev_b32 v4, 3, v1
    v_mul_u32_u24 v4, 896, v4
    v_bfe_u32 v5, v1, 4, 1
    v_lshlrev_b32 v5, 2, v5
    v_and_b32 v6, 7, v1
    v_xor_b32_e64 v5, v5, v6
    v_lshl_add_u32 v4, v5, 4, v4
    v_add_u32_e64 v14, s31, v4
    s_lshl_b32 s45, s91, 4
    s_add_u32 s45, s45, s90
    s_add_u32 s45, s45, 128
    s_lshl_b32 s46, s91, 1
    s_add_u32 s46, s46, s36
    s_lshl_b32 s31, s44, 12
    s_add_u32 s31, s31, 8650752
    v_add_u32 v63, s31, v3
    v_add_u32 v166, 4096, v63
    s_mul_i32 s31, s46, 224
    s_add_u32 s31, s31, 2228224
    v_lshl_add_u32 v167, v12, 3, s31
    s_mov_b32 s47, 7168
    s_mov_b32 s56, -1
    s_mov_b32 s57, 0
    s_mov_b32 s54, 0x0fffffff
    s_mov_b32 s55, 0
    v_bfe_u32 v4, v1, 2, 1
    v_cmp_eq_u32 vcc, v4, v13
    v_and_b32 v4, 1, v1
    v_lshlrev_b32 v4, 4, v4
    v_mov_b32 v5, 0x3f80
    v_lshlrev_b32 v5, v4, v5
    v_cndmask_b32 v5, 0, v5, vcc
    v_bfe_u32 v4, v1, 1, 1
    v_bfe_u32 v6, v1, 3, 2
    v_lshl_add_u32 v4, v6, 1, v4
    v_cmp_eq_u32 vcc, 0, v4
    s_nop 1
    v_cndmask_b32 v224, 0, v5, vcc
    v_cmp_eq_u32 vcc, 1, v4
    s_nop 1
    v_cndmask_b32 v225, 0, v5, vcc
    v_cmp_eq_u32 vcc, 2, v4
    s_nop 1
    v_cndmask_b32 v226, 0, v5, vcc
    v_cmp_eq_u32 vcc, 3, v4
    s_nop 1
    v_cndmask_b32 v227, 0, v5, vcc
    v_cmp_eq_u32 vcc, 4, v4
    s_nop 1
    v_cndmask_b32 v228, 0, v5, vcc
    v_cmp_eq_u32 vcc, 5, v4
    s_nop 1
    v_cndmask_b32 v229, 0, v5, vcc
    v_cmp_eq_u32 vcc, 6, v4
    s_nop 1
    v_cndmask_b32 v230, 0, v5, vcc
    v_cmp_eq_u32 vcc, 7, v4
    s_nop 1
    v_cndmask_b32 v231, 0, v5, vcc
    s_mov_b32 s24, s74
    s_mov_b32 s25, s75
    s_mov_b32 s26, 0x188000
    s_mov_b32 s27, 0x00020000
    s_and_b32 s31, s28, 1
    s_lshl_b32 s31, s31, 3
    s_and_b32 s32, s28, 6
    s_add_u32 s32, s32, s29
    s_and_b32 s32, s32, 7
    s_add_u32 s93, s32, s31
    s_mul_i32 s32, s93, 224
    v_lshrrev_b32_e64 v4, 3, v1
    v_mul_u32_u24 v4, 3584, v4
    v_bfe_u32 v5, v1, 4, 1
    v_lshlrev_b32 v5, 2, v5
    v_and_b32 v6, 7, v1
    v_xor_b32_e64 v5, v5, v6
    v_lshl_add_u32 v15, v5, 4, v4
    v_mul_u32_u24 v4, 43, v1
    v_lshrrev_b32 v4, 8, v4
    v_mul_u32_u24 v5, 6, v4
    v_sub_u32 v5, v1, v5
    v_lshrrev_b32 v6, 1, v4
    v_and_b32 v4, 1, v4
    v_lshl_add_u32 v4, v4, 2, v6
    v_mul_u32_u24 v4, 3584, v4
    v_lshl_add_u32 v4, v5, 4, v4
    v_add_u32 v16, 128, v4
    s_mul_i32 s86, s3, 28672
    s_add_u32 s86, s86, s32
    s_lshl_b32 s87, s3, 10
    s_mul_i32 s92, s3, 768
    s_add_u32 s92, s92, 57344
    s_add_u32 m0, s42, 0
    s_lshl_b32 s39, s37, 7
    s_add_u32 s39, s39, s38
    buffer_load_dwordx4 v18, s[4:7], s39 offen lds
    s_add_u32 m0, s43, 0
    s_mul_i32 s40, s37, 172032
    s_add_u32 s40, s40, s41
    s_mov_b32 exec_hi, 0x00ffffff
    buffer_load_dwordx4 v19, s[8:11], s40 offen lds
    s_mov_b32 exec_hi, -1
    s_add_u32 m0, s43, 896
    s_add_u32 s40, s40, 5376
    s_mov_b32 exec_hi, 0x00ffffff
    buffer_load_dwordx4 v19, s[8:11], s40 offen lds
    s_mov_b32 exec_hi, -1
    s_nop 0
    s_add_u32 m0, s42, 4096
    s_add_u32 s39, s39, 28672
    buffer_load_dwordx4 v18, s[4:7], s39 offen lds
    s_add_u32 m0, s43, 7168
    s_sub_u32 s40, s40, 4480
    s_mov_b32 exec_hi, 0x00ffffff
    buffer_load_dwordx4 v19, s[8:11], s40 offen lds
    s_mov_b32 exec_hi, -1
    s_waitcnt vmcnt(5)
    s_waitcnt lgkmcnt(0)
    s_barrier
    ds_read_b64_tr_b16 v[176:177], v61 offset:0
    ds_read_b64_tr_b16 v[178:179], v61 offset:112
    ds_read_b128 v[168:171], v57 offset:0
    ds_read_b128 v[172:175], v57 offset:4096
    ds_read_b64_tr_b16 v[180:181], v61 offset:7168
    ds_read_b64_tr_b16 v[182:183], v61 offset:7280
    ds_read_b64_tr_b16 v[184:185], v61 offset:14336
    ds_read_b64_tr_b16 v[186:187], v61 offset:14448
    s_waitcnt lgkmcnt(5)
    v_mfma_f32_32x32x16_bf16 v[64:79], v[176:179], v[168:171], 0
    s_add_u32 m0, s42, 8192
    s_add_u32 s39, s39, 28672
    buffer_load_dwordx4 v18, s[4:7], s39 offen lds
    s_waitcnt lgkmcnt(4)
    v_mfma_f32_32x32x16_bf16 v[80:95], v[176:179], v[172:175], 0
    ds_read_b64_tr_b16 v[196:197], v61 offset:1792
    ds_read_b64_tr_b16 v[198:199], v61 offset:1904
    ds_read_b128 v[188:191], v58 offset:0
    s_waitcnt lgkmcnt(5)
    v_mfma_f32_32x32x16_bf16 v[96:111], v[180:183], v[168:171], 0
    s_add_u32 m0, s43, 8064
    s_add_u32 s40, s40, 5376
    s_mov_b32 exec_hi, 0x00ffffff
    buffer_load_dwordx4 v19, s[8:11], s40 offen lds
    s_mov_b32 exec_hi, -1
    v_mfma_f32_32x32x16_bf16 v[112:127], v[180:183], v[172:175], 0
    ds_read_b128 v[192:195], v58 offset:4096
    ds_read_b64_tr_b16 v[200:201], v61 offset:8960
    ds_read_b64_tr_b16 v[202:203], v61 offset:9072
    s_waitcnt lgkmcnt(6)
    v_mfma_f32_32x32x16_bf16 v[128:143], v[168:171], v[184:187], 0
    s_add_u32 m0, s43, 14336
    s_sub_u32 s40, s40, 4480
    s_mov_b32 exec_hi, 0x00ffffff
    buffer_load_dwordx4 v19, s[8:11], s40 offen lds
    s_mov_b32 exec_hi, -1
    v_mfma_f32_32x32x16_bf16 v[144:159], v[172:175], v[184:187], 0
    ds_read_b64_tr_b16 v[204:205], v61 offset:16128
    ds_read_b64_tr_b16 v[206:207], v61 offset:16240
    s_waitcnt lgkmcnt(5)
    v_mfma_f32_32x32x16_bf16 v[64:79], v[196:199], v[188:191], v[64:79]
    s_add_u32 m0, s42, 12288
    s_add_u32 s39, s39, 28672
    buffer_load_dwordx4 v18, s[4:7], s39 offen lds
    s_waitcnt lgkmcnt(4)
    v_mfma_f32_32x32x16_bf16 v[80:95], v[196:199], v[192:195], v[80:95]
    ds_read_b64_tr_b16 v[176:177], v61 offset:3584
    ds_read_b64_tr_b16 v[178:179], v61 offset:3696
    ds_read_b128 v[168:171], v59 offset:0
    s_waitcnt lgkmcnt(5)
    v_mfma_f32_32x32x16_bf16 v[96:111], v[200:203], v[188:191], v[96:111]
    s_add_u32 m0, s43, 15232
    s_add_u32 s40, s40, 5376
    s_mov_b32 exec_hi, 0x00ffffff
    buffer_load_dwordx4 v19, s[8:11], s40 offen lds
    s_mov_b32 exec_hi, -1
    s_add_u32 s37, s37, 1
    s_cmp_eq_u32 s37, 7
    s_cselect_b32 s37, 0, s37
    v_mfma_f32_32x32x16_bf16 v[112:127], v[200:203], v[192:195], v[112:127]
    ds_read_b128 v[172:175], v59 offset:4096
    ds_read_b64_tr_b16 v[180:181], v61 offset:10752
    ds_read_b64_tr_b16 v[182:183], v61 offset:10864
    s_waitcnt lgkmcnt(6)
    v_mfma_f32_32x32x16_bf16 v[128:143], v[188:191], v[204:207], v[128:143]
    s_add_u32 m0, s42, 37888
    s_lshl_b32 s39, s37, 7
    s_add_u32 s39, s39, s38
    buffer_load_dwordx4 v18, s[4:7], s39 offen lds
    v_mfma_f32_32x32x16_bf16 v[144:159], v[192:195], v[204:207], v[144:159]
    ds_read_b64_tr_b16 v[184:185], v61 offset:17920
    ds_read_b64_tr_b16 v[186:187], v61 offset:18032
    s_waitcnt lgkmcnt(5)
    v_mfma_f32_32x32x16_bf16 v[64:79], v[176:179], v[168:171], v[64:79]
    s_add_u32 m0, s43, 37888
    s_mul_i32 s40, s37, 172032
    s_add_u32 s40, s40, s41
    s_mov_b32 exec_hi, 0x00ffffff
    buffer_load_dwordx4 v19, s[8:11], s40 offen lds
    s_mov_b32 exec_hi, -1
    s_waitcnt lgkmcnt(4)
    v_mfma_f32_32x32x16_bf16 v[80:95], v[176:179], v[172:175], v[80:95]
    ds_read_b64_tr_b16 v[196:197], v61 offset:5376
    ds_read_b64_tr_b16 v[198:199], v61 offset:5488
    ds_read_b128 v[188:191], v60 offset:0
    s_waitcnt lgkmcnt(5)
    v_mfma_f32_32x32x16_bf16 v[96:111], v[180:183], v[168:171], v[96:111]
    s_add_u32 m0, s43, 38784
    s_add_u32 s40, s40, 5376
    s_mov_b32 exec_hi, 0x00ffffff
    buffer_load_dwordx4 v19, s[8:11], s40 offen lds
    s_mov_b32 exec_hi, -1
    v_mfma_f32_32x32x16_bf16 v[112:127], v[180:183], v[172:175], v[112:127]
    ds_read_b128 v[192:195], v60 offset:4096
    ds_read_b64_tr_b16 v[200:201], v61 offset:12544
    ds_read_b64_tr_b16 v[202:203], v61 offset:12656
    s_waitcnt lgkmcnt(6)
    s_nop 0
    v_mfma_f32_32x32x16_bf16 v[128:143], v[168:171], v[184:187], v[128:143]
    s_add_u32 m0, s42, 41984
    s_add_u32 s39, s39, 28672
    buffer_load_dwordx4 v18, s[4:7], s39 offen lds
    v_mfma_f32_32x32x16_bf16 v[144:159], v[172:175], v[184:187], v[144:159]
    ds_read_b64_tr_b16 v[204:205], v61 offset:19712
    ds_read_b64_tr_b16 v[206:207], v61 offset:19824
    s_waitcnt lgkmcnt(5)
    v_mfma_f32_32x32x16_bf16 v[64:79], v[196:199], v[188:191], v[64:79]
    s_add_u32 m0, s43, 45056
    s_sub_u32 s40, s40, 4480
    s_mov_b32 exec_hi, 0x00ffffff
    buffer_load_dwordx4 v19, s[8:11], s40 offen lds
    s_mov_b32 exec_hi, -1
    s_waitcnt lgkmcnt(4)
    v_mfma_f32_32x32x16_bf16 v[80:95], v[196:199], v[192:195], v[80:95]
    s_waitcnt lgkmcnt(0)
    s_waitcnt vmcnt(5)
    s_barrier
    ds_read_b64_tr_b16 v[176:177], v56 offset:0
    ds_read_b64_tr_b16 v[178:179], v56 offset:112
    ds_read_b128 v[168:171], v52 offset:0
    v_mfma_f32_32x32x16_bf16 v[96:111], v[200:203], v[188:191], v[96:111]
    s_add_u32 m0, s42, 46080
    s_add_u32 s39, s39, 28672
    buffer_load_dwordx4 v18, s[4:7], s39 offen lds
    v_mfma_f32_32x32x16_bf16 v[112:127], v[200:203], v[192:195], v[112:127]
    ds_read_b128 v[172:175], v52 offset:4096
    ds_read_b64_tr_b16 v[180:181], v56 offset:7168
    ds_read_b64_tr_b16 v[182:183], v56 offset:7280
    v_mfma_f32_32x32x16_bf16 v[128:143], v[188:191], v[204:207], v[128:143]
    s_add_u32 m0, s43, 45952
    s_add_u32 s40, s40, 5376
    s_mov_b32 exec_hi, 0x00ffffff
    buffer_load_dwordx4 v19, s[8:11], s40 offen lds
    s_mov_b32 exec_hi, -1
    v_mfma_f32_32x32x16_bf16 v[144:159], v[192:195], v[204:207], v[144:159]
    ds_read_b64_tr_b16 v[184:185], v56 offset:14336
    ds_read_b64_tr_b16 v[186:187], v56 offset:14448
    s_waitcnt lgkmcnt(5)
    v_mfma_f32_32x32x16_bf16 v[64:79], v[176:179], v[168:171], v[64:79]
    s_add_u32 m0, s43, 52224
    s_sub_u32 s40, s40, 4480
    s_mov_b32 exec_hi, 0x00ffffff
    buffer_load_dwordx4 v19, s[8:11], s40 offen lds
    s_mov_b32 exec_hi, -1
    s_waitcnt lgkmcnt(4)
    v_mfma_f32_32x32x16_bf16 v[80:95], v[176:179], v[172:175], v[80:95]
    ds_read_b64_tr_b16 v[196:197], v56 offset:1792
    ds_read_b64_tr_b16 v[198:199], v56 offset:1904
    ds_read_b128 v[188:191], v53 offset:0
    s_waitcnt lgkmcnt(5)
    s_nop 0
    v_mfma_f32_32x32x16_bf16 v[96:111], v[180:183], v[168:171], v[96:111]
    s_add_u32 m0, s42, 50176
    s_add_u32 s39, s39, 28672
    buffer_load_dwordx4 v18, s[4:7], s39 offen lds
    v_mfma_f32_32x32x16_bf16 v[112:127], v[180:183], v[172:175], v[112:127]
    ds_read_b128 v[192:195], v53 offset:4096
    ds_read_b64_tr_b16 v[200:201], v56 offset:8960
    ds_read_b64_tr_b16 v[202:203], v56 offset:9072
    s_waitcnt lgkmcnt(6)
    v_mfma_f32_32x32x16_bf16 v[128:143], v[168:171], v[184:187], v[128:143]
    s_add_u32 m0, s43, 53120
    s_add_u32 s40, s40, 5376
    s_mov_b32 exec_hi, 0x00ffffff
    buffer_load_dwordx4 v19, s[8:11], s40 offen lds
    s_mov_b32 exec_hi, -1
    s_add_u32 s37, s37, 1
    s_cmp_eq_u32 s37, 7
    s_cselect_b32 s37, 0, s37
    v_mfma_f32_32x32x16_bf16 v[144:159], v[172:175], v[184:187], v[144:159]
    ds_read_b64_tr_b16 v[204:205], v56 offset:16128
    ds_read_b64_tr_b16 v[206:207], v56 offset:16240
    s_waitcnt lgkmcnt(5)
    v_mfma_f32_32x32x16_bf16 v[64:79], v[196:199], v[188:191], v[64:79]
    s_add_u32 m0, s42, 100352
    s_lshl_b32 s39, s37, 7
    s_add_u32 s39, s39, s38
    buffer_load_dwordx4 v18, s[4:7], s39 offen lds
    s_waitcnt lgkmcnt(4)
    v_mfma_f32_32x32x16_bf16 v[80:95], v[196:199], v[192:195], v[80:95]
    ds_read_b64_tr_b16 v[176:177], v56 offset:3584
    ds_read_b64_tr_b16 v[178:179], v56 offset:3696
    ds_read_b128 v[168:171], v54 offset:0
    s_waitcnt lgkmcnt(5)
    v_mfma_f32_32x32x16_bf16 v[96:111], v[200:203], v[188:191], v[96:111]
    s_add_u32 m0, s43, 100352
    s_mul_i32 s40, s37, 172032
    s_add_u32 s40, s40, s41
    s_mov_b32 exec_hi, 0x00ffffff
    buffer_load_dwordx4 v19, s[8:11], s40 offen lds
    s_mov_b32 exec_hi, -1
    v_mfma_f32_32x32x16_bf16 v[112:127], v[200:203], v[192:195], v[112:127]
    ds_read_b128 v[172:175], v54 offset:4096
    ds_read_b64_tr_b16 v[180:181], v56 offset:10752
    ds_read_b64_tr_b16 v[182:183], v56 offset:10864
    s_waitcnt lgkmcnt(6)
    v_mfma_f32_32x32x16_bf16 v[128:143], v[188:191], v[204:207], v[128:143]
    s_add_u32 m0, s43, 101248
    s_add_u32 s40, s40, 5376
    s_mov_b32 exec_hi, 0x00ffffff
    buffer_load_dwordx4 v19, s[8:11], s40 offen lds
    s_mov_b32 exec_hi, -1
    v_mfma_f32_32x32x16_bf16 v[144:159], v[192:195], v[204:207], v[144:159]
    ds_read_b64_tr_b16 v[184:185], v56 offset:17920
    ds_read_b64_tr_b16 v[186:187], v56 offset:18032
    s_waitcnt lgkmcnt(5)
    v_mfma_f32_32x32x16_bf16 v[64:79], v[176:179], v[168:171], v[64:79]
    s_add_u32 m0, s42, 104448
    s_add_u32 s39, s39, 28672
    buffer_load_dwordx4 v18, s[4:7], s39 offen lds
    s_waitcnt lgkmcnt(4)
    v_mfma_f32_32x32x16_bf16 v[80:95], v[176:179], v[172:175], v[80:95]
    ds_read_b64_tr_b16 v[196:197], v56 offset:5376
    ds_read_b64_tr_b16 v[198:199], v56 offset:5488
    ds_read_b128 v[188:191], v55 offset:0
    s_waitcnt lgkmcnt(5)
    v_mfma_f32_32x32x16_bf16 v[96:111], v[180:183], v[168:171], v[96:111]
    s_add_u32 m0, s43, 107520
    s_sub_u32 s40, s40, 4480
    s_mov_b32 exec_hi, 0x00ffffff
    buffer_load_dwordx4 v19, s[8:11], s40 offen lds
    s_mov_b32 exec_hi, -1
    v_mfma_f32_32x32x16_bf16 v[112:127], v[180:183], v[172:175], v[112:127]
    ds_read_b128 v[192:195], v55 offset:4096
    ds_read_b64_tr_b16 v[200:201], v56 offset:12544
    ds_read_b64_tr_b16 v[202:203], v56 offset:12656
    s_waitcnt lgkmcnt(6)
    s_nop 0
    v_mfma_f32_32x32x16_bf16 v[128:143], v[168:171], v[184:187], v[128:143]
    s_add_u32 m0, s42, 108544
    s_add_u32 s39, s39, 28672
    buffer_load_dwordx4 v18, s[4:7], s39 offen lds
    v_mfma_f32_32x32x16_bf16 v[144:159], v[172:175], v[184:187], v[144:159]
    ds_read_b64_tr_b16 v[204:205], v56 offset:19712
    ds_read_b64_tr_b16 v[206:207], v56 offset:19824
    s_waitcnt lgkmcnt(5)
    v_mfma_f32_32x32x16_bf16 v[64:79], v[196:199], v[188:191], v[64:79]
    s_add_u32 m0, s43, 108416
    s_add_u32 s40, s40, 5376
    s_mov_b32 exec_hi, 0x00ffffff
    buffer_load_dwordx4 v19, s[8:11], s40 offen lds
    s_mov_b32 exec_hi, -1
    s_waitcnt lgkmcnt(4)
    v_mfma_f32_32x32x16_bf16 v[80:95], v[196:199], v[192:195], v[80:95]
    s_waitcnt lgkmcnt(0)
    s_waitcnt vmcnt(7)
    s_barrier
    ds_read_b64_tr_b16 v[176:177], v56 offset:37888
    ds_read_b64_tr_b16 v[178:179], v56 offset:38000
    ds_read_b128 v[168:171], v52 offset:37888
    v_mfma_f32_32x32x16_bf16 v[96:111], v[200:203], v[188:191], v[96:111]
    s_add_u32 m0, s43, 114688
    s_sub_u32 s40, s40, 4480
    s_mov_b32 exec_hi, 0x00ffffff
    buffer_load_dwordx4 v19, s[8:11], s40 offen lds
    s_mov_b32 exec_hi, -1
    s_nop 0
    v_mfma_f32_32x32x16_bf16 v[112:127], v[200:203], v[192:195], v[112:127]
    ds_read_b128 v[172:175], v52 offset:41984
    ds_read_b64_tr_b16 v[180:181], v56 offset:45056
    ds_read_b64_tr_b16 v[182:183], v56 offset:45168
    v_mfma_f32_32x32x16_bf16 v[128:143], v[188:191], v[204:207], v[128:143]
    s_add_u32 m0, s42, 112640
    s_add_u32 s39, s39, 28672
    buffer_load_dwordx4 v18, s[4:7], s39 offen lds
    v_mfma_f32_32x32x16_bf16 v[144:159], v[192:195], v[204:207], v[144:159]
    ds_read_b64_tr_b16 v[184:185], v56 offset:52224
    ds_read_b64_tr_b16 v[186:187], v56 offset:52336
    s_waitcnt lgkmcnt(5)
    v_mfma_f32_32x32x16_bf16 v[64:79], v[176:179], v[168:171], v[64:79]
    s_add_u32 m0, s43, 115584
    s_add_u32 s40, s40, 5376
    s_mov_b32 exec_hi, 0x00ffffff
    buffer_load_dwordx4 v19, s[8:11], s40 offen lds
    s_mov_b32 exec_hi, -1
    s_add_u32 s37, s37, 1
    s_cmp_eq_u32 s37, 7
    s_cselect_b32 s37, 0, s37
    s_waitcnt lgkmcnt(4)
    v_mfma_f32_32x32x16_bf16 v[80:95], v[176:179], v[172:175], v[80:95]
    ds_read_b64_tr_b16 v[196:197], v56 offset:39680
    ds_read_b64_tr_b16 v[198:199], v56 offset:39792
    ds_read_b128 v[188:191], v53 offset:37888
    s_waitcnt lgkmcnt(5)
    v_mfma_f32_32x32x16_bf16 v[96:111], v[180:183], v[168:171], v[96:111]
    s_mov_b32 s16, s80
    s_mov_b32 s17, s81
    s_mov_b32 s18, 0x100
    s_mov_b32 s19, 0x00020000
    v_mov_b32 v11, 0
    buffer_load_dword v17, v11, s[16:19], 0 offen sc1
    v_mfma_f32_32x32x16_bf16 v[112:127], v[180:183], v[172:175], v[112:127]
    ds_read_b128 v[192:195], v53 offset:41984
    ds_read_b64_tr_b16 v[200:201], v56 offset:46848
    ds_read_b64_tr_b16 v[202:203], v56 offset:46960
    s_waitcnt lgkmcnt(6)
    v_mfma_f32_32x32x16_bf16 v[128:143], v[168:171], v[184:187], v[128:143]
    s_add_u32 m0, s42, 0
    s_lshl_b32 s39, s37, 7
    s_add_u32 s39, s39, s38
    buffer_load_dwordx4 v18, s[4:7], s39 offen lds
    v_mfma_f32_32x32x16_bf16 v[144:159], v[172:175], v[184:187], v[144:159]
    ds_read_b64_tr_b16 v[204:205], v56 offset:54016
    ds_read_b64_tr_b16 v[206:207], v56 offset:54128
    s_waitcnt lgkmcnt(5)
    v_mfma_f32_32x32x16_bf16 v[64:79], v[196:199], v[188:191], v[64:79]
    s_add_u32 m0, s43, 0
    s_mul_i32 s40, s37, 172032
    s_add_u32 s40, s40, s41
    s_mov_b32 exec_hi, 0x00ffffff
    buffer_load_dwordx4 v19, s[8:11], s40 offen lds
    s_mov_b32 exec_hi, -1
    s_waitcnt lgkmcnt(4)
    v_mfma_f32_32x32x16_bf16 v[80:95], v[196:199], v[192:195], v[80:95]
    ds_read_b64_tr_b16 v[176:177], v56 offset:41472
    ds_read_b64_tr_b16 v[178:179], v56 offset:41584
    ds_read_b128 v[168:171], v54 offset:37888
    s_waitcnt lgkmcnt(5)
    v_mfma_f32_32x32x16_bf16 v[96:111], v[200:203], v[188:191], v[96:111]
    s_add_u32 m0, s43, 896
    s_add_u32 s40, s40, 5376
    s_mov_b32 exec_hi, 0x00ffffff
    buffer_load_dwordx4 v19, s[8:11], s40 offen lds
    s_mov_b32 exec_hi, -1
    v_mfma_f32_32x32x16_bf16 v[112:127], v[200:203], v[192:195], v[112:127]
    ds_read_b128 v[172:175], v54 offset:41984
    ds_read_b64_tr_b16 v[180:181], v56 offset:48640
    ds_read_b64_tr_b16 v[182:183], v56 offset:48752
    s_waitcnt lgkmcnt(6)
    v_mfma_f32_32x32x16_bf16 v[128:143], v[188:191], v[204:207], v[128:143]
    s_add_u32 m0, s42, 4096
    s_add_u32 s39, s39, 28672
    buffer_load_dwordx4 v18, s[4:7], s39 offen lds
    v_mfma_f32_32x32x16_bf16 v[144:159], v[192:195], v[204:207], v[144:159]
    ds_read_b64_tr_b16 v[184:185], v56 offset:55808
    ds_read_b64_tr_b16 v[186:187], v56 offset:55920
    s_waitcnt lgkmcnt(5)
    v_mfma_f32_32x32x16_bf16 v[64:79], v[176:179], v[168:171], v[64:79]
    s_add_u32 m0, s43, 7168
    s_sub_u32 s40, s40, 4480
    s_mov_b32 exec_hi, 0x00ffffff
    buffer_load_dwordx4 v19, s[8:11], s40 offen lds
    s_mov_b32 exec_hi, -1
    s_waitcnt lgkmcnt(4)
    v_mfma_f32_32x32x16_bf16 v[80:95], v[176:179], v[172:175], v[80:95]
    ds_read_b64_tr_b16 v[196:197], v56 offset:43264
    ds_read_b64_tr_b16 v[198:199], v56 offset:43376
    ds_read_b128 v[188:191], v55 offset:37888
    s_waitcnt lgkmcnt(5)
    v_mfma_f32_32x32x16_bf16 v[96:111], v[180:183], v[168:171], v[96:111]
    s_add_u32 m0, s42, 8192
    s_add_u32 s39, s39, 28672
    buffer_load_dwordx4 v18, s[4:7], s39 offen lds
    v_mfma_f32_32x32x16_bf16 v[112:127], v[180:183], v[172:175], v[112:127]
    ds_read_b128 v[192:195], v55 offset:41984
    ds_read_b64_tr_b16 v[200:201], v56 offset:50432
    ds_read_b64_tr_b16 v[202:203], v56 offset:50544
    s_waitcnt lgkmcnt(6)
    v_mfma_f32_32x32x16_bf16 v[128:143], v[168:171], v[184:187], v[128:143]
    s_add_u32 m0, s43, 8064
    s_add_u32 s40, s40, 5376
    s_mov_b32 exec_hi, 0x00ffffff
    buffer_load_dwordx4 v19, s[8:11], s40 offen lds
    s_mov_b32 exec_hi, -1
    v_mfma_f32_32x32x16_bf16 v[144:159], v[172:175], v[184:187], v[144:159]
    ds_read_b64_tr_b16 v[204:205], v56 offset:57600
    ds_read_b64_tr_b16 v[206:207], v56 offset:57712
    s_waitcnt lgkmcnt(5)
    v_mfma_f32_32x32x16_bf16 v[64:79], v[196:199], v[188:191], v[64:79]
    s_add_u32 m0, s43, 14336
    s_sub_u32 s40, s40, 4480
    s_mov_b32 exec_hi, 0x00ffffff
    buffer_load_dwordx4 v19, s[8:11], s40 offen lds
    s_mov_b32 exec_hi, -1
    s_waitcnt lgkmcnt(4)
    v_mfma_f32_32x32x16_bf16 v[80:95], v[196:199], v[192:195], v[80:95]
    s_waitcnt lgkmcnt(0)
    s_waitcnt vmcnt(9)
    s_barrier
    ds_read_b64_tr_b16 v[176:177], v61 offset:0
    ds_read_b64_tr_b16 v[178:179], v61 offset:112
    ds_read_b128 v[168:171], v57 offset:0
    v_mfma_f32_32x32x16_bf16 v[96:111], v[200:203], v[188:191], v[96:111]
    s_add_u32 m0, s42, 12288
    s_add_u32 s39, s39, 28672
    buffer_load_dwordx4 v18, s[4:7], s39 offen lds
    v_mfma_f32_32x32x16_bf16 v[112:127], v[200:203], v[192:195], v[112:127]
    ds_read_b128 v[172:175], v57 offset:4096
    ds_read_b64_tr_b16 v[180:181], v61 offset:7168
    ds_read_b64_tr_b16 v[182:183], v61 offset:7280
    v_mfma_f32_32x32x16_bf16 v[128:143], v[188:191], v[204:207], v[128:143]
    s_add_u32 m0, s43, 15232
    s_add_u32 s40, s40, 5376
    s_mov_b32 exec_hi, 0x00ffffff
    buffer_load_dwordx4 v19, s[8:11], s40 offen lds
    s_mov_b32 exec_hi, -1
    s_add_u32 s37, s37, 1
    s_cmp_eq_u32 s37, 7
    s_cselect_b32 s37, 0, s37
    v_mfma_f32_32x32x16_bf16 v[144:159], v[192:195], v[204:207], v[144:159]
    ds_read_b64_tr_b16 v[184:185], v61 offset:14336
    ds_read_b64_tr_b16 v[186:187], v61 offset:14448
    s_waitcnt lgkmcnt(5)
    v_mfma_f32_32x32x16_bf16 v[64:79], v[176:179], v[168:171], v[64:79]
    s_mov_b32 s20, s64
    s_mov_b32 s21, s65
    s_mov_b32 s22, 0x6200
    s_mov_b32 s23, 0x00020000
    s_mul_i32 s33, s91, 3136
    s_add_u32 s33, s33, s42
    s_add_u32 m0, s42, 138240
    s_nop 0
    buffer_load_dwordx4 v3, s[20:23], s33 offen lds
    s_waitcnt lgkmcnt(4)
    v_mfma_f32_32x32x16_bf16 v[80:95], v[176:179], v[172:175], v[80:95]
    ds_read_b64_tr_b16 v[196:197], v61 offset:1792
    ds_read_b64_tr_b16 v[198:199], v61 offset:1904
    ds_read_b128 v[188:191], v58 offset:0
    s_waitcnt lgkmcnt(5)
    v_mfma_f32_32x32x16_bf16 v[96:111], v[180:183], v[168:171], v[96:111]
    s_mul_i32 s33, s91, 3136
    s_add_u32 s33, s33, s42
    s_add_u32 m0, s42, 142336
    s_add_u32 s33, s33, 4
    buffer_load_dwordx4 v3, s[20:23], s33 offen lds
    v_mfma_f32_32x32x16_bf16 v[112:127], v[180:183], v[172:175], v[112:127]
    ds_read_b128 v[192:195], v58 offset:4096
    ds_read_b64_tr_b16 v[200:201], v61 offset:8960
    ds_read_b64_tr_b16 v[202:203], v61 offset:9072
    s_waitcnt lgkmcnt(6)
    v_mfma_f32_32x32x16_bf16 v[128:143], v[168:171], v[184:187], v[128:143]
    s_add_u32 m0, s42, 37888
    s_lshl_b32 s39, s37, 7
    s_add_u32 s39, s39, s38
    buffer_load_dwordx4 v18, s[4:7], s39 offen lds
    v_mfma_f32_32x32x16_bf16 v[144:159], v[172:175], v[184:187], v[144:159]
    ds_read_b64_tr_b16 v[204:205], v61 offset:16128
    ds_read_b64_tr_b16 v[206:207], v61 offset:16240
    s_waitcnt lgkmcnt(5)
    v_mfma_f32_32x32x16_bf16 v[64:79], v[196:199], v[188:191], v[64:79]
    s_add_u32 m0, s43, 37888
    s_mul_i32 s40, s37, 172032
    s_add_u32 s40, s40, s41
    s_mov_b32 exec_hi, 0x00ffffff
    buffer_load_dwordx4 v19, s[8:11], s40 offen lds
    s_mov_b32 exec_hi, -1
    s_waitcnt lgkmcnt(4)
    v_mfma_f32_32x32x16_bf16 v[80:95], v[196:199], v[192:195], v[80:95]
    ds_read_b64_tr_b16 v[176:177], v61 offset:3584
    ds_read_b64_tr_b16 v[178:179], v61 offset:3696
    ds_read_b128 v[168:171], v59 offset:0
    s_waitcnt lgkmcnt(5)
    v_mfma_f32_32x32x16_bf16 v[96:111], v[200:203], v[188:191], v[96:111]
    s_add_u32 m0, s43, 38784
    s_add_u32 s40, s40, 5376
    s_mov_b32 exec_hi, 0x00ffffff
    buffer_load_dwordx4 v19, s[8:11], s40 offen lds
    s_mov_b32 exec_hi, -1
    v_mfma_f32_32x32x16_bf16 v[112:127], v[200:203], v[192:195], v[112:127]
    ds_read_b128 v[172:175], v59 offset:4096
    ds_read_b64_tr_b16 v[180:181], v61 offset:10752
    ds_read_b64_tr_b16 v[182:183], v61 offset:10864
    s_waitcnt lgkmcnt(6)
    s_nop 0
    v_mfma_f32_32x32x16_bf16 v[128:143], v[188:191], v[204:207], v[128:143]
    s_add_u32 m0, s42, 41984
    s_add_u32 s39, s39, 28672
    buffer_load_dwordx4 v18, s[4:7], s39 offen lds
    v_mfma_f32_32x32x16_bf16 v[144:159], v[192:195], v[204:207], v[144:159]
    ds_read_b64_tr_b16 v[184:185], v61 offset:17920
    ds_read_b64_tr_b16 v[186:187], v61 offset:18032
    s_waitcnt lgkmcnt(5)
    v_mfma_f32_32x32x16_bf16 v[64:79], v[176:179], v[168:171], v[64:79]
    s_add_u32 m0, s43, 45056
    s_sub_u32 s40, s40, 4480
    s_mov_b32 exec_hi, 0x00ffffff
    buffer_load_dwordx4 v19, s[8:11], s40 offen lds
    s_mov_b32 exec_hi, -1
    s_waitcnt lgkmcnt(4)
    v_mfma_f32_32x32x16_bf16 v[80:95], v[176:179], v[172:175], v[80:95]
    ds_read_b64_tr_b16 v[196:197], v61 offset:5376
    ds_read_b64_tr_b16 v[198:199], v61 offset:5488
    ds_read_b128 v[188:191], v60 offset:0
    s_waitcnt lgkmcnt(5)
    v_mfma_f32_32x32x16_bf16 v[96:111], v[180:183], v[168:171], v[96:111]
    s_add_u32 m0, s42, 46080
    s_add_u32 s39, s39, 28672
    buffer_load_dwordx4 v18, s[4:7], s39 offen lds
    v_mfma_f32_32x32x16_bf16 v[112:127], v[180:183], v[172:175], v[112:127]
    ds_read_b128 v[192:195], v60 offset:4096
    ds_read_b64_tr_b16 v[200:201], v61 offset:12544
    ds_read_b64_tr_b16 v[202:203], v61 offset:12656
    s_waitcnt lgkmcnt(6)
    v_mfma_f32_32x32x16_bf16 v[128:143], v[168:171], v[184:187], v[128:143]
    s_add_u32 m0, s43, 45952
    s_add_u32 s40, s40, 5376
    s_mov_b32 exec_hi, 0x00ffffff
    buffer_load_dwordx4 v19, s[8:11], s40 offen lds
    s_mov_b32 exec_hi, -1
    v_mfma_f32_32x32x16_bf16 v[144:159], v[172:175], v[184:187], v[144:159]
    ds_read_b64_tr_b16 v[204:205], v61 offset:19712
    ds_read_b64_tr_b16 v[206:207], v61 offset:19824
    s_waitcnt lgkmcnt(5)
    v_mfma_f32_32x32x16_bf16 v[64:79], v[196:199], v[188:191], v[64:79]
    s_add_u32 m0, s43, 52224
    s_sub_u32 s40, s40, 4480
    s_mov_b32 exec_hi, 0x00ffffff
    buffer_load_dwordx4 v19, s[8:11], s40 offen lds
    s_mov_b32 exec_hi, -1
    s_waitcnt lgkmcnt(4)
    v_mfma_f32_32x32x16_bf16 v[80:95], v[196:199], v[192:195], v[80:95]
    s_waitcnt lgkmcnt(0)
    s_waitcnt vmcnt(10)
    s_barrier
    ds_read_b64_tr_b16 v[176:177], v56 offset:0
    ds_read_b64_tr_b16 v[178:179], v56 offset:112
    ds_read_b128 v[168:171], v52 offset:0
    v_mfma_f32_32x32x16_bf16 v[96:111], v[200:203], v[188:191], v[96:111]
    s_add_u32 m0, s42, 50176
    s_add_u32 s39, s39, 28672
    buffer_load_dwordx4 v18, s[4:7], s39 offen lds
    v_mfma_f32_32x32x16_bf16 v[112:127], v[200:203], v[192:195], v[112:127]
    ds_read_b128 v[172:175], v52 offset:4096
    ds_read_b64_tr_b16 v[180:181], v56 offset:7168
    ds_read_b64_tr_b16 v[182:183], v56 offset:7280
    v_mfma_f32_32x32x16_bf16 v[128:143], v[188:191], v[204:207], v[128:143]
    s_add_u32 m0, s43, 53120
    s_add_u32 s40, s40, 5376
    s_mov_b32 exec_hi, 0x00ffffff
    buffer_load_dwordx4 v19, s[8:11], s40 offen lds
    s_mov_b32 exec_hi, -1
    s_add_u32 s37, s37, 1
    s_cmp_eq_u32 s37, 7
    s_cselect_b32 s37, 0, s37
    v_mfma_f32_32x32x16_bf16 v[144:159], v[192:195], v[204:207], v[144:159]
    ds_read_b64_tr_b16 v[184:185], v56 offset:14336
    ds_read_b64_tr_b16 v[186:187], v56 offset:14448
    s_waitcnt lgkmcnt(5)
    v_mfma_f32_32x32x16_bf16 v[64:79], v[176:179], v[168:171], v[64:79]
    buffer_load_dwordx4 v[20:23], v63, s[12:15], 0 offen offset:0 sc1
    buffer_load_dwordx4 v[24:27], v63, s[12:15], 0 offen offset:1024 sc1
    buffer_load_dwordx4 v[28:31], v63, s[12:15], 0 offen offset:2048 sc1
    buffer_load_dwordx4 v[32:35], v63, s[12:15], 0 offen offset:3072 sc1
    s_waitcnt lgkmcnt(4)
    v_mfma_f32_32x32x16_bf16 v[80:95], v[176:179], v[172:175], v[80:95]
    ds_read_b64_tr_b16 v[196:197], v56 offset:1792
    ds_read_b64_tr_b16 v[198:199], v56 offset:1904
    ds_read_b128 v[188:191], v53 offset:0
    s_waitcnt lgkmcnt(5)
    s_nop 0
    v_mfma_f32_32x32x16_bf16 v[96:111], v[180:183], v[168:171], v[96:111]
    buffer_load_dwordx4 v[36:39], v166, s[12:15], 0 offen offset:0 sc1
    buffer_load_dwordx4 v[40:43], v166, s[12:15], 0 offen offset:1024 sc1
    buffer_load_dwordx4 v[44:47], v166, s[12:15], 0 offen offset:2048 sc1
    buffer_load_dwordx4 v[48:51], v166, s[12:15], 0 offen offset:3072 sc1
    v_mfma_f32_32x32x16_bf16 v[112:127], v[180:183], v[172:175], v[112:127]
    ds_read_b128 v[192:195], v53 offset:4096
    ds_read_b64_tr_b16 v[200:201], v56 offset:8960
    ds_read_b64_tr_b16 v[202:203], v56 offset:9072
    s_waitcnt lgkmcnt(6)
    v_mfma_f32_32x32x16_bf16 v[128:143], v[168:171], v[184:187], v[128:143]
    s_add_u32 m0, s42, 100352
    s_lshl_b32 s39, s37, 7
    s_add_u32 s39, s39, s38
    buffer_load_dwordx4 v18, s[4:7], s39 offen lds
    v_mfma_f32_32x32x16_bf16 v[144:159], v[172:175], v[184:187], v[144:159]
    ds_read_b64_tr_b16 v[204:205], v56 offset:16128
    ds_read_b64_tr_b16 v[206:207], v56 offset:16240
    s_waitcnt lgkmcnt(5)
    v_mfma_f32_32x32x16_bf16 v[64:79], v[196:199], v[188:191], v[64:79]
    s_add_u32 m0, s43, 100352
    s_mul_i32 s40, s37, 172032
    s_add_u32 s40, s40, s41
    s_mov_b32 exec_hi, 0x00ffffff
    buffer_load_dwordx4 v19, s[8:11], s40 offen lds
    s_mov_b32 exec_hi, -1
    s_waitcnt lgkmcnt(4)
    v_mfma_f32_32x32x16_bf16 v[80:95], v[196:199], v[192:195], v[80:95]
    ds_read_b64_tr_b16 v[176:177], v56 offset:3584
    ds_read_b64_tr_b16 v[178:179], v56 offset:3696
    ds_read_b128 v[168:171], v54 offset:0
    s_waitcnt lgkmcnt(5)
    v_mfma_f32_32x32x16_bf16 v[96:111], v[200:203], v[188:191], v[96:111]
    s_add_u32 m0, s43, 101248
    s_add_u32 s40, s40, 5376
    s_mov_b32 exec_hi, 0x00ffffff
    buffer_load_dwordx4 v19, s[8:11], s40 offen lds
    s_mov_b32 exec_hi, -1
    v_mfma_f32_32x32x16_bf16 v[112:127], v[200:203], v[192:195], v[112:127]
    ds_read_b128 v[172:175], v54 offset:4096
    ds_read_b64_tr_b16 v[180:181], v56 offset:10752
    ds_read_b64_tr_b16 v[182:183], v56 offset:10864
    s_waitcnt lgkmcnt(6)
    v_mfma_f32_32x32x16_bf16 v[128:143], v[188:191], v[204:207], v[128:143]
    s_add_u32 m0, s42, 104448
    s_add_u32 s39, s39, 28672
    buffer_load_dwordx4 v18, s[4:7], s39 offen lds
    v_mfma_f32_32x32x16_bf16 v[144:159], v[192:195], v[204:207], v[144:159]
    ds_read_b64_tr_b16 v[184:185], v56 offset:17920
    ds_read_b64_tr_b16 v[186:187], v56 offset:18032
    s_waitcnt lgkmcnt(5)
    v_mfma_f32_32x32x16_bf16 v[64:79], v[176:179], v[168:171], v[64:79]
    s_add_u32 m0, s43, 107520
    s_sub_u32 s40, s40, 4480
    s_mov_b32 exec_hi, 0x00ffffff
    buffer_load_dwordx4 v19, s[8:11], s40 offen lds
    s_mov_b32 exec_hi, -1
    s_waitcnt lgkmcnt(4)
    v_mfma_f32_32x32x16_bf16 v[80:95], v[176:179], v[172:175], v[80:95]
    ds_read_b64_tr_b16 v[196:197], v56 offset:5376
    ds_read_b64_tr_b16 v[198:199], v56 offset:5488
    ds_read_b128 v[188:191], v55 offset:0
    s_waitcnt lgkmcnt(5)
    v_mfma_f32_32x32x16_bf16 v[96:111], v[180:183], v[168:171], v[96:111]
    s_add_u32 m0, s42, 108544
    s_add_u32 s39, s39, 28672
    buffer_load_dwordx4 v18, s[4:7], s39 offen lds
    v_mfma_f32_32x32x16_bf16 v[112:127], v[180:183], v[172:175], v[112:127]
    ds_read_b128 v[192:195], v55 offset:4096
    ds_read_b64_tr_b16 v[200:201], v56 offset:12544
    ds_read_b64_tr_b16 v[202:203], v56 offset:12656
    s_waitcnt lgkmcnt(6)
    v_mfma_f32_32x32x16_bf16 v[128:143], v[168:171], v[184:187], v[128:143]
    s_add_u32 m0, s43, 108416
    s_add_u32 s40, s40, 5376
    s_mov_b32 exec_hi, 0x00ffffff
    buffer_load_dwordx4 v19, s[8:11], s40 offen lds
    s_mov_b32 exec_hi, -1
    v_mfma_f32_32x32x16_bf16 v[144:159], v[172:175], v[184:187], v[144:159]
    ds_read_b64_tr_b16 v[204:205], v56 offset:19712
    ds_read_b64_tr_b16 v[206:207], v56 offset:19824
    s_waitcnt lgkmcnt(5)
    v_mfma_f32_32x32x16_bf16 v[64:79], v[196:199], v[188:191], v[64:79]
    s_add_u32 m0, s43, 114688
    s_sub_u32 s40, s40, 4480
    s_mov_b32 exec_hi, 0x00ffffff
    buffer_load_dwordx4 v19, s[8:11], s40 offen lds
    s_mov_b32 exec_hi, -1
    s_waitcnt lgkmcnt(4)
    v_mfma_f32_32x32x16_bf16 v[80:95], v[196:199], v[192:195], v[80:95]
    s_waitcnt lgkmcnt(0)
    s_waitcnt vmcnt(16)
    s_barrier
    ds_read_b64_tr_b16 v[176:177], v56 offset:37888
    ds_read_b64_tr_b16 v[178:179], v56 offset:38000
    ds_read_b128 v[168:171], v52 offset:37888
    v_mfma_f32_32x32x16_bf16 v[96:111], v[200:203], v[188:191], v[96:111]
    s_add_u32 m0, s42, 112640
    s_add_u32 s39, s39, 28672
    buffer_load_dwordx4 v18, s[4:7], s39 offen lds
    v_mfma_f32_32x32x16_bf16 v[112:127], v[200:203], v[192:195], v[112:127]
    ds_read_b128 v[172:175], v52 offset:41984
    ds_read_b64_tr_b16 v[180:181], v56 offset:45056
    ds_read_b64_tr_b16 v[182:183], v56 offset:45168
    v_mfma_f32_32x32x16_bf16 v[128:143], v[188:191], v[204:207], v[128:143]
    s_add_u32 m0, s43, 115584
    s_add_u32 s40, s40, 5376
    s_mov_b32 exec_hi, 0x00ffffff
    buffer_load_dwordx4 v19, s[8:11], s40 offen lds
    s_mov_b32 exec_hi, -1
    s_add_u32 s37, s37, 1
    s_cmp_eq_u32 s37, 7
    s_cselect_b32 s37, 0, s37
    v_mfma_f32_32x32x16_bf16 v[144:159], v[192:195], v[204:207], v[144:159]
    ds_read_b64_tr_b16 v[184:185], v56 offset:52224
    ds_read_b64_tr_b16 v[186:187], v56 offset:52336
    s_waitcnt lgkmcnt(5)
    v_mfma_f32_32x32x16_bf16 v[64:79], v[176:179], v[168:171], v[64:79]
    v_readfirstlane_b32 s30, v17
    s_nop 1
    s_cmp_lg_u32 s30, 0
    s_cbranch_scc1 .Lnonce17
    v_mov_b32 v11, 0
    s_waitcnt vmcnt(0) lgkmcnt(0)
    s_mov_b32 s34, 0
.Lspin18:
    buffer_load_dword v17, v11, s[16:19], 0 offen sc1
    s_add_u32 s34, s34, 1
    s_waitcnt vmcnt(0)
    v_cmp_eq_u32_e64 vcc, 0, v17
    s_cmp_ge_u32 s34, 200000
    s_cbranch_scc1 .Lspun19
    s_cbranch_vccnz .Lspin18
.Lspun19:
    s_nop 1
    v_readfirstlane_b32 s30, v17
    s_nop 3
.Lnonce17:
    s_waitcnt lgkmcnt(4)
    v_mfma_f32_32x32x16_bf16 v[80:95], v[176:179], v[172:175], v[80:95]
    ds_read_b64_tr_b16 v[196:197], v56 offset:39680
    ds_read_b64_tr_b16 v[198:199], v56 offset:39792
    ds_read_b128 v[188:191], v53 offset:37888
    s_waitcnt lgkmcnt(5)
    s_nop 0
    v_mfma_f32_32x32x16_bf16 v[96:111], v[180:183], v[168:171], v[96:111]
    s_add_u32 m0, s87, 24576
    s_add_u32 s33, s86, 688128
    buffer_load_dwordx4 v15, s[24:27], s33 offen lds
    v_mfma_f32_32x32x16_bf16 v[112:127], v[180:183], v[172:175], v[112:127]
    ds_read_b128 v[192:195], v53 offset:41984
    ds_read_b64_tr_b16 v[200:201], v56 offset:46848
    ds_read_b64_tr_b16 v[202:203], v56 offset:46960
    s_waitcnt lgkmcnt(6)
    v_mfma_f32_32x32x16_bf16 v[128:143], v[168:171], v[184:187], v[128:143]
    s_add_u32 m0, s92, 18432
    s_add_u32 s33, s86, 688128
    s_mov_b32 exec_hi, 0xffff
    buffer_load_dwordx4 v16, s[24:27], s33 offen lds
    s_mov_b32 exec_hi, -1
    v_mfma_f32_32x32x16_bf16 v[144:159], v[172:175], v[184:187], v[144:159]
    ds_read_b64_tr_b16 v[204:205], v56 offset:54016
    ds_read_b64_tr_b16 v[206:207], v56 offset:54128
    s_waitcnt vmcnt(16)
    v_cndmask_b32 v33, v21, v33, s[56:57]
    v_cndmask_b32 v35, v21, v35, s[56:57]
    v_xor_b32 v4, s30, v21
    v_xor_b32 v5, s30, v23
    v_or_b32 v4, v4, v5
    v_xor_b32 v5, s30, v25
    v_or_b32 v4, v4, v5
    v_xor_b32 v5, s30, v27
    v_or_b32 v4, v4, v5
    v_xor_b32 v5, s30, v29
    v_or_b32 v4, v4, v5
    v_xor_b32 v5, s30, v31
    v_or_b32 v4, v4, v5
    v_xor_b32 v5, s30, v33
    v_or_b32 v4, v4, v5
    v_xor_b32 v5, s30, v35
    v_or_b32_e64 v4, v4, v5
    s_waitcnt vmcnt(12)
    v_cndmask_b32 v49, v37, v49, s[56:57]
    v_cndmask_b32 v51, v37, v51, s[56:57]
    v_xor_b32 v5, s30, v37
    v_or_b32 v4, v4, v5
    v_xor_b32 v5, s30, v39
    v_or_b32 v4, v4, v5
    v_xor_b32 v5, s30, v41
    v_or_b32 v4, v4, v5
    v_xor_b32 v5, s30, v43
    v_or_b32 v4, v4, v5
    v_xor_b32 v5, s30, v45
    v_or_b32 v4, v4, v5
    v_xor_b32 v5, s30, v47
    v_or_b32 v4, v4, v5
    v_xor_b32 v5, s30, v49
    v_or_b32 v4, v4, v5
    v_xor_b32 v5, s30, v51
    v_or_b32 v4, v4, v5
    v_cmp_ne_u32_e64 vcc, 0, v4
    s_nop 1
    s_cbranch_vccz .Lstok20
    s_waitcnt vmcnt(0) lgkmcnt(0)
    s_mov_b32 s34, 0
.Lspin21:
    buffer_load_dwordx4 v[20:23], v63, s[12:15], 0 offen offset:0 sc1
    buffer_load_dwordx4 v[24:27], v63, s[12:15], 0 offen offset:1024 sc1
    buffer_load_dwordx4 v[28:31], v63, s[12:15], 0 offen offset:2048 sc1
    buffer_load_dwordx4 v[32:35], v63, s[12:15], 0 offen offset:3072 sc1
    buffer_load_dwordx4 v[36:39], v166, s[12:15], 0 offen offset:0 sc1
    buffer_load_dwordx4 v[40:43], v166, s[12:15], 0 offen offset:1024 sc1
    buffer_load_dwordx4 v[44:47], v166, s[12:15], 0 offen offset:2048 sc1
    buffer_load_dwordx4 v[48:51], v166, s[12:15], 0 offen offset:3072 sc1
    s_add_u32 s34, s34, 1
    s_waitcnt vmcnt(0)
    v_cndmask_b32 v33, v21, v33, s[56:57]
    v_cndmask_b32 v35, v21, v35, s[56:57]
    v_xor_b32 v4, s30, v21
    v_xor_b32 v5, s30, v23
    v_or_b32 v4, v4, v5
    v_xor_b32 v5, s30, v25
    v_or_b32 v4, v4, v5
    v_xor_b32 v5, s30, v27
    v_or_b32 v4, v4, v5
    v_xor_b32 v5, s30, v29
    v_or_b32 v4, v4, v5
    v_xor_b32 v5, s30, v31
    v_or_b32 v4, v4, v5
    v_xor_b32 v5, s30, v33
    v_or_b32 v4, v4, v5
    v_xor_b32 v5, s30, v35
    v_or_b32_e64 v4, v4, v5
    v_cndmask_b32 v49, v37, v49, s[56:57]
    v_cndmask_b32 v51, v37, v51, s[56:57]
    v_xor_b32 v5, s30, v37
    v_or_b32 v4, v4, v5
    v_xor_b32 v5, s30, v39
    v_or_b32 v4, v4, v5
    v_xor_b32 v5, s30, v41
    v_or_b32 v4, v4, v5
    v_xor_b32 v5, s30, v43
    v_or_b32 v4, v4, v5
    v_xor_b32 v5, s30, v45
    v_or_b32 v4, v4, v5
    v_xor_b32 v5, s30, v47
    v_or_b32 v4, v4, v5
    v_xor_b32 v5, s30, v49
    v_or_b32 v4, v4, v5
    v_xor_b32 v5, s30, v51
    v_or_b32 v4, v4, v5
    v_cmp_ne_u32_e64 vcc, 0, v4
    s_cmp_ge_u32 s34, 200000
    s_cbranch_scc1 .Lspun22
    s_cbranch_vccnz .Lspin21
.Lspun22:
    s_nop 1
.Lstok20:
    s_waitcnt lgkmcnt(5)
    v_mfma_f32_32x32x16_bf16 v[64:79], v[196:199], v[188:191], v[64:79]
    s_add_u32 m0, s87, 28672
    s_add_u32 s33, s86, 802816
    buffer_load_dwordx4 v15, s[24:27], s33 offen lds
    s_waitcnt lgkmcnt(4)
    s_nop 0
    v_mfma_f32_32x32x16_bf16 v[80:95], v[196:199], v[192:195], v[80:95]
    ds_read_b64_tr_b16 v[176:177], v56 offset:41472
    ds_read_b64_tr_b16 v[178:179], v56 offset:41584
    ds_read_b128 v[168:171], v54 offset:37888
    v_cndmask_b32 v32, 0, v32, s[56:57]
    v_cndmask_b32 v34, 0, v34, s[56:57]
    v_add_f32 v20, v20, v24
    v_add_f32_e64 v28, v28, v32
    s_waitcnt lgkmcnt(5)
    v_mfma_f32_32x32x16_bf16 v[96:111], v[200:203], v[188:191], v[96:111]
    s_add_u32 m0, s92, 21504
    s_add_u32 s33, s86, 802816
    s_mov_b32 exec_hi, 0xffff
    buffer_load_dwordx4 v16, s[24:27], s33 offen lds
    s_mov_b32 exec_hi, -1
    v_mfma_f32_32x32x16_bf16 v[112:127], v[200:203], v[192:195], v[112:127]
    ds_read_b128 v[172:175], v54 offset:41984
    ds_read_b64_tr_b16 v[180:181], v56 offset:48640
    ds_read_b64_tr_b16 v[182:183], v56 offset:48752
    v_add_f32 v20, v20, v28
    v_add_f32 v22, v22, v26
    v_add_f32 v30, v30, v34
    v_add_f32 v22, v22, v30
    s_waitcnt lgkmcnt(6)
    v_mfma_f32_32x32x16_bf16 v[128:143], v[188:191], v[204:207], v[128:143]
    s_add_u32 m0, s87, 32768
    s_add_u32 s33, s86, 917504
    buffer_load_dwordx4 v15, s[24:27], s33 offen lds
    v_mfma_f32_32x32x16_bf16 v[144:159], v[192:195], v[204:207], v[144:159]
    ds_read_b64_tr_b16 v[184:185], v56 offset:55808
    ds_read_b64_tr_b16 v[186:187], v56 offset:55920
    v_mov_b32 v21, v20
    v_mov_b32 v23, v22
    s_nop 0
    v_permlane32_swap_b32 v20, v21
    v_permlane32_swap_b32 v22, v23
    s_waitcnt lgkmcnt(5)
    v_mfma_f32_32x32x16_bf16 v[64:79], v[176:179], v[168:171], v[64:79]
    s_add_u32 m0, s92, 24576
    s_add_u32 s33, s86, 917504
    s_mov_b32 exec_hi, 0xffff
    buffer_load_dwordx4 v16, s[24:27], s33 offen lds
    s_mov_b32 exec_hi, -1
    s_waitcnt lgkmcnt(4)
    v_mfma_f32_32x32x16_bf16 v[80:95], v[176:179], v[172:175], v[80:95]
    ds_read_b64_tr_b16 v[196:197], v56 offset:43264
    ds_read_b64_tr_b16 v[198:199], v56 offset:43376
    ds_read_b128 v[188:191], v55 offset:37888
    v_add_f32 v20, v20, v21
    v_add_f32 v22, v22, v23
    v_mul_f32 v208, 0x3b124925, v20
    v_mul_f32 v210, 0x3b124925, v22
    s_waitcnt lgkmcnt(5)
    s_nop 0
    v_mfma_f32_32x32x16_bf16 v[96:111], v[180:183], v[168:171], v[96:111]
    v_mfma_f32_32x32x16_bf16 v[112:127], v[180:183], v[172:175], v[112:127]
    ds_read_b128 v[192:195], v55 offset:41984
    ds_read_b64_tr_b16 v[200:201], v56 offset:50432
    ds_read_b64_tr_b16 v[202:203], v56 offset:50544
    v_fma_f32 v210, -v208, v208, v210
    v_max_f32_e64 v210, 0, v210
    v_cndmask_b32 v48, 0, v48, s[56:57]
    v_cndmask_b32 v50, 0, v50, s[56:57]
    s_waitcnt lgkmcnt(6)
    v_mfma_f32_32x32x16_bf16 v[128:143], v[168:171], v[184:187], v[128:143]
    v_mfma_f32_32x32x16_bf16 v[144:159], v[172:175], v[184:187], v[144:159]
    ds_read_b64_tr_b16 v[204:205], v56 offset:57600
    ds_read_b64_tr_b16 v[206:207], v56 offset:57712
    v_add_f32 v36, v36, v40
    v_add_f32 v44, v44, v48
    v_add_f32 v36, v36, v44
    v_add_f32 v38, v38, v42
    s_waitcnt lgkmcnt(5)
    v_mfma_f32_32x32x16_bf16 v[64:79], v[196:199], v[188:191], v[64:79]
    buffer_load_dwordx2 v[160:161], v167, s[12:15], 0 offen offset:0 sc1
    buffer_load_dwordx2 v[162:163], v167, s[12:15], 0 offen offset:3584 sc1
    buffer_load_dwordx2 v[164:165], v167, s[12:15], s47 offen offset:0 sc1
    s_waitcnt lgkmcnt(4)
    v_mfma_f32_32x32x16_bf16 v[80:95], v[196:199], v[192:195], v[80:95]
    s_waitcnt lgkmcnt(0)
    s_waitcnt vmcnt(9)
    s_barrier
    ds_read_b64_tr_b16 v[176:177], v61 offset:0
    ds_read_b64_tr_b16 v[178:179], v61 offset:112
    ds_read_b128 v[168:171], v57 offset:0
    v_mfma_f32_32x32x16_bf16 v[96:111], v[200:203], v[188:191], v[96:111]
    v_mfma_f32_32x32x16_bf16 v[112:127], v[200:203], v[192:195], v[112:127]
    ds_read_b128 v[172:175], v57 offset:4096
    ds_read_b64_tr_b16 v[180:181], v61 offset:7168
    ds_read_b64_tr_b16 v[182:183], v61 offset:7280
    v_mfma_f32_32x32x16_bf16 v[128:143], v[188:191], v[204:207], v[128:143]
    v_mfma_f32_32x32x16_bf16 v[144:159], v[192:195], v[204:207], v[144:159]
    ds_read_b64_tr_b16 v[184:185], v61 offset:14336
    ds_read_b64_tr_b16 v[186:187], v61 offset:14448
    s_waitcnt lgkmcnt(5)
    v_mfma_f32_32x32x16_bf16 v[64:79], v[176:179], v[168:171], v[64:79]
    s_add_u32 m0, s87, 0
    s_add_u32 s33, s86, 0
    buffer_load_dwordx4 v15, s[24:27], s33 offen lds
    s_waitcnt lgkmcnt(4)
    v_mfma_f32_32x32x16_bf16 v[80:95], v[176:179], v[172:175], v[80:95]
    ds_read_b64_tr_b16 v[196:197], v61 offset:1792
    ds_read_b64_tr_b16 v[198:199], v61 offset:1904
    ds_read_b128 v[188:191], v58 offset:0
    v_add_f32 v46, v46, v50
    v_add_f32 v38, v38, v46
    v_mov_b32 v37, v36
    v_mov_b32_e64 v39, v38
    s_waitcnt lgkmcnt(5)
    v_mfma_f32_32x32x16_bf16 v[96:111], v[180:183], v[168:171], v[96:111]
    s_add_u32 m0, s92, 0
    s_add_u32 s33, s86, 0
    s_mov_b32 exec_hi, 0xffff
    buffer_load_dwordx4 v16, s[24:27], s33 offen lds
    s_mov_b32 exec_hi, -1
    v_mfma_f32_32x32x16_bf16 v[112:127], v[180:183], v[172:175], v[112:127]
    ds_read_b128 v[192:195], v58 offset:4096
    ds_read_b64_tr_b16 v[200:201], v61 offset:8960
    ds_read_b64_tr_b16 v[202:203], v61 offset:9072
    v_permlane32_swap_b32 v36, v37
    v_permlane32_swap_b32 v38, v39
    v_add_f32 v36, v36, v37
    v_add_f32 v38, v38, v39
    s_waitcnt lgkmcnt(6)
    v_mfma_f32_32x32x16_bf16 v[128:143], v[168:171], v[184:187], v[128:143]
    s_add_u32 m0, s87, 4096
    s_add_u32 s33, s86, 114688
    buffer_load_dwordx4 v15, s[24:27], s33 offen lds
    v_mfma_f32_32x32x16_bf16 v[144:159], v[172:175], v[184:187], v[144:159]
    ds_read_b64_tr_b16 v[204:205], v61 offset:16128
    ds_read_b64_tr_b16 v[206:207], v61 offset:16240
    v_mul_f32 v212, 0x3b124925, v36
    v_mul_f32 v214, 0x3b124925, v38
    v_fma_f32 v214, -v212, v212, v214
    v_max_f32 v214, 0, v214
    s_waitcnt lgkmcnt(5)
    v_mfma_f32_32x32x16_bf16 v[64:79], v[196:199], v[188:191], v[64:79]
    s_add_u32 m0, s92, 3072
    s_add_u32 s33, s86, 114688
    s_mov_b32 exec_hi, 0xffff
    buffer_load_dwordx4 v16, s[24:27], s33 offen lds
    s_mov_b32 exec_hi, -1
    s_waitcnt lgkmcnt(4)
    v_mfma_f32_32x32x16_bf16 v[80:95], v[196:199], v[192:195], v[80:95]
    ds_read_b64_tr_b16 v[176:177], v61 offset:3584
    ds_read_b64_tr_b16 v[178:179], v61 offset:3696
    ds_read_b128 v[168:171], v59 offset:0
    v_add_f32 v4, 0x3727c5ac, v210
    v_rsq_f32_e64 v209, v4
    v_add_f32 v5, 0x3727c5ac, v214
    v_rsq_f32 v213, v5
    s_waitcnt lgkmcnt(5)
    v_mfma_f32_32x32x16_bf16 v[96:111], v[200:203], v[188:191], v[96:111]
    s_add_u32 m0, s87, 8192
    s_add_u32 s33, s86, 229376
    buffer_load_dwordx4 v15, s[24:27], s33 offen lds
    v_mfma_f32_32x32x16_bf16 v[112:127], v[200:203], v[192:195], v[112:127]
    ds_read_b128 v[172:175], v59 offset:4096
    ds_read_b64_tr_b16 v[180:181], v61 offset:10752
    ds_read_b64_tr_b16 v[182:183], v61 offset:10864
    v_mul_f32 v211, v4, v209
    v_mul_f32 v215, v5, v213
    v_cvt_pk_bf16_f32 v216, -v208, -v208
    v_and_b32 v4, 0xffff0000, v216
    s_waitcnt lgkmcnt(6)
    v_mfma_f32_32x32x16_bf16 v[128:143], v[188:191], v[204:207], v[128:143]
    s_add_u32 m0, s92, 6144
    s_add_u32 s33, s86, 229376
    s_mov_b32 exec_hi, 0xffff
    buffer_load_dwordx4 v16, s[24:27], s33 offen lds
    s_mov_b32 exec_hi, -1
    v_mfma_f32_32x32x16_bf16 v[144:159], v[192:195], v[204:207], v[144:159]
    ds_read_b64_tr_b16 v[184:185], v61 offset:17920
    ds_read_b64_tr_b16 v[186:187], v61 offset:18032
    v_add_f32_e64 v4, v208, v4
    v_cvt_pk_bf16_f32 v217, -v4, v211
    v_and_b32 v4, 0xffff0000, v217
    v_sub_f32 v4, v211, v4
    s_waitcnt lgkmcnt(5)
    v_mfma_f32_32x32x16_bf16 v[64:79], v[176:179], v[168:171], v[64:79]
    s_add_u32 m0, s87, 12288
    s_add_u32 s33, s86, 344064
    buffer_load_dwordx4 v15, s[24:27], s33 offen lds
    s_waitcnt lgkmcnt(4)
    v_mfma_f32_32x32x16_bf16 v[80:95], v[176:179], v[172:175], v[80:95]
    ds_read_b64_tr_b16 v[196:197], v61 offset:5376
    ds_read_b64_tr_b16 v[198:199], v61 offset:5488
    ds_read_b128 v[188:191], v60 offset:0
    v_cvt_pk_bf16_f32 v218, v4, 0
    v_mov_b32 v219, 0
    v_cvt_pk_bf16_f32 v220, -v212, -v212
    v_and_b32 v4, 0xffff0000, v220
    s_waitcnt lgkmcnt(5)
    v_mfma_f32_32x32x16_bf16 v[96:111], v[180:183], v[168:171], v[96:111]
    s_add_u32 m0, s92, 9216
    s_add_u32 s33, s86, 344064
    s_mov_b32 exec_hi, 0xffff
    buffer_load_dwordx4 v16, s[24:27], s33 offen lds
    s_mov_b32 exec_hi, -1
    v_mfma_f32_32x32x16_bf16 v[112:127], v[180:183], v[172:175], v[112:127]
    ds_read_b128 v[192:195], v60 offset:4096
    ds_read_b64_tr_b16 v[200:201], v61 offset:12544
    ds_read_b64_tr_b16 v[202:203], v61 offset:12656
    v_add_f32_e64 v4, v212, v4
    v_cvt_pk_bf16_f32 v221, -v4, v215
    v_and_b32 v4, 0xffff0000, v221
    v_sub_f32 v4, v215, v4
    s_waitcnt lgkmcnt(6)
    v_mfma_f32_32x32x16_bf16 v[128:143], v[168:171], v[184:187], v[128:143]
    s_add_u32 m0, s87, 16384
    s_add_u32 s33, s86, 458752
    buffer_load_dwordx4 v15, s[24:27], s33 offen lds
    v_mfma_f32_32x32x16_bf16 v[144:159], v[172:175], v[184:187], v[144:159]
    ds_read_b64_tr_b16 v[204:205], v61 offset:19712
    ds_read_b64_tr_b16 v[206:207], v61 offset:19824
    v_cvt_pk_bf16_f32 v222, v4, 0
    v_mov_b32 v223, 0
    s_waitcnt lgkmcnt(5)
    v_mfma_f32_32x32x16_bf16 v[64:79], v[196:199], v[188:191], v[64:79]
    s_add_u32 m0, s92, 12288
    s_add_u32 s33, s86, 458752
    s_mov_b32 exec_hi, 0xffff
    buffer_load_dwordx4 v16, s[24:27], s33 offen lds
    s_mov_b32 exec_hi, -1
    s_waitcnt lgkmcnt(4)
    v_mfma_f32_32x32x16_bf16 v[80:95], v[196:199], v[192:195], v[80:95]
    s_waitcnt lgkmcnt(2)
    v_mfma_f32_32x32x16_bf16 v[96:111], v[200:203], v[188:191], v[96:111]
    s_add_u32 m0, s87, 20480
    s_add_u32 s33, s86, 573440
    buffer_load_dwordx4 v15, s[24:27], s33 offen lds
    v_mfma_f32_32x32x16_bf16 v[112:127], v[200:203], v[192:195], v[112:127]
    s_waitcnt lgkmcnt(0)
    v_mfma_f32_32x32x16_bf16 v[128:143], v[188:191], v[204:207], v[128:143]
    s_add_u32 m0, s92, 15360
    s_add_u32 s33, s86, 573440
    s_mov_b32 exec_hi, 0xffff
    buffer_load_dwordx4 v16, s[24:27], s33 offen lds
    s_mov_b32 exec_hi, -1
    v_mfma_f32_32x32x16_bf16 v[144:159], v[192:195], v[204:207], v[144:159]
    s_barrier
    s_waitcnt vmcnt(14)
    v_xor_b32 v4, s30, v161
    v_cndmask_b32 v4, 0, v4, s[54:55]
    s_waitcnt vmcnt(13)
    v_xor_b32 v5, s30, v163
    v_cndmask_b32 v5, 0, v5, s[54:55]
    v_or_b32 v4, v4, v5
    s_waitcnt vmcnt(12)
    v_xor_b32_e64 v5, s30, v165
    v_cndmask_b32 v5, 0, v5, s[54:55]
    v_or_b32 v4, v4, v5
    v_cmp_ne_u32 vcc, 0, v4
    s_nop 1
    s_cbranch_vccz .Lgrok23
    s_waitcnt vmcnt(0)
    s_mov_b32 s34, 0
.Lspin24:
    buffer_load_dwordx2 v[160:161], v167, s[12:15], 0 offen offset:0 sc1
    buffer_load_dwordx2 v[162:163], v167, s[12:15], 0 offen offset:3584 sc1
    buffer_load_dwordx2 v[164:165], v167, s[12:15], s47 offen offset:0 sc1
    s_add_u32 s34, s34, 1
    s_waitcnt vmcnt(0)
    v_xor_b32_e64 v4, s30, v161
    v_cndmask_b32 v4, 0, v4, s[54:55]
    v_xor_b32_e64 v5, s30, v163
    v_cndmask_b32 v5, 0, v5, s[54:55]
    v_or_b32 v4, v4, v5
    v_xor_b32 v5, s30, v165
    v_cndmask_b32 v5, 0, v5, s[54:55]
    v_or_b32 v4, v4, v5
    v_cmp_ne_u32 vcc, 0, v4
    s_cmp_ge_u32 s34, 200000
    s_cbranch_scc1 .Lspun25
    s_cbranch_vccnz .Lspin24
.Lspun25:
    s_nop 1
.Lgrok23:
    s_mov_b32 s20, s76
    s_mov_b32 s21, s77
    s_mov_b32 s22, 0x188000
    s_mov_b32 s23, 0x00020000
    s_sub_u32 s31, s2, 112
    s_lshl_b32 s31, s31, 2
    s_add_u32 s31, s31, s3
    s_mul_i32 s31, s31, 3200
    v_lshlrev_b32 v10, 7, v1
    v_cmp_gt_u32_e64 vcc, 25, v1
    v_mov_b32 v11, 0x7fff0000
    s_nop 0
    v_cndmask_b32 v10, v11, v10, vcc
    buffer_load_dword v2, v10, s[20:23], s31 offen
    s_mov_b32 s20, s66
    s_mov_b32 s21, s67
    s_mov_b32 s22, 0x62000
    s_mov_b32 s23, 0x00020000
    buffer_load_dword v2, v10, s[20:23], s31 offen
    ds_read_b64_tr_b16 v[52:53], v62 offset:0
    ds_read_b64_tr_b16 v[54:55], v62 offset:448
    ds_read_b64_tr_b16 v[56:57], v62 offset:896
    ds_read_b64_tr_b16 v[58:59], v62 offset:1344
    s_mov_b32 exec_lo, 0xf0000000
    s_mov_b32 exec_hi, 0xf0000000
    v_pk_mov_b32 v[128:129], 0, 0
    v_pk_mov_b32 v[130:131], 0, 0
    v_pk_mov_b32 v[132:133], 0, 0
    v_pk_mov_b32 v[134:135], 0, 0
    v_pk_mov_b32 v[136:137], 0, 0
    v_pk_mov_b32 v[138:139], 0, 0
    v_pk_mov_b32 v[140:141], 0, 0
    v_pk_mov_b32 v[142:143], 0, 0
    v_pk_mov_b32 v[144:145], 0, 0
    v_pk_mov_b32 v[146:147], 0, 0
    v_pk_mov_b32 v[148:149], 0, 0
    v_pk_mov_b32 v[150:151], 0, 0
    v_pk_mov_b32 v[152:153], 0, 0
    v_pk_mov_b32 v[154:155], 0, 0
    v_pk_mov_b32 v[156:157], 0, 0
    v_pk_mov_b32 v[158:159], 0, 0
    s_mov_b64 exec, -1
    s_waitcnt lgkmcnt(0)
    v_cndmask_b32 v58, 0, v58, s[56:57]
    v_cndmask_b32 v59, 0, v59, s[56:57]
    v_cndmask_b32 v4, 0, v160, s[54:55]
    v_cvt_pk_bf16_f32 v169, v4, 0
    v_lshlrev_b32 v170, 16, v169
    v_sub_f32 v170, v4, v170
    v_cvt_pk_bf16_f32 v168, v4, v170
    v_mov_b32 v170, 0
    v_mov_b32 v171, 0
    v_cndmask_b32 v4, 0, v162, s[54:55]
    v_cvt_pk_bf16_f32 v173, v4, 0
    v_lshlrev_b32 v174, 16, v173
    v_sub_f32 v174, v4, v174
    v_cvt_pk_bf16_f32 v172, v4, v174
    v_mov_b32 v174, 0
    v_mov_b32 v175, 0
    v_cndmask_b32 v4, 0, v164, s[54:55]
    v_cvt_pk_bf16_f32 v177, v4, 0
    v_lshlrev_b32 v178, 16, v177
    v_sub_f32 v178, v4, v178
    v_cvt_pk_bf16_f32 v176, v4, v178
    v_mov_b32 v178, 0
    v_mov_b32 v179, 0
    s_mov_b32 exec_lo, 0x10000000
    s_mov_b32 exec_hi, 0
    v_mov_b32 v177, 0x3f800000
    v_mov_b32 v178, 0x3f80
    s_mov_b64 exec, -1
    s_nop 0
    v_mfma_f32_32x32x16_bf16 v[96:111], v[172:175], v[216:219], v[96:111]
    v_mfma_f32_32x32x16_bf16 v[112:127], v[172:175], v[220:223], v[112:127]
    v_mfma_f32_32x32x16_bf16 v[128:143], v[216:219], v[176:179], v[128:143]
    v_mfma_f32_32x32x16_bf16 v[144:159], v[220:223], v[176:179], v[144:159]
    v_mfma_f32_32x32x16_bf16 v[64:79], v[168:171], v[216:219], v[64:79]
    s_add_u32 m0, s87, 36864
    s_add_u32 s33, s86, 1032192
    buffer_load_dwordx4 v15, s[24:27], s33 offen lds
    v_mfma_f32_32x32x16_bf16 v[80:95], v[168:171], v[220:223], v[80:95]
    s_nop 3
    s_nop 0
    v_cvt_pk_bf16_f32 v20, v96, v97
    v_cvt_pk_bf16_f32 v21, v98, v99
    v_cvt_pk_bf16_f32 v22, v100, v101
    v_cvt_pk_bf16_f32 v23, v102, v103
    v_cvt_pk_bf16_f32 v24, v104, v105
    v_cvt_pk_bf16_f32 v25, v106, v107
    v_cvt_pk_bf16_f32 v26, v108, v109
    v_cvt_pk_bf16_f32 v27, v110, v111
    v_mfma_f32_32x32x16_bf16 v[180:195], v[52:55], v[20:23], 0
    s_nop 0
    s_nop 0
    v_mfma_f32_32x32x16_bf16 v[180:195], v[56:59], v[24:27], v[180:195]
    v_cvt_pk_bf16_f32 v28, v112, v113
    v_cvt_pk_bf16_f32 v29, v114, v115
    v_cvt_pk_bf16_f32 v30, v116, v117
    v_cvt_pk_bf16_f32 v31, v118, v119
    v_cvt_pk_bf16_f32 v32, v120, v121
    v_cvt_pk_bf16_f32 v33, v122, v123
    v_cvt_pk_bf16_f32 v34, v124, v125
    v_cvt_pk_bf16_f32 v35, v126, v127
    v_mfma_f32_32x32x16_bf16 v[232:247], v[52:55], v[28:31], 0
    s_nop 0
    s_nop 0
    v_mfma_f32_32x32x16_bf16 v[232:247], v[56:59], v[32:35], v[232:247]
    v_cvt_pk_bf16_f32 v36, v128, v129
    v_cvt_pk_bf16_f32 v37, v130, v131
    v_cvt_pk_bf16_f32 v38, v132, v133
    v_cvt_pk_bf16_f32 v39, v134, v135
    v_cvt_pk_bf16_f32 v40, v136, v137
    s_add_u32 m0, s92, 27648
    s_add_u32 s33, s86, 1032192
    s_mov_b32 exec_hi, 0xffff
    buffer_load_dwordx4 v16, s[24:27], s33 offen lds
    s_mov_b32 exec_hi, -1
    s_nop 0
    v_cvt_pk_bf16_f32 v41, v138, v139
    v_cvt_pk_bf16_f32 v42, v140, v141
    v_cvt_pk_bf16_f32 v43, v142, v143
    v_cvt_pk_bf16_f32 v44, v144, v145
    v_cvt_pk_bf16_f32 v45, v146, v147
    v_cvt_pk_bf16_f32 v46, v148, v149
    v_cvt_pk_bf16_f32 v47, v150, v151
    v_cvt_pk_bf16_f32 v48, v152, v153
    v_cvt_pk_bf16_f32 v49, v154, v155
    v_cvt_pk_bf16_f32 v50, v156, v157
    v_cvt_pk_bf16_f32 v51, v158, v159
    v_mul_f32 v18, 0x3fb8aa3b, v209
    v_max3_f32 v176, v180, v181, v182
    v_min3_f32 v177, v180, v181, v182
    v_max3_f32 v176, v176, v183, v184
    v_min3_f32 v177, v177, v183, v184
    v_max3_f32 v176, v176, v185, v186
    v_min3_f32 v177, v177, v185, v186
    v_max3_f32 v176, v176, v187, v188
    v_min3_f32 v177, v177, v187, v188
    v_max3_f32 v176, v176, v189, v190
    v_min3_f32 v177, v177, v189, v190
    v_max3_f32 v176, v176, v191, v192
    v_min3_f32 v177, v177, v191, v192
    v_max_f32 v176, v176, v193
    v_min_f32 v177, v177, v193
    s_add_u32 m0, s87, 40960
    s_add_u32 s33, s86, 1146880
    buffer_load_dwordx4 v15, s[24:27], s33 offen lds
    v_mov_b32 v178, v176
    v_mov_b32 v179, v177
    s_nop 0
    v_permlane32_swap_b32 v176, v178
    v_permlane32_swap_b32 v177, v179
    v_max_f32 v176, v176, v178
    v_min_f32 v177, v177, v179
    v_mul_f32 v19, v18, v176
    v_pk_fma_f32 v[160:161], v[180:181], v[18:19], v[18:19] op_sel:[0,0,1] op_sel_hi:[1,0,1] neg_lo:[0,0,1] neg_hi:[0,0,1]
    v_pk_fma_f32 v[162:163], v[182:183], v[18:19], v[18:19] op_sel:[0,0,1] op_sel_hi:[1,0,1] neg_lo:[0,0,1] neg_hi:[0,0,1]
    v_pk_fma_f32 v[164:165], v[184:185], v[18:19], v[18:19] op_sel:[0,0,1] op_sel_hi:[1,0,1] neg_lo:[0,0,1] neg_hi:[0,0,1]
    v_pk_fma_f32 v[166:167], v[186:187], v[18:19], v[18:19] op_sel:[0,0,1] op_sel_hi:[1,0,1] neg_lo:[0,0,1] neg_hi:[0,0,1]
    v_pk_fma_f32 v[168:169], v[188:189], v[18:19], v[18:19] op_sel:[0,0,1] op_sel_hi:[1,0,1] neg_lo:[0,0,1] neg_hi:[0,0,1]
    v_pk_fma_f32 v[170:171], v[190:191], v[18:19], v[18:19] op_sel:[0,0,1] op_sel_hi:[1,0,1] neg_lo:[0,0,1] neg_hi:[0,0,1]
    v_pk_fma_f32 v[172:173], v[192:193], v[18:19], v[18:19] op_sel:[0,0,1] op_sel_hi:[1,0,1] neg_lo:[0,0,1] neg_hi:[0,0,1]
    v_exp_f32 v160, v160
    v_exp_f32 v161, v161
    v_exp_f32 v162, v162
    v_exp_f32 v163, v163
    v_exp_f32 v164, v164
    v_exp_f32 v165, v165
    v_exp_f32 v166, v166
    v_exp_f32 v167, v167
    v_exp_f32 v168, v168
    v_exp_f32 v169, v169
    v_exp_f32 v170, v170
    v_exp_f32 v171, v171
    s_add_u32 m0, s92, 30720
    s_add_u32 s33, s86, 1146880
    s_mov_b32 exec_hi, 0xffff
    buffer_load_dwordx4 v16, s[24:27], s33 offen lds
    s_mov_b32 exec_hi, -1
    v_exp_f32 v172, v172
    v_exp_f32_e64 v173, v173
    v_pk_add_f32 v[178:179], v[160:161], v[162:163]
    v_pk_add_f32 v[178:179], v[178:179], v[164:165]
    v_pk_add_f32 v[178:179], v[178:179], v[166:167]
    v_pk_add_f32 v[178:179], v[178:179], v[168:169]
    v_pk_add_f32 v[178:179], v[178:179], v[170:171]
    v_pk_add_f32 v[178:179], v[178:179], v[172:173]
    v_add_f32 v178, v178, v179
    v_mov_b32 v179, v178
    s_nop 1
    v_permlane32_swap_b32 v178, v179
    v_add_f32 v178, v178, v179
    v_rcp_f32 v178, v178
    s_nop 0
    v_mul_f32 v178, v178, v209
    v_pk_mul_f32 v[160:161], v[160:161], v[178:179] op_sel_hi:[1,0]
    v_pk_mul_f32 v[162:163], v[162:163], v[178:179] op_sel_hi:[1,0]
    v_pk_mul_f32 v[164:165], v[164:165], v[178:179] op_sel_hi:[1,0]
    v_pk_mul_f32 v[166:167], v[166:167], v[178:179] op_sel_hi:[1,0]
    v_pk_mul_f32 v[168:169], v[168:169], v[178:179] op_sel_hi:[1,0]
    v_pk_mul_f32 v[170:171], v[170:171], v[178:179] op_sel_hi:[1,0]
    v_pk_mul_f32 v[172:173], v[172:173], v[178:179] op_sel_hi:[1,0]
    v_cvt_pk_bf16_f32 v20, v160, v161
    v_cvt_pk_bf16_f32 v21, v162, v163
    v_cvt_pk_bf16_f32 v22, v164, v165
    v_cvt_pk_bf16_f32 v23, v166, v167
    v_cvt_pk_bf16_f32 v24, v168, v169
    s_add_u32 m0, s87, 45056
    s_add_u32 s33, s86, 1261568
    buffer_load_dwordx4 v15, s[24:27], s33 offen lds
    v_cvt_pk_bf16_f32 v25, v170, v171
    v_cvt_pk_bf16_f32 v26, v172, v173
    v_mov_b32 v27, 0
    v_mul_f32 v19, v18, v177
    v_pk_fma_f32 v[160:161], v[180:181], v[18:19], v[18:19] op_sel:[0,0,1] op_sel_hi:[1,0,1] neg_lo:[1,0,0] neg_hi:[1,0,0]
    v_pk_fma_f32 v[162:163], v[182:183], v[18:19], v[18:19] op_sel:[0,0,1] op_sel_hi:[1,0,1] neg_lo:[1,0,0] neg_hi:[1,0,0]
    v_pk_fma_f32 v[164:165], v[184:185], v[18:19], v[18:19] op_sel:[0,0,1] op_sel_hi:[1,0,1] neg_lo:[1,0,0] neg_hi:[1,0,0]
    v_pk_fma_f32 v[166:167], v[186:187], v[18:19], v[18:19] op_sel:[0,0,1] op_sel_hi:[1,0,1] neg_lo:[1,0,0] neg_hi:[1,0,0]
    v_pk_fma_f32 v[168:169], v[188:189], v[18:19], v[18:19] op_sel:[0,0,1] op_sel_hi:[1,0,1] neg_lo:[1,0,0] neg_hi:[1,0,0]
    v_pk_fma_f32 v[170:171], v[190:191], v[18:19], v[18:19] op_sel:[0,0,1] op_sel_hi:[1,0,1] neg_lo:[1,0,0] neg_hi:[1,0,0]
    v_pk_fma_f32 v[172:173], v[192:193], v[18:19], v[18:19] op_sel:[0,0,1] op_sel_hi:[1,0,1] neg_lo:[1,0,0] neg_hi:[1,0,0]
    v_exp_f32 v160, v160
    v_exp_f32 v161, v161
    v_exp_f32 v162, v162
    v_exp_f32 v163, v163
    v_exp_f32 v164, v164
    v_exp_f32 v165, v165
    v_exp_f32 v166, v166
    v_exp_f32 v167, v167
    v_exp_f32 v168, v168
    v_exp_f32 v169, v169
    v_exp_f32 v170, v170
    v_exp_f32 v171, v171
    v_exp_f32 v172, v172
    v_exp_f32 v173, v173
    v_pk_add_f32 v[178:179], v[160:161], v[162:163]
    s_add_u32 m0, s92, 33792
    s_add_u32 s33, s86, 1261568
    s_mov_b32 exec_hi, 0xffff
    buffer_load_dwordx4 v16, s[24:27], s33 offen lds
    s_mov_b32 exec_hi, -1
    v_pk_add_f32 v[178:179], v[178:179], v[164:165]
    v_pk_add_f32 v[178:179], v[178:179], v[166:167]
    v_pk_add_f32 v[178:179], v[178:179], v[168:169]
    v_pk_add_f32 v[178:179], v[178:179], v[170:171]
    v_pk_add_f32 v[178:179], v[178:179], v[172:173]
    v_add_f32 v178, v178, v179
    v_mov_b32 v179, v178
    s_nop 1
    v_permlane32_swap_b32 v178, v179
    v_add_f32 v178, v178, v179
    v_rcp_f32 v178, v178
    s_nop 0
    v_mul_f32_e64 v178, v178, v209
    v_pk_mul_f32 v[160:161], v[160:161], v[178:179] op_sel_hi:[1,0]
    v_pk_mul_f32 v[162:163], v[162:163], v[178:179] op_sel_hi:[1,0]
    v_pk_mul_f32 v[164:165], v[164:165], v[178:179] op_sel_hi:[1,0]
    v_pk_mul_f32 v[166:167], v[166:167], v[178:179] op_sel_hi:[1,0]
    v_pk_mul_f32 v[168:169], v[168:169], v[178:179] op_sel_hi:[1,0]
    v_pk_mul_f32 v[170:171], v[170:171], v[178:179] op_sel_hi:[1,0]
    v_pk_mul_f32 v[172:173], v[172:173], v[178:179] op_sel_hi:[1,0]
    v_cvt_pk_bf16_f32 v28, v160, v161
    v_cvt_pk_bf16_f32 v29, v162, v163
    v_cvt_pk_bf16_f32 v30, v164, v165
    v_cvt_pk_bf16_f32 v31, v166, v167
    v_cvt_pk_bf16_f32 v32, v168, v169
    v_cvt_pk_bf16_f32 v33, v170, v171
    v_cvt_pk_bf16_f32 v34, v172, v173
    v_mov_b32_e64 v35, 0
    s_add_u32 m0, s87, 49152
    s_add_u32 s33, s86, 1376256
    buffer_load_dwordx4 v15, s[24:27], s33 offen lds
    v_mfma_f32_32x32x16_bf16 v[96:111], v[20:23], v[224:227], 0
    v_mfma_f32_32x32x16_bf16 v[96:111], v[24:27], v[228:231], v[96:111]
    v_mfma_f32_32x32x16_bf16 v[112:127], v[28:31], v[224:227], 0
    v_mfma_f32_32x32x16_bf16 v[112:127], v[32:35], v[228:231], v[112:127]
    s_nop 9
    s_nop 0
    v_cvt_pk_bf16_f32 v196, v96, v97
    v_cvt_pk_bf16_f32 v197, v98, v99
    v_cvt_pk_bf16_f32 v198, v100, v101
    v_cvt_pk_bf16_f32 v199, v102, v103
    v_cvt_pk_bf16_f32 v200, v104, v105
    v_cvt_pk_bf16_f32 v201, v106, v107
    v_cvt_pk_bf16_f32 v202, v108, v109
    v_cvt_pk_bf16_f32 v203, v110, v111
    v_mfma_f32_32x32x16_bf16 v[128:143], v[196:199], v[36:39], 0
    s_nop 0
    s_nop 0
    v_mfma_f32_32x32x16_bf16 v[128:143], v[200:203], v[40:43], v[128:143]
    v_cvt_pk_bf16_f32 v196, v112, v113
    v_cvt_pk_bf16_f32 v197, v114, v115
    v_cvt_pk_bf16_f32 v198, v116, v117
    v_cvt_pk_bf16_f32 v199, v118, v119
    v_cvt_pk_bf16_f32 v200, v120, v121
    v_cvt_pk_bf16_f32 v201, v122, v123
    v_cvt_pk_bf16_f32 v202, v124, v125
    v_cvt_pk_bf16_f32 v203, v126, v127
    v_mfma_f32_32x32x16_bf16 v[144:159], v[196:199], v[36:39], 0
    s_nop 0
    s_nop 0
    v_mfma_f32_32x32x16_bf16 v[144:159], v[200:203], v[40:43], v[144:159]
    v_mul_f32 v18, 0x3fb8aa3b, v213
    v_max3_f32 v176, v232, v233, v234
    s_add_u32 m0, s92, 36864
    s_add_u32 s33, s86, 1376256
    s_mov_b32 exec_hi, 0xffff
    buffer_load_dwordx4 v16, s[24:27], s33 offen lds
    s_mov_b32 exec_hi, -1
    s_nop 0
    v_min3_f32 v177, v232, v233, v234
    v_max3_f32 v176, v176, v235, v236
    v_min3_f32 v177, v177, v235, v236
    v_max3_f32 v176, v176, v237, v238
    v_min3_f32 v177, v177, v237, v238
    v_max3_f32 v176, v176, v239, v240
    v_min3_f32 v177, v177, v239, v240
    v_max3_f32 v176, v176, v241, v242
    v_min3_f32 v177, v177, v241, v242
    v_max3_f32 v176, v176, v243, v244
    v_min3_f32 v177, v177, v243, v244
    v_max_f32 v176, v176, v245
    v_min_f32 v177, v177, v245
    v_mov_b32 v178, v176
    v_mov_b32 v179, v177
    s_nop 0
    v_permlane32_swap_b32 v176, v178
    v_permlane32_swap_b32 v177, v179
    v_max_f32 v176, v176, v178
    v_min_f32 v177, v177, v179
    v_mul_f32 v19, v18, v176
    v_pk_fma_f32 v[160:161], v[232:233], v[18:19], v[18:19] op_sel:[0,0,1] op_sel_hi:[1,0,1] neg_lo:[0,0,1] neg_hi:[0,0,1]
    v_pk_fma_f32 v[162:163], v[234:235], v[18:19], v[18:19] op_sel:[0,0,1] op_sel_hi:[1,0,1] neg_lo:[0,0,1] neg_hi:[0,0,1]
    v_pk_fma_f32 v[164:165], v[236:237], v[18:19], v[18:19] op_sel:[0,0,1] op_sel_hi:[1,0,1] neg_lo:[0,0,1] neg_hi:[0,0,1]
    v_pk_fma_f32 v[166:167], v[238:239], v[18:19], v[18:19] op_sel:[0,0,1] op_sel_hi:[1,0,1] neg_lo:[0,0,1] neg_hi:[0,0,1]
    v_pk_fma_f32 v[168:169], v[240:241], v[18:19], v[18:19] op_sel:[0,0,1] op_sel_hi:[1,0,1] neg_lo:[0,0,1] neg_hi:[0,0,1]
    v_pk_fma_f32 v[170:171], v[242:243], v[18:19], v[18:19] op_sel:[0,0,1] op_sel_hi:[1,0,1] neg_lo:[0,0,1] neg_hi:[0,0,1]
    s_add_u32 m0, s87, 53248
    s_add_u32 s33, s86, 1490944
    buffer_load_dwordx4 v15, s[24:27], s33 offen lds
    v_pk_fma_f32 v[172:173], v[244:245], v[18:19], v[18:19] op_sel:[0,0,1] op_sel_hi:[1,0,1] neg_lo:[0,0,1] neg_hi:[0,0,1]
    v_exp_f32 v160, v160
    v_exp_f32 v161, v161
    v_exp_f32 v162, v162
    v_exp_f32 v163, v163
    v_exp_f32 v164, v164
    v_exp_f32 v165, v165
    v_exp_f32 v166, v166
    v_exp_f32 v167, v167
    v_exp_f32 v168, v168
    v_exp_f32 v169, v169
    v_exp_f32 v170, v170
    v_exp_f32 v171, v171
    v_exp_f32 v172, v172
    v_exp_f32 v173, v173
    v_pk_add_f32 v[178:179], v[160:161], v[162:163]
    v_pk_add_f32 v[178:179], v[178:179], v[164:165]
    v_pk_add_f32 v[178:179], v[178:179], v[166:167]
    v_pk_add_f32 v[178:179], v[178:179], v[168:169]
    v_pk_add_f32 v[178:179], v[178:179], v[170:171]
    v_pk_add_f32 v[178:179], v[178:179], v[172:173]
    v_add_f32 v178, v178, v179
    v_mov_b32 v179, v178
    s_nop 1
    v_permlane32_swap_b32 v178, v179
    v_add_f32 v178, v178, v179
    v_rcp_f32 v178, v178
    s_add_u32 m0, s92, 39936
    s_add_u32 s33, s86, 1490944
    s_mov_b32 exec_hi, 0xffff
    buffer_load_dwordx4 v16, s[24:27], s33 offen lds
    s_mov_b32 exec_hi, -1
    v_mul_f32 v178, v178, v213
    v_pk_mul_f32 v[160:161], v[160:161], v[178:179] op_sel_hi:[1,0]
    v_pk_mul_f32 v[162:163], v[162:163], v[178:179] op_sel_hi:[1,0]
    v_pk_mul_f32 v[164:165], v[164:165], v[178:179] op_sel_hi:[1,0]
    v_pk_mul_f32 v[166:167], v[166:167], v[178:179] op_sel_hi:[1,0]
    v_pk_mul_f32 v[168:169], v[168:169], v[178:179] op_sel_hi:[1,0]
    v_pk_mul_f32 v[170:171], v[170:171], v[178:179] op_sel_hi:[1,0]
    v_pk_mul_f32 v[172:173], v[172:173], v[178:179] op_sel_hi:[1,0]
    v_cvt_pk_bf16_f32 v20, v160, v161
    v_cvt_pk_bf16_f32 v21, v162, v163
    v_cvt_pk_bf16_f32 v22, v164, v165
    v_cvt_pk_bf16_f32 v23, v166, v167
    v_cvt_pk_bf16_f32 v24, v168, v169
    v_cvt_pk_bf16_f32 v25, v170, v171
    v_cvt_pk_bf16_f32 v26, v172, v173
    v_mov_b32 v27, 0
    v_mul_f32 v19, v18, v177
    v_pk_fma_f32 v[160:161], v[232:233], v[18:19], v[18:19] op_sel:[0,0,1] op_sel_hi:[1,0,1] neg_lo:[1,0,0] neg_hi:[1,0,0]
    v_pk_fma_f32 v[162:163], v[234:235], v[18:19], v[18:19] op_sel:[0,0,1] op_sel_hi:[1,0,1] neg_lo:[1,0,0] neg_hi:[1,0,0]
    v_pk_fma_f32 v[164:165], v[236:237], v[18:19], v[18:19] op_sel:[0,0,1] op_sel_hi:[1,0,1] neg_lo:[1,0,0] neg_hi:[1,0,0]
    v_pk_fma_f32 v[166:167], v[238:239], v[18:19], v[18:19] op_sel:[0,0,1] op_sel_hi:[1,0,1] neg_lo:[1,0,0] neg_hi:[1,0,0]
    v_pk_fma_f32 v[168:169], v[240:241], v[18:19], v[18:19] op_sel:[0,0,1] op_sel_hi:[1,0,1] neg_lo:[1,0,0] neg_hi:[1,0,0]
    v_pk_fma_f32 v[170:171], v[242:243], v[18:19], v[18:19] op_sel:[0,0,1] op_sel_hi:[1,0,1] neg_lo:[1,0,0] neg_hi:[1,0,0]
    v_pk_fma_f32 v[172:173], v[244:245], v[18:19], v[18:19] op_sel:[0,0,1] op_sel_hi:[1,0,1] neg_lo:[1,0,0] neg_hi:[1,0,0]
    v_exp_f32 v160, v160
    v_exp_f32 v161, v161
    v_exp_f32 v162, v162
    v_exp_f32 v163, v163
    v_exp_f32 v164, v164
    v_exp_f32 v165, v165
    v_exp_f32 v166, v166
    v_exp_f32 v167, v167
    v_exp_f32 v168, v168
    v_exp_f32 v169, v169
    v_exp_f32 v170, v170
    v_exp_f32 v171, v171
    v_exp_f32 v172, v172
    v_exp_f32 v173, v173
    v_pk_add_f32 v[178:179], v[160:161], v[162:163]
    v_pk_add_f32 v[178:179], v[178:179], v[164:165]
    v_pk_add_f32 v[178:179], v[178:179], v[166:167]
    v_pk_add_f32 v[178:179], v[178:179], v[168:169]
    v_pk_add_f32 v[178:179], v[178:179], v[170:171]
    v_pk_add_f32 v[178:179], v[178:179], v[172:173]
    v_add_f32 v178, v178, v179
    v_mov_b32 v179, v178
    s_nop 1
    v_permlane32_swap_b32 v178, v179
    v_add_f32 v178, v178, v179
    v_rcp_f32 v178, v178
    s_nop 0
    v_mul_f32 v178, v178, v213
    v_pk_mul_f32 v[160:161], v[160:161], v[178:179] op_sel_hi:[1,0]
    v_pk_mul_f32 v[162:163], v[162:163], v[178:179] op_sel_hi:[1,0]
    v_pk_mul_f32 v[164:165], v[164:165], v[178:179] op_sel_hi:[1,0]
    v_pk_mul_f32 v[166:167], v[166:167], v[178:179] op_sel_hi:[1,0]
    v_pk_mul_f32 v[168:169], v[168:169], v[178:179] op_sel_hi:[1,0]
    v_pk_mul_f32 v[170:171], v[170:171], v[178:179] op_sel_hi:[1,0]
    v_pk_mul_f32 v[172:173], v[172:173], v[178:179] op_sel_hi:[1,0]
    v_cvt_pk_bf16_f32 v28, v160, v161
    v_cvt_pk_bf16_f32 v29, v162, v163
    v_cvt_pk_bf16_f32 v30, v164, v165
    v_cvt_pk_bf16_f32 v31, v166, v167
    v_cvt_pk_bf16_f32 v32, v168, v169
    v_cvt_pk_bf16_f32 v33, v170, v171
    v_cvt_pk_bf16_f32 v34, v172, v173
    v_mov_b32_e64 v35, 0
    v_mfma_f32_32x32x16_bf16 v[96:111], v[20:23], v[224:227], 0
    v_mfma_f32_32x32x16_bf16 v[96:111], v[24:27], v[228:231], v[96:111]
    v_mfma_f32_32x32x16_bf16 v[112:127], v[28:31], v[224:227], 0
    v_mfma_f32_32x32x16_bf16 v[112:127], v[32:35], v[228:231], v[112:127]
    s_nop 9
    s_nop 0
    v_cvt_pk_bf16_f32 v196, v96, v97
    v_cvt_pk_bf16_f32 v197, v98, v99
    v_cvt_pk_bf16_f32 v198, v100, v101
    v_cvt_pk_bf16_f32 v199, v102, v103
    v_cvt_pk_bf16_f32 v200, v104, v105
    v_cvt_pk_bf16_f32 v201, v106, v107
    v_cvt_pk_bf16_f32 v202, v108, v109
    v_cvt_pk_bf16_f32 v203, v110, v111
    v_mfma_f32_32x32x16_bf16 v[128:143], v[196:199], v[44:47], v[128:143]
    s_nop 0
    s_nop 0
    v_mfma_f32_32x32x16_bf16 v[128:143], v[200:203], v[48:51], v[128:143]
    v_cvt_pk_bf16_f32 v196, v112, v113
    v_cvt_pk_bf16_f32 v197, v114, v115
    v_cvt_pk_bf16_f32 v198, v116, v117
    v_cvt_pk_bf16_f32 v199, v118, v119
    v_cvt_pk_bf16_f32 v200, v120, v121
    v_cvt_pk_bf16_f32 v201, v122, v123
    v_cvt_pk_bf16_f32 v202, v124, v125
    v_cvt_pk_bf16_f32 v203, v126, v127
    v_mfma_f32_32x32x16_bf16 v[144:159], v[196:199], v[44:47], v[144:159]
    s_nop 0
    s_nop 0
    v_mfma_f32_32x32x16_bf16 v[144:159], v[200:203], v[48:51], v[144:159]
    v_cvt_pk_bf16_f32 v196, v64, v65
    v_cvt_pk_bf16_f32 v197, v66, v67
    v_cvt_pk_bf16_f32 v198, v68, v69
    v_cvt_pk_bf16_f32 v199, v70, v71
    v_cvt_pk_bf16_f32 v200, v72, v73
    v_cvt_pk_bf16_f32 v201, v74, v75
    v_cvt_pk_bf16_f32 v202, v76, v77
    v_cvt_pk_bf16_f32 v203, v78, v79
    s_cmp_eq_u32 s35, 0
    s_cbranch_scc1 .Lswap26
    s_nop 1
    v_swap_b32 v128, v144
    v_swap_b32 v129, v145
    v_swap_b32 v130, v146
    v_swap_b32 v131, v147
    v_swap_b32 v132, v148
    v_swap_b32 v133, v149
    v_swap_b32 v134, v150
    v_swap_b32 v135, v151
    v_swap_b32 v136, v152
    v_swap_b32 v137, v153
    v_swap_b32 v138, v154
    v_swap_b32 v139, v155
    v_swap_b32 v140, v156
    v_swap_b32 v141, v157
    v_swap_b32 v142, v158
    v_swap_b32 v143, v159
.Lswap26:
    s_nop 2
    s_lshl_b32 s31, s3, 12
    s_add_u32 s31, s31, 100352
    v_add_u32 v4, s31, v3
    s_xor_b32 s31, s3, 1
    s_lshl_b32 s31, s31, 12
    s_add_u32 s31, s31, 100352
    v_add_u32_e64 v5, s31, v3
    ds_write_b128 v4, v[144:147] offset:0
    ds_write_b128 v4, v[148:151] offset:1024
    ds_write_b128 v4, v[152:155] offset:2048
    ds_write_b128 v4, v[156:159] offset:3072
    v_mfma_f32_32x32x16_bf16 v[180:195], v[52:55], v[196:199], 0
    v_mfma_f32_32x32x16_bf16 v[180:195], v[56:59], v[200:203], v[180:195]
    v_cvt_pk_bf16_f32 v224, v80, v81
    v_cvt_pk_bf16_f32 v225, v82, v83
    v_cvt_pk_bf16_f32 v226, v84, v85
    v_cvt_pk_bf16_f32 v227, v86, v87
    v_cvt_pk_bf16_f32 v228, v88, v89
    v_cvt_pk_bf16_f32 v229, v90, v91
    v_cvt_pk_bf16_f32 v230, v92, v93
    v_cvt_pk_bf16_f32 v231, v94, v95
    s_waitcnt lgkmcnt(0)
    s_barrier
    ds_read_b128 v[144:147], v5 offset:0
    ds_read_b128 v[148:151], v5 offset:1024
    ds_read_b128 v[152:155], v5 offset:2048
    ds_read_b128 v[156:159], v5 offset:3072
    v_mfma_f32_32x32x16_bf16 v[232:247], v[52:55], v[224:227], 0
    v_mfma_f32_32x32x16_bf16 v[232:247], v[56:59], v[228:231], v[232:247]
    s_lshl_b32 s31, s46, 4
    s_add_u32 s31, s31, s90
    s_lshl_b32 s31, s31, 1
    s_add_u32 s31, s31, s35
    s_lshl_b32 s31, s31, 11
    s_add_u32 s31, s31, 4194304
    s_waitcnt lgkmcnt(3)
    v_add_f32 v128, v128, v144
    v_add_f32 v129, v129, v145
    v_add_f32 v130, v130, v146
    v_add_f32 v131, v131, v147
    s_waitcnt lgkmcnt(2)
    v_add_f32 v132, v132, v148
    v_add_f32 v133, v133, v149
    v_add_f32 v134, v134, v150
    v_add_f32 v135, v135, v151
    s_waitcnt lgkmcnt(1)
    v_add_f32 v136, v136, v152
    v_add_f32 v137, v137, v153
    v_add_f32 v138, v138, v154
    v_add_f32 v139, v139, v155
    s_waitcnt lgkmcnt(0)
    v_add_f32 v140, v140, v156
    v_add_f32 v141, v141, v157
    v_add_f32 v142, v142, v158
    v_add_f32_e64 v143, v143, v159
    v_cvt_pk_bf16_f32 v96, v128, v129
    v_cvt_pk_bf16_f32 v97, v130, v131
    v_cvt_pk_bf16_f32 v98, v132, v133
    v_cvt_pk_bf16_f32 v99, v134, v135
    v_cvt_pk_bf16_f32 v100, v136, v137
    v_cvt_pk_bf16_f32 v101, v138, v139
    v_cvt_pk_bf16_f32 v102, v140, v141
    v_cvt_pk_bf16_f32 v103, v142, v143
    buffer_store_dwordx4 v[96:99], v3, s[12:15], s31 offen offset:0 sc1
    buffer_store_dwordx4 v[100:103], v3, s[12:15], s31 offen offset:1024 sc1
    v_mul_f32 v18, 0x3fb8aa3b, v209
    v_max3_f32 v176, v180, v181, v182
    v_min3_f32 v177, v180, v181, v182
    v_max3_f32 v176, v176, v183, v184
    v_min3_f32 v177, v177, v183, v184
    v_max3_f32 v176, v176, v185, v186
    v_min3_f32 v177, v177, v185, v186
    v_max3_f32 v176, v176, v187, v188
    v_min3_f32 v177, v177, v187, v188
    v_max3_f32 v176, v176, v189, v190
    v_min3_f32 v177, v177, v189, v190
    v_max3_f32 v176, v176, v191, v192
    v_min3_f32 v177, v177, v191, v192
    v_max_f32 v176, v176, v193
    v_min_f32 v177, v177, v193
    v_mov_b32 v178, v176
    v_mov_b32 v179, v177
    s_nop 0
    v_permlane32_swap_b32 v176, v178
    v_permlane32_swap_b32 v177, v179
    v_max_f32 v176, v176, v178
    v_min_f32 v177, v177, v179
    v_mul_f32 v19, v18, v176
    v_pk_fma_f32 v[160:161], v[180:181], v[18:19], v[18:19] op_sel:[0,0,1] op_sel_hi:[1,0,1] neg_lo:[0,0,1] neg_hi:[0,0,1]
    v_pk_fma_f32 v[162:163], v[182:183], v[18:19], v[18:19] op_sel:[0,0,1] op_sel_hi:[1,0,1] neg_lo:[0,0,1] neg_hi:[0,0,1]
    v_pk_fma_f32 v[164:165], v[184:185], v[18:19], v[18:19] op_sel:[0,0,1] op_sel_hi:[1,0,1] neg_lo:[0,0,1] neg_hi:[0,0,1]
    v_pk_fma_f32 v[166:167], v[186:187], v[18:19], v[18:19] op_sel:[0,0,1] op_sel_hi:[1,0,1] neg_lo:[0,0,1] neg_hi:[0,0,1]
    v_pk_fma_f32 v[168:169], v[188:189], v[18:19], v[18:19] op_sel:[0,0,1] op_sel_hi:[1,0,1] neg_lo:[0,0,1] neg_hi:[0,0,1]
    v_pk_fma_f32 v[170:171], v[190:191], v[18:19], v[18:19] op_sel:[0,0,1] op_sel_hi:[1,0,1] neg_lo:[0,0,1] neg_hi:[0,0,1]
    v_pk_fma_f32 v[172:173], v[192:193], v[18:19], v[18:19] op_sel:[0,0,1] op_sel_hi:[1,0,1] neg_lo:[0,0,1] neg_hi:[0,0,1]
    v_exp_f32 v160, v160
    v_exp_f32 v161, v161
    v_exp_f32 v162, v162
    v_exp_f32 v163, v163
    v_exp_f32 v164, v164
    v_exp_f32 v165, v165
    v_exp_f32 v166, v166
    v_exp_f32 v167, v167
    v_exp_f32 v168, v168
    v_exp_f32 v169, v169
    v_exp_f32 v170, v170
    v_exp_f32 v171, v171
    v_exp_f32 v172, v172
    v_exp_f32 v173, v173
    v_pk_add_f32 v[178:179], v[160:161], v[162:163]
    v_pk_add_f32 v[178:179], v[178:179], v[164:165]
    v_pk_add_f32 v[178:179], v[178:179], v[166:167]
    v_pk_add_f32 v[178:179], v[178:179], v[168:169]
    v_pk_add_f32 v[178:179], v[178:179], v[170:171]
    v_pk_add_f32 v[178:179], v[178:179], v[172:173]
    v_add_f32 v178, v178, v179
    v_mov_b32 v179, v178
    s_nop 1
    v_permlane32_swap_b32 v178, v179
    v_add_f32 v178, v178, v179
    v_rcp_f32_e64 v178, v178
    s_nop 0
    v_pk_mul_f32 v[160:161], v[160:161], v[178:179] op_sel_hi:[1,0]
    v_pk_mul_f32 v[162:163], v[162:163], v[178:179] op_sel_hi:[1,0]
    v_pk_mul_f32 v[164:165], v[164:165], v[178:179] op_sel_hi:[1,0]
    v_pk_mul_f32 v[166:167], v[166:167], v[178:179] op_sel_hi:[1,0]
    v_pk_mul_f32 v[168:169], v[168:169], v[178:179] op_sel_hi:[1,0]
    v_pk_mul_f32 v[170:171], v[170:171], v[178:179] op_sel_hi:[1,0]
    v_pk_mul_f32 v[172:173], v[172:173], v[178:179] op_sel_hi:[1,0]
    v_cvt_pk_bf16_f32 v20, v160, v161
    v_cvt_pk_bf16_f32 v21, v162, v163
    v_cvt_pk_bf16_f32 v22, v164, v165
    v_cvt_pk_bf16_f32 v23, v166, v167
    v_cvt_pk_bf16_f32 v24, v168, v169
    v_cvt_pk_bf16_f32 v25, v170, v171
    v_cvt_pk_bf16_f32 v26, v172, v173
    v_mov_b32 v27, 0
    v_mul_f32 v19, v18, v177
    v_pk_fma_f32 v[160:161], v[180:181], v[18:19], v[18:19] op_sel:[0,0,1] op_sel_hi:[1,0,1] neg_lo:[1,0,0] neg_hi:[1,0,0]
    v_pk_fma_f32 v[162:163], v[182:183], v[18:19], v[18:19] op_sel:[0,0,1] op_sel_hi:[1,0,1] neg_lo:[1,0,0] neg_hi:[1,0,0]
    v_pk_fma_f32 v[164:165], v[184:185], v[18:19], v[18:19] op_sel:[0,0,1] op_sel_hi:[1,0,1] neg_lo:[1,0,0] neg_hi:[1,0,0]
    v_pk_fma_f32 v[166:167], v[186:187], v[18:19], v[18:19] op_sel:[0,0,1] op_sel_hi:[1,0,1] neg_lo:[1,0,0] neg_hi:[1,0,0]
    v_pk_fma_f32 v[168:169], v[188:189], v[18:19], v[18:19] op_sel:[0,0,1] op_sel_hi:[1,0,1] neg_lo:[1,0,0] neg_hi:[1,0,0]
    v_pk_fma_f32 v[170:171], v[190:191], v[18:19], v[18:19] op_sel:[0,0,1] op_sel_hi:[1,0,1] neg_lo:[1,0,0] neg_hi:[1,0,0]
    v_pk_fma_f32 v[172:173], v[192:193], v[18:19], v[18:19] op_sel:[0,0,1] op_sel_hi:[1,0,1] neg_lo:[1,0,0] neg_hi:[1,0,0]
    v_exp_f32 v160, v160
    v_exp_f32 v161, v161
    v_exp_f32 v162, v162
    v_exp_f32 v163, v163
    v_exp_f32 v164, v164
    v_exp_f32 v165, v165
    v_exp_f32 v166, v166
    v_exp_f32 v167, v167
    v_exp_f32 v168, v168
    v_exp_f32 v169, v169
    v_exp_f32 v170, v170
    v_exp_f32 v171, v171
    v_exp_f32 v172, v172
    v_exp_f32 v173, v173
    v_pk_add_f32 v[178:179], v[160:161], v[162:163]
    v_pk_add_f32 v[178:179], v[178:179], v[164:165]
    v_pk_add_f32 v[178:179], v[178:179], v[166:167]
    v_pk_add_f32 v[178:179], v[178:179], v[168:169]
    v_pk_add_f32 v[178:179], v[178:179], v[170:171]
    v_pk_add_f32 v[178:179], v[178:179], v[172:173]
    v_add_f32 v178, v178, v179
    v_mov_b32 v179, v178
    s_nop 1
    v_permlane32_swap_b32 v178, v179
    v_add_f32 v178, v178, v179
    v_rcp_f32_e64 v178, v178
    s_nop 0
    v_pk_mul_f32 v[160:161], v[160:161], v[178:179] op_sel_hi:[1,0]
    v_pk_mul_f32 v[162:163], v[162:163], v[178:179] op_sel_hi:[1,0]
    v_pk_mul_f32 v[164:165], v[164:165], v[178:179] op_sel_hi:[1,0]
    v_pk_mul_f32 v[166:167], v[166:167], v[178:179] op_sel_hi:[1,0]
    v_pk_mul_f32 v[168:169], v[168:169], v[178:179] op_sel_hi:[1,0]
    v_pk_mul_f32 v[170:171], v[170:171], v[178:179] op_sel_hi:[1,0]
    v_pk_mul_f32 v[172:173], v[172:173], v[178:179] op_sel_hi:[1,0]
    v_cvt_pk_bf16_f32 v28, v160, v161
    v_cvt_pk_bf16_f32 v29, v162, v163
    v_cvt_pk_bf16_f32 v30, v164, v165
    v_cvt_pk_bf16_f32 v31, v166, v167
    v_cvt_pk_bf16_f32 v32, v168, v169
    v_cvt_pk_bf16_f32 v33, v170, v171
    v_cvt_pk_bf16_f32 v34, v172, v173
    v_mov_b32 v35, 0
    s_waitcnt vmcnt(0)
    s_barrier
    s_cmp_lg_u32 s3, 0
    s_cbranch_scc1 .Lpub27
    s_lshl_b32 s31, s45, 7
    s_add_u32 s31, s31, 6356992
    v_mov_b32 v10, s30
    v_mov_b32_e64 v11, s31
    s_mov_b64 exec, 1
    buffer_store_dword v10, v11, s[12:15], 0 offen sc1
    s_mov_b64 exec, -1
.Lpub27:
    s_mov_b32 s20, s66
    s_mov_b32 s21, s67
    s_mov_b32 s22, 0x62000
    s_mov_b32 s23, 0x00020000
    s_lshr_b32 s31, s29, 2
    s_lshl_b32 s31, s31, 7
    s_mul_i32 s88, s3, 7168
    s_add_u32 s88, s88, s31
    s_lshl_b32 s89, s3, 10
    s_nop 0
    s_add_u32 s89, s89, 100352
    v_mul_f32 v18, 0x3fb8aa3b, v213
    v_max3_f32 v176, v232, v233, v234
    v_min3_f32 v177, v232, v233, v234
    v_max3_f32 v176, v176, v235, v236
    v_min3_f32 v177, v177, v235, v236
    v_max3_f32 v176, v176, v237, v238
    s_add_u32 m0, s89, 0
    s_add_u32 s33, s88, 0
    buffer_load_dwordx4 v14, s[20:23], s33 offen lds
    v_min3_f32 v177, v177, v237, v238
    v_max3_f32 v176, v176, v239, v240
    v_min3_f32 v177, v177, v239, v240
    v_max3_f32 v176, v176, v241, v242
    v_min3_f32 v177, v177, v241, v242
    v_max3_f32 v176, v176, v243, v244
    s_add_u32 m0, s89, 4096
    s_add_u32 s33, s88, 28672
    buffer_load_dwordx4 v14, s[20:23], s33 offen lds
    v_min3_f32 v177, v177, v243, v244
    v_max_f32 v176, v176, v245
    v_min_f32 v177, v177, v245
    v_mov_b32 v178, v176
    v_mov_b32 v179, v177
    s_nop 0
    v_permlane32_swap_b32 v176, v178
    s_add_u32 m0, s89, 8192
    s_add_u32 s33, s88, 57344
    buffer_load_dwordx4 v14, s[20:23], s33 offen lds
    v_permlane32_swap_b32 v177, v179
    v_max_f32 v176, v176, v178
    v_min_f32 v177, v177, v179
    v_mul_f32 v19, v18, v176
    v_pk_fma_f32 v[160:161], v[232:233], v[18:19], v[18:19] op_sel:[0,0,1] op_sel_hi:[1,0,1] neg_lo:[0,0,1] neg_hi:[0,0,1]
    v_pk_fma_f32 v[162:163], v[234:235], v[18:19], v[18:19] op_sel:[0,0,1] op_sel_hi:[1,0,1] neg_lo:[0,0,1] neg_hi:[0,0,1]
    s_add_u32 m0, s89, 12288
    s_add_u32 s33, s88, 86016
    buffer_load_dwordx4 v14, s[20:23], s33 offen lds
    v_pk_fma_f32 v[164:165], v[236:237], v[18:19], v[18:19] op_sel:[0,0,1] op_sel_hi:[1,0,1] neg_lo:[0,0,1] neg_hi:[0,0,1]
    v_pk_fma_f32 v[166:167], v[238:239], v[18:19], v[18:19] op_sel:[0,0,1] op_sel_hi:[1,0,1] neg_lo:[0,0,1] neg_hi:[0,0,1]
    v_pk_fma_f32 v[168:169], v[240:241], v[18:19], v[18:19] op_sel:[0,0,1] op_sel_hi:[1,0,1] neg_lo:[0,0,1] neg_hi:[0,0,1]
    v_pk_fma_f32 v[170:171], v[242:243], v[18:19], v[18:19] op_sel:[0,0,1] op_sel_hi:[1,0,1] neg_lo:[0,0,1] neg_hi:[0,0,1]
    v_pk_fma_f32 v[172:173], v[244:245], v[18:19], v[18:19] op_sel:[0,0,1] op_sel_hi:[1,0,1] neg_lo:[0,0,1] neg_hi:[0,0,1]
    v_exp_f32_e64 v160, v160
    s_add_u32 m0, s89, 16384
    s_add_u32 s33, s88, 114688
    buffer_load_dwordx4 v14, s[20:23], s33 offen lds
    v_exp_f32 v161, v161
    v_exp_f32 v162, v162
    v_exp_f32 v163, v163
    v_exp_f32 v164, v164
    v_exp_f32 v165, v165
    v_exp_f32 v166, v166
    s_add_u32 m0, s89, 20480
    s_add_u32 s33, s88, 143360
    buffer_load_dwordx4 v14, s[20:23], s33 offen lds
    v_exp_f32 v167, v167
    v_exp_f32 v168, v168
    v_exp_f32 v169, v169
    v_exp_f32 v170, v170
    v_exp_f32 v171, v171
    v_exp_f32 v172, v172
    s_add_u32 m0, s89, 24576
    s_add_u32 s33, s88, 172032
    buffer_load_dwordx4 v14, s[20:23], s33 offen lds
    v_exp_f32_e64 v173, v173
    v_pk_add_f32 v[178:179], v[160:161], v[162:163]
    v_pk_add_f32 v[178:179], v[178:179], v[164:165]
    v_pk_add_f32 v[178:179], v[178:179], v[166:167]
    v_pk_add_f32 v[178:179], v[178:179], v[168:169]
    v_pk_add_f32 v[178:179], v[178:179], v[170:171]
    s_add_u32 m0, s89, 28672
    s_add_u32 s33, s88, 200704
    buffer_load_dwordx4 v14, s[20:23], s33 offen lds
    v_pk_add_f32 v[178:179], v[178:179], v[172:173]
    v_add_f32 v178, v178, v179
    v_mov_b32 v179, v178
    s_nop 1
    v_permlane32_swap_b32 v178, v179
    v_add_f32 v178, v178, v179
    v_rcp_f32 v178, v178
    s_add_u32 m0, s89, 32768
    s_add_u32 s33, s88, 229376
    buffer_load_dwordx4 v14, s[20:23], s33 offen lds
    v_pk_mul_f32 v[160:161], v[160:161], v[178:179] op_sel_hi:[1,0]
    v_pk_mul_f32 v[162:163], v[162:163], v[178:179] op_sel_hi:[1,0]
    v_pk_mul_f32 v[164:165], v[164:165], v[178:179] op_sel_hi:[1,0]
    v_pk_mul_f32 v[166:167], v[166:167], v[178:179] op_sel_hi:[1,0]
    v_pk_mul_f32 v[168:169], v[168:169], v[178:179] op_sel_hi:[1,0]
    v_pk_mul_f32 v[170:171], v[170:171], v[178:179] op_sel_hi:[1,0]
    s_add_u32 m0, s89, 36864
    s_add_u32 s33, s88, 258048
    buffer_load_dwordx4 v14, s[20:23], s33 offen lds
    v_pk_mul_f32 v[172:173], v[172:173], v[178:179] op_sel_hi:[1,0]
    v_cvt_pk_bf16_f32 v36, v160, v161
    v_cvt_pk_bf16_f32 v37, v162, v163
    v_cvt_pk_bf16_f32 v38, v164, v165
    v_cvt_pk_bf16_f32 v39, v166, v167
    v_cvt_pk_bf16_f32 v40, v168, v169
    s_add_u32 m0, s89, 40960
    s_add_u32 s33, s88, 286720
    buffer_load_dwordx4 v14, s[20:23], s33 offen lds
    v_cvt_pk_bf16_f32 v41, v170, v171
    v_cvt_pk_bf16_f32 v42, v172, v173
    v_mov_b32 v43, 0
    v_mul_f32 v19, v18, v177
    v_pk_fma_f32 v[160:161], v[232:233], v[18:19], v[18:19] op_sel:[0,0,1] op_sel_hi:[1,0,1] neg_lo:[1,0,0] neg_hi:[1,0,0]
    v_pk_fma_f32 v[162:163], v[234:235], v[18:19], v[18:19] op_sel:[0,0,1] op_sel_hi:[1,0,1] neg_lo:[1,0,0] neg_hi:[1,0,0]
    s_add_u32 m0, s89, 45056
    s_add_u32 s33, s88, 315392
    buffer_load_dwordx4 v14, s[20:23], s33 offen lds
    v_pk_fma_f32 v[164:165], v[236:237], v[18:19], v[18:19] op_sel:[0,0,1] op_sel_hi:[1,0,1] neg_lo:[1,0,0] neg_hi:[1,0,0]
    v_pk_fma_f32 v[166:167], v[238:239], v[18:19], v[18:19] op_sel:[0,0,1] op_sel_hi:[1,0,1] neg_lo:[1,0,0] neg_hi:[1,0,0]
    v_pk_fma_f32 v[168:169], v[240:241], v[18:19], v[18:19] op_sel:[0,0,1] op_sel_hi:[1,0,1] neg_lo:[1,0,0] neg_hi:[1,0,0]
    v_pk_fma_f32 v[170:171], v[242:243], v[18:19], v[18:19] op_sel:[0,0,1] op_sel_hi:[1,0,1] neg_lo:[1,0,0] neg_hi:[1,0,0]
    v_pk_fma_f32 v[172:173], v[244:245], v[18:19], v[18:19] op_sel:[0,0,1] op_sel_hi:[1,0,1] neg_lo:[1,0,0] neg_hi:[1,0,0]
    v_exp_f32_e64 v160, v160
    s_add_u32 m0, s89, 49152
    s_add_u32 s33, s88, 344064
    buffer_load_dwordx4 v14, s[20:23], s33 offen lds
    v_exp_f32 v161, v161
    v_exp_f32 v162, v162
    v_exp_f32 v163, v163
    v_exp_f32 v164, v164
    v_exp_f32 v165, v165
    v_exp_f32 v166, v166
    s_add_u32 m0, s89, 53248
    s_add_u32 s33, s88, 372736
    buffer_load_dwordx4 v14, s[20:23], s33 offen lds
    v_exp_f32 v167, v167
    v_exp_f32 v168, v168
    v_exp_f32 v169, v169
    v_exp_f32 v170, v170
    v_exp_f32 v171, v171
    v_exp_f32 v172, v172
    v_exp_f32_e64 v173, v173
    v_pk_add_f32 v[178:179], v[160:161], v[162:163]
    v_pk_add_f32 v[178:179], v[178:179], v[164:165]
    v_pk_add_f32 v[178:179], v[178:179], v[166:167]
    v_pk_add_f32 v[178:179], v[178:179], v[168:169]
    v_pk_add_f32 v[178:179], v[178:179], v[170:171]
    v_pk_add_f32 v[178:179], v[178:179], v[172:173]
    v_add_f32 v178, v178, v179
    v_mov_b32 v179, v178
    s_nop 1
    v_permlane32_swap_b32 v178, v179
    v_add_f32 v178, v178, v179
    v_rcp_f32_e64 v178, v178
    s_nop 0
    v_pk_mul_f32 v[160:161], v[160:161], v[178:179] op_sel_hi:[1,0]
    v_pk_mul_f32 v[162:163], v[162:163], v[178:179] op_sel_hi:[1,0]
    v_pk_mul_f32 v[164:165], v[164:165], v[178:179] op_sel_hi:[1,0]
    v_pk_mul_f32 v[166:167], v[166:167], v[178:179] op_sel_hi:[1,0]
    v_pk_mul_f32 v[168:169], v[168:169], v[178:179] op_sel_hi:[1,0]
    v_pk_mul_f32 v[170:171], v[170:171], v[178:179] op_sel_hi:[1,0]
    v_pk_mul_f32 v[172:173], v[172:173], v[178:179] op_sel_hi:[1,0]
    v_cvt_pk_bf16_f32 v44, v160, v161
    v_cvt_pk_bf16_f32 v45, v162, v163
    v_cvt_pk_bf16_f32 v46, v164, v165
    v_cvt_pk_bf16_f32 v47, v166, v167
    v_cvt_pk_bf16_f32 v48, v168, v169
    v_cvt_pk_bf16_f32 v49, v170, v171
    v_cvt_pk_bf16_f32 v50, v172, v173
    v_mov_b32 v51, 0
    s_barrier
    s_branch .Ls34
.Lspare3:
    v_lshlrev_b32 v3, 4, v1
    v_and_b32 v12, 31, v1
    v_lshrrev_b32_e64 v13, 5, v1
    s_waitcnt lgkmcnt(0)
    s_mov_b32 s12, s82
    s_mov_b32 s13, s83
    s_mov_b32 s14, 0x3000000
    s_mov_b32 s15, 0x00020000
    s_sub_u32 s37, s2, 240
    s_mov_b32 s20, s70
    s_mov_b32 s21, s71
    s_mov_b32 s22, 0x62000
    s_mov_b32 s23, 0x00020000
    s_lshl_b32 s35, s37, 2
    s_add_u32 s35, s35, s3
    s_mul_i32 s35, s35, 6272
    v_lshlrev_b32 v54, 7, v1
    v_cmp_gt_u32 vcc, 49, v1
    v_mov_b32 v11, 0x7fff0000
    s_nop 0
    v_cndmask_b32 v10, v11, v54, vcc
    buffer_load_dword v2, v10, s[20:23], s35 offen
    s_cmp_lg_u32 s3, 3
    s_cbranch_scc1 .Ltlb30
    v_lshlrev_b32_e64 v9, 21, v1
    s_mov_b64 exec, 0x1ff
    buffer_load_dword v2, v9, s[12:15], 0 offen
    s_mov_b64 exec, 1
    s_mov_b32 s24, s80
    s_mov_b32 s25, s81
    s_mov_b32 s26, 0x100
    s_mov_b32 s27, 0x00020000
    buffer_load_dword v2, v9, s[24:27], 0 offen offset:128
    s_mov_b32 s24, s72
    s_mov_b32 s25, s73
    s_mov_b32 s26, 0x62000
    s_mov_b32 s27, 0x00020000
    buffer_load_dword v2, v9, s[24:27], 0 offen offset:128
    s_mov_b32 s24, s74
    s_mov_b32 s25, s75
    s_mov_b32 s26, 0x188000
    s_mov_b32 s27, 0x00020000
    buffer_load_dword v2, v9, s[24:27], 0 offen offset:128
    s_mov_b32 s24, s64
    s_mov_b32 s25, s65
    s_mov_b32 s26, 0x6200
    s_mov_b32 s27, 0x00020000
    buffer_load_dword v2, v9, s[24:27], 0 offen offset:128
    s_mov_b32 s24, s76
    s_mov_b32 s25, s77
    s_mov_b32 s26, 0x188000
    s_mov_b32 s27, 0x00020000
    buffer_load_dword v2, v9, s[24:27], 0 offen offset:128
    s_mov_b32 s24, s66
    s_mov_b32 s25, s67
    s_mov_b32 s26, 0x62000
    s_mov_b32 s27, 0x00020000
    buffer_load_dword v2, v9, s[24:27], 0 offen offset:128
    s_mov_b32 s24, s78
    s_mov_b32 s25, s79
    s_mov_b32 s26, 0x1c0000
    s_mov_b32 s27, 0x00020000
    buffer_load_dword v2, v9, s[24:27], 0 offen offset:128
    s_mov_b64 exec, -1
.Ltlb30:
    s_cmp_ge_u32 s37, 12
    s_cbranch_scc1 .Lpf28
    s_mov_b32 s8, s62
    s_mov_b32 s9, s63
    s_mov_b32 s10, 0x126000
    s_mov_b32 s11, 0x00020000
    s_mul_i32 s38, s3, 25088
    s_mov_b32 s31, 2688
    s_mul_i32 s32, s37, 224
    v_mul_u32_u24 v4, 4682, v1
    v_lshrrev_b32 v4, 16, v4
    v_mul_u32_u24 v5, 14, v4
    v_sub_u32 v5, v1, v5
    v_lshrrev_b32 v6, 1, v4
    v_and_b32_e64 v4, 1, v4
    v_lshl_add_u32 v4, v4, 2, v6
    v_mul_lo_u32 v4, v4, s31
    v_lshl_add_u32 v4, v5, 4, v4
    v_cmp_gt_u32 vcc, 7, v5
    v_mov_b32 v5, s32
    v_mov_b32 v6, s32
    v_cndmask_b32 v5, v6, v5, vcc
    v_add_u32_e64 v18, v4, v5
    s_mul_i32 s36, s3, 301056
    s_mov_b32 exec_hi, 0x00ffffff
    s_add_u32 m0, s38, 0
    s_add_u32 s33, s36, 0
    buffer_load_dwordx4 v18, s[8:11], s33 offen lds
    s_add_u32 m0, s38, 896
    s_add_u32 s33, s36, 5376
    buffer_load_dwordx4 v18, s[8:11], s33 offen lds
    s_add_u32 m0, s38, 1792
    s_add_u32 s33, s36, 21504
    buffer_load_dwordx4 v18, s[8:11], s33 offen lds
    s_add_u32 m0, s38, 2688
    s_add_u32 s33, s36, 26880
    buffer_load_dwordx4 v18, s[8:11], s33 offen lds
    s_add_u32 m0, s38, 3584
    s_add_u32 s33, s36, 43008
    buffer_load_dwordx4 v18, s[8:11], s33 offen lds
    s_add_u32 m0, s38, 4480
    s_add_u32 s33, s36, 48384
    buffer_load_dwordx4 v18, s[8:11], s33 offen lds
    s_add_u32 m0, s38, 5376
    s_add_u32 s33, s36, 64512
    buffer_load_dwordx4 v18, s[8:11], s33 offen lds
    s_add_u32 m0, s38, 6272
    s_add_u32 s33, s36, 69888
    buffer_load_dwordx4 v18, s[8:11], s33 offen lds
    s_add_u32 m0, s38, 7168
    s_add_u32 s33, s36, 86016
    buffer_load_dwordx4 v18, s[8:11], s33 offen lds
    s_add_u32 m0, s38, 8064
    s_add_u32 s33, s36, 91392
    buffer_load_dwordx4 v18, s[8:11], s33 offen lds
    s_add_u32 m0, s38, 8960
    s_add_u32 s33, s36, 107520
    buffer_load_dwordx4 v18, s[8:11], s33 offen lds
    s_add_u32 m0, s38, 9856
    s_add_u32 s33, s36, 112896
    buffer_load_dwordx4 v18, s[8:11], s33 offen lds
    s_add_u32 m0, s38, 10752
    s_add_u32 s33, s36, 129024
    buffer_load_dwordx4 v18, s[8:11], s33 offen lds
    s_add_u32 m0, s38, 11648
    s_add_u32 s33, s36, 134400
    buffer_load_dwordx4 v18, s[8:11], s33 offen lds
    s_add_u32 m0, s38, 12544
    s_add_u32 s33, s36, 150528
    buffer_load_dwordx4 v18, s[8:11], s33 offen lds
    s_add_u32 m0, s38, 13440
    s_add_u32 s33, s36, 155904
    buffer_load_dwordx4 v18, s[8:11], s33 offen lds
    s_add_u32 m0, s38, 14336
    s_add_u32 s33, s36, 172032
    buffer_load_dwordx4 v18, s[8:11], s33 offen lds
    s_add_u32 m0, s38, 15232
    s_add_u32 s33, s36, 177408
    buffer_load_dwordx4 v18, s[8:11], s33 offen lds
    s_add_u32 m0, s38, 16128
    s_add_u32 s33, s36, 193536
    buffer_load_dwordx4 v18, s[8:11], s33 offen lds
    s_add_u32 m0, s38, 17024
    s_add_u32 s33, s36, 198912
    buffer_load_dwordx4 v18, s[8:11], s33 offen lds
    s_add_u32 m0, s38, 17920
    s_add_u32 s33, s36, 215040
    buffer_load_dwordx4 v18, s[8:11], s33 offen lds
    s_add_u32 m0, s38, 18816
    s_add_u32 s33, s36, 220416
    buffer_load_dwordx4 v18, s[8:11], s33 offen lds
    s_add_u32 m0, s38, 19712
    s_add_u32 s33, s36, 236544
    buffer_load_dwordx4 v18, s[8:11], s33 offen lds
    s_add_u32 m0, s38, 20608
    s_add_u32 s33, s36, 241920
    buffer_load_dwordx4 v18, s[8:11], s33 offen lds
    s_add_u32 m0, s38, 21504
    s_add_u32 s33, s36, 258048
    buffer_load_dwordx4 v18, s[8:11], s33 offen lds
    s_add_u32 m0, s38, 22400
    s_add_u32 s33, s36, 263424
    buffer_load_dwordx4 v18, s[8:11], s33 offen lds
    s_add_u32 m0, s38, 23296
    s_add_u32 s33, s36, 279552
    buffer_load_dwordx4 v18, s[8:11], s33 offen lds
    s_add_u32 m0, s38, 24192
    s_add_u32 s33, s36, 284928
    buffer_load_dwordx4 v18, s[8:11], s33 offen lds
    s_mov_b32 exec_hi, -1
    s_branch .Lsj29
.Lpf28:
    s_sub_u32 s35, s37, 12
    s_lshl_b32 s35, s35, 2
    s_add_u32 s35, s35, s3
    v_lshlrev_b32_e64 v54, 7, v1
    s_lshl_b32 s35, s35, 13
    s_mov_b32 s20, s72
    s_mov_b32 s21, s73
    s_mov_b32 s22, 0x62000
    s_mov_b32 s23, 0x00020000
    s_add_u32 s31, s35, 0
    s_nop 0
    buffer_load_dword v2, v54, s[20:23], s31 offen
    s_add_u32 s31, s35, 131072
    buffer_load_dword v2, v54, s[20:23], s31 offen
    s_add_u32 s31, s35, 262144
    buffer_load_dword v2, v54, s[20:23], s31 offen
    s_add_u32 s31, s35, 393216
    buffer_load_dword v2, v54, s[20:23], s31 offen
    s_mov_b32 s20, s64
    s_mov_b32 s21, s65
    s_mov_b32 s22, 0x6200
    s_mov_b32 s23, 0x00020000
    buffer_load_dword v2, v54, s[20:23], s35 offen
    s_add_u32 s31, s35, 6356992
    buffer_load_dword v2, v54, s[12:15], s31 offen
    s_lshr_b32 s31, s35, 1
    s_add_u32 s31, s31, 6488064
    v_lshlrev_b32 v4, 7, v12
    buffer_load_dword v2, v4, s[12:15], s31 offen
.Lsj29:
    s_mov_b32 s16, s80
    s_mov_b32 s17, s81
    s_mov_b32 s18, 0x100
    s_mov_b32 s19, 0x00020000
    v_mov_b32_e64 v11, 0
    buffer_load_dword v17, v11, s[16:19], 0 offen sc1
    v_bfe_u32 v5, v1, 2, 2
    v_lshl_add_u32 v5, v5, 1, v13
    v_mul_u32_u24 v4, 96, v5
    v_mul_u32_u24 v5, 224, v5
    v_bfe_u32 v6, v1, 4, 1
    v_lshlrev_b32 v6, 5, v6
    v_and_b32 v7, 3, v1
    v_lshl_add_u32 v6, v7, 3, v6
    s_lshl_b32 s31, s3, 6
    v_add_u32 v7, s31, v6
    v_min_u32 v7, 216, v7
    v_add_u32_e64 v19, v7, v5
    v_add_u32 v52, 57344, v19
    v_add_u32 v7, 57216, v7
    v_add_u32_e64 v54, v7, v4
    v_bfe_u32 v4, v1, 2, 2
    v_lshrrev_b32_e64 v5, 5, v1
    v_lshl_add_u32 v4, v5, 2, v4
    v_lshlrev_b32_e64 v4, 7, v4
    v_bfe_u32 v5, v1, 3, 1
    v_lshl_add_u32 v4, v5, 6, v4
    v_bfe_u32 v5, v1, 4, 1
    v_lshl_add_u32 v4, v5, 5, v4
    v_and_b32_e64 v5, 3, v1
    v_lshl_add_u32 v18, v5, 3, v4
    v_xor_b32 v18, s31, v18
    v_lshrrev_b32 v6, 2, v1
    v_lshrrev_b32 v7, 4, v1
    v_xor_b32 v6, v6, v7
    v_and_b32 v6, 1, v6
    v_and_b32 v7, 3, v1
    v_or_b32 v6, v6, v7
    v_cmp_eq_u32 vcc, 0, v6
    v_mov_b32 v7, 0x3f803f80
    s_nop 0
    v_cndmask_b32 v56, 0, v7, vcc
    v_mov_b32 v57, v56
    v_mov_b32 v58, v56
    v_mov_b32 v59, v56
    s_lshl_b32 s31, s3, 5
    v_add_u32_e64 v4, s31, v12
    v_lshl_add_u32 v5, v13, 7, v4
    v_cmp_gt_u32 vcc, 112, v5
    v_lshlrev_b32_e64 v4, 3, v4
    v_mov_b32 v53, 0x7fff0000
    v_cndmask_b32 v53, v53, v4, vcc
    s_mov_b32 s31, 0
    v_lshrrev_b32_e64 v4, 3, v1
    v_mul_u32_u24 v4, 896, v4
    v_bfe_u32 v5, v1, 4, 1
    v_lshlrev_b32 v5, 2, v5
    v_and_b32 v6, 7, v1
    v_xor_b32_e64 v5, v5, v6
    v_lshl_add_u32 v4, v5, 4, v4
    v_add_u32_e64 v14, s31, v4
    s_mov_b32 s24, s74
    s_mov_b32 s25, s75
    s_mov_b32 s26, 0x188000
    s_mov_b32 s27, 0x00020000
    s_and_b32 s31, s28, 1
    s_lshl_b32 s31, s31, 3
    s_and_b32 s32, s28, 6
    s_add_u32 s32, s32, s29
    s_and_b32 s32, s32, 7
    s_add_u32 s93, s32, s31
    s_mul_i32 s32, s93, 224
    v_lshrrev_b32_e64 v4, 3, v1
    v_mul_u32_u24 v4, 3584, v4
    v_bfe_u32 v5, v1, 4, 1
    v_lshlrev_b32 v5, 2, v5
    v_and_b32 v6, 7, v1
    v_xor_b32_e64 v5, v5, v6
    v_lshl_add_u32 v15, v5, 4, v4
    v_mul_u32_u24 v4, 43, v1
    v_lshrrev_b32 v4, 8, v4
    v_mul_u32_u24 v5, 6, v4
    v_sub_u32 v5, v1, v5
    v_lshrrev_b32 v6, 1, v4
    v_and_b32 v4, 1, v4
    v_lshl_add_u32 v4, v4, 2, v6
    v_mul_u32_u24 v4, 3584, v4
    v_lshl_add_u32 v4, v5, 4, v4
    v_add_u32 v16, 128, v4
    s_mul_i32 s86, s3, 28672
    s_add_u32 s86, s86, s32
    s_lshl_b32 s87, s3, 10
    s_mul_i32 s92, s3, 768
    s_add_u32 s92, s92, 57344
    v_mov_b32 v4, 0
    v_lshlrev_b32 v5, 2, v0
    v_add_u32 v5, 157696, v5
    ds_write_b32 v5, v4
    s_lshl_b32 s31, s3, 2
    s_add_u32 s31, s31, 163824
    v_mov_b32 v5, s31
    ds_write_b32 v5, v4
    s_waitcnt vmcnt(0)
    v_readfirstlane_b32 s30, v17
    s_nop 1
    s_cmp_lg_u32 s30, 0
    s_cbranch_scc1 .Lnonce31
    v_mov_b32 v11, 0
    s_waitcnt lgkmcnt(0)
    s_mov_b32 s34, 0
.Lspin32:
    buffer_load_dword v17, v11, s[16:19], 0 offen sc1
    s_add_u32 s34, s34, 1
    s_waitcnt vmcnt(0)
    v_cmp_eq_u32_e64 vcc, 0, v17
    s_cmp_ge_u32 s34, 200000
    s_cbranch_scc1 .Lspun33
    s_cbranch_vccnz .Lspin32
.Lspun33:
    s_nop 1
    v_readfirstlane_b32 s30, v17
    s_nop 3
.Lnonce31:
    s_waitcnt lgkmcnt(0)
    s_barrier
    s_cmp_ge_u32 s37, 12
    s_cbranch_scc1 .Lnoq34
    s_nop 0
    ds_read_b64_tr_b16 v[64:65], v19 offset:0
    ds_read_b64_tr_b16 v[66:67], v19 offset:1792
    ds_read_b64_tr_b16 v[68:69], v19 offset:3584
    ds_read_b64_tr_b16 v[70:71], v19 offset:5376
    ds_read_b64_tr_b16 v[72:73], v19 offset:7168
    ds_read_b64_tr_b16 v[74:75], v19 offset:8960
    ds_read_b64_tr_b16 v[76:77], v19 offset:10752
    ds_read_b64_tr_b16 v[78:79], v19 offset:12544
    ds_read_b64_tr_b16 v[80:81], v19 offset:14336
    ds_read_b64_tr_b16 v[82:83], v19 offset:16128
    ds_read_b64_tr_b16 v[84:85], v19 offset:17920
    ds_read_b64_tr_b16 v[86:87], v19 offset:19712
    s_waitcnt lgkmcnt(10)
    v_mfma_f32_16x16x32_bf16 v[60:63], v[56:59], v[64:67], 0
    ds_read_b64_tr_b16 v[88:89], v19 offset:21504
    ds_read_b64_tr_b16 v[90:91], v19 offset:23296
    s_waitcnt lgkmcnt(10)
    v_mfma_f32_16x16x32_bf16 v[60:63], v[56:59], v[68:71], v[60:63]
    ds_read_b64_tr_b16 v[92:93], v19 offset:25088
    ds_read_b64_tr_b16 v[94:95], v19 offset:26880
    s_waitcnt lgkmcnt(10)
    v_mfma_f32_16x16x32_bf16 v[60:63], v[56:59], v[72:75], v[60:63]
    ds_read_b64_tr_b16 v[64:65], v19 offset:28672
    ds_read_b64_tr_b16 v[66:67], v19 offset:30464
    s_waitcnt lgkmcnt(10)
    v_mfma_f32_16x16x32_bf16 v[60:63], v[56:59], v[76:79], v[60:63]
    ds_read_b64_tr_b16 v[68:69], v19 offset:32256
    ds_read_b64_tr_b16 v[70:71], v19 offset:34048
    s_waitcnt lgkmcnt(10)
    v_mfma_f32_16x16x32_bf16 v[60:63], v[56:59], v[80:83], v[60:63]
    ds_read_b64_tr_b16 v[72:73], v19 offset:35840
    ds_read_b64_tr_b16 v[74:75], v19 offset:37632
    s_waitcnt lgkmcnt(10)
    v_mfma_f32_16x16x32_bf16 v[60:63], v[56:59], v[84:87], v[60:63]
    ds_read_b64_tr_b16 v[76:77], v19 offset:39424
    ds_read_b64_tr_b16 v[78:79], v19 offset:41216
    s_waitcnt lgkmcnt(10)
    v_mfma_f32_16x16x32_bf16 v[60:63], v[56:59], v[88:91], v[60:63]
    ds_read_b64_tr_b16 v[80:81], v19 offset:43008
    ds_read_b64_tr_b16 v[82:83], v19 offset:44800
    s_waitcnt lgkmcnt(10)
    v_mfma_f32_16x16x32_bf16 v[60:63], v[56:59], v[92:95], v[60:63]
    ds_read_b64_tr_b16 v[84:85], v19 offset:46592
    ds_read_b64_tr_b16 v[86:87], v19 offset:48384
    s_waitcnt lgkmcnt(10)
    v_mfma_f32_16x16x32_bf16 v[60:63], v[56:59], v[64:67], v[60:63]
    ds_read_b64_tr_b16 v[88:89], v19 offset:50176
    ds_read_b64_tr_b16 v[90:91], v19 offset:51968
    s_waitcnt lgkmcnt(10)
    v_mfma_f32_16x16x32_bf16 v[60:63], v[56:59], v[68:71], v[60:63]
    ds_read_b64_tr_b16 v[92:93], v19 offset:53760
    ds_read_b64_tr_b16 v[94:95], v19 offset:55552
    s_waitcnt lgkmcnt(10)
    v_mfma_f32_16x16x32_bf16 v[60:63], v[56:59], v[72:75], v[60:63]
    ds_read_b64_tr_b16 v[64:65], v52 offset:0
    ds_read_b64_tr_b16 v[66:67], v52 offset:1792
    s_waitcnt lgkmcnt(10)
    v_mfma_f32_16x16x32_bf16 v[60:63], v[56:59], v[76:79], v[60:63]
    ds_read_b64_tr_b16 v[68:69], v52 offset:3584
    ds_read_b64_tr_b16 v[70:71], v52 offset:5376
    s_waitcnt lgkmcnt(10)
    v_mfma_f32_16x16x32_bf16 v[60:63], v[56:59], v[80:83], v[60:63]
    ds_read_b64_tr_b16 v[72:73], v52 offset:7168
    ds_read_b64_tr_b16 v[74:75], v52 offset:8960
    s_waitcnt lgkmcnt(10)
    v_mfma_f32_16x16x32_bf16 v[60:63], v[56:59], v[84:87], v[60:63]
    ds_read_b64_tr_b16 v[76:77], v52 offset:10752
    ds_read_b64_tr_b16 v[78:79], v52 offset:12544
    s_waitcnt lgkmcnt(10)
    v_mfma_f32_16x16x32_bf16 v[60:63], v[56:59], v[88:91], v[60:63]
    ds_read_b64_tr_b16 v[80:81], v52 offset:14336
    ds_read_b64_tr_b16 v[82:83], v52 offset:16128
    s_waitcnt lgkmcnt(10)
    v_mfma_f32_16x16x32_bf16 v[60:63], v[56:59], v[92:95], v[60:63]
    ds_read_b64_tr_b16 v[84:85], v52 offset:17920
    ds_read_b64_tr_b16 v[86:87], v52 offset:19712
    s_waitcnt lgkmcnt(10)
    v_mfma_f32_16x16x32_bf16 v[60:63], v[56:59], v[64:67], v[60:63]
    ds_read_b64_tr_b16 v[88:89], v52 offset:21504
    ds_read_b64_tr_b16 v[90:91], v52 offset:23296
    s_waitcnt lgkmcnt(10)
    v_mfma_f32_16x16x32_bf16 v[60:63], v[56:59], v[68:71], v[60:63]
    ds_read_b64_tr_b16 v[92:93], v52 offset:25088
    ds_read_b64_tr_b16 v[94:95], v52 offset:26880
    s_waitcnt lgkmcnt(10)
    v_mfma_f32_16x16x32_bf16 v[60:63], v[56:59], v[72:75], v[60:63]
    ds_read_b64_tr_b16 v[64:65], v52 offset:28672
    ds_read_b64_tr_b16 v[66:67], v52 offset:30464
    s_waitcnt lgkmcnt(10)
    v_mfma_f32_16x16x32_bf16 v[60:63], v[56:59], v[76:79], v[60:63]
    ds_read_b64_tr_b16 v[68:69], v52 offset:32256
    ds_read_b64_tr_b16 v[70:71], v52 offset:34048
    s_waitcnt lgkmcnt(10)
    v_mfma_f32_16x16x32_bf16 v[60:63], v[56:59], v[80:83], v[60:63]
    ds_read_b64_tr_b16 v[72:73], v52 offset:35840
    ds_read_b64_tr_b16 v[74:75], v52 offset:37632
    s_waitcnt lgkmcnt(10)
    v_mfma_f32_16x16x32_bf16 v[60:63], v[56:59], v[84:87], v[60:63]
    ds_read_b64_tr_b16 v[76:77], v52 offset:39424
    ds_read_b64_tr_b16 v[78:79], v52 offset:41216
    s_waitcnt lgkmcnt(10)
    v_mfma_f32_16x16x32_bf16 v[60:63], v[56:59], v[88:91], v[60:63]
    s_waitcnt lgkmcnt(8)
    v_mfma_f32_16x16x32_bf16 v[60:63], v[56:59], v[92:95], v[60:63]
    s_waitcnt lgkmcnt(6)
    v_mfma_f32_16x16x32_bf16 v[60:63], v[56:59], v[64:67], v[60:63]
    s_waitcnt lgkmcnt(4)
    v_mfma_f32_16x16x32_bf16 v[60:63], v[56:59], v[68:71], v[60:63]
    s_waitcnt lgkmcnt(2)
    v_mfma_f32_16x16x32_bf16 v[60:63], v[56:59], v[72:75], v[60:63]
    s_waitcnt lgkmcnt(0)
    v_mfma_f32_16x16x32_bf16 v[60:63], v[56:59], v[76:79], v[60:63]
    s_nop 7
    v_mov_b32 v61, s30
    s_mul_i32 s31, s37, 896
    s_add_u32 s31, s31, 2228224
    buffer_store_dwordx2 v[60:61], v53, s[12:15], s31 offen sc1
.Lnoq34:
    s_barrier
    s_add_u32 m0, s87, 0
    s_add_u32 s33, s86, 0
    buffer_load_dwordx4 v15, s[24:27], s33 offen lds
    s_add_u32 m0, s92, 0
    s_add_u32 s33, s86, 0
    s_mov_b32 exec_hi, 0xffff
    buffer_load_dwordx4 v16, s[24:27], s33 offen lds
    s_mov_b32 exec_hi, -1
    s_add_u32 m0, s87, 4096
    s_add_u32 s33, s86, 114688
    buffer_load_dwordx4 v15, s[24:27], s33 offen lds
    s_add_u32 m0, s92, 3072
    s_add_u32 s33, s86, 114688
    s_mov_b32 exec_hi, 0xffff
    buffer_load_dwordx4 v16, s[24:27], s33 offen lds
    s_mov_b32 exec_hi, -1
    s_nop 0
    s_add_u32 m0, s87, 8192
    s_add_u32 s33, s86, 229376
    buffer_load_dwordx4 v15, s[24:27], s33 offen lds
    s_add_u32 m0, s92, 6144
    s_add_u32 s33, s86, 229376
    s_mov_b32 exec_hi, 0xffff
    buffer_load_dwordx4 v16, s[24:27], s33 offen lds
    s_mov_b32 exec_hi, -1
    s_nop 0
    s_add_u32 m0, s87, 12288
    s_add_u32 s33, s86, 344064
    buffer_load_dwordx4 v15, s[24:27], s33 offen lds
    s_add_u32 m0, s92, 9216
    s_add_u32 s33, s86, 344064
    s_mov_b32 exec_hi, 0xffff
    buffer_load_dwordx4 v16, s[24:27], s33 offen lds
    s_mov_b32 exec_hi, -1
    s_nop 0
    s_add_u32 m0, s87, 16384
    s_add_u32 s33, s86, 458752
    buffer_load_dwordx4 v15, s[24:27], s33 offen lds
    s_add_u32 m0, s92, 12288
    s_add_u32 s33, s86, 458752
    s_mov_b32 exec_hi, 0xffff
    buffer_load_dwordx4 v16, s[24:27], s33 offen lds
    s_mov_b32 exec_hi, -1
    s_nop 0
    s_add_u32 m0, s87, 20480
    s_add_u32 s33, s86, 573440
    buffer_load_dwordx4 v15, s[24:27], s33 offen lds
    s_add_u32 m0, s92, 15360
    s_add_u32 s33, s86, 573440
    s_mov_b32 exec_hi, 0xffff
    buffer_load_dwordx4 v16, s[24:27], s33 offen lds
    s_mov_b32 exec_hi, -1
    s_nop 0
    s_add_u32 m0, s87, 24576
    s_add_u32 s33, s86, 688128
    buffer_load_dwordx4 v15, s[24:27], s33 offen lds
    s_add_u32 m0, s92, 18432
    s_add_u32 s33, s86, 688128
    s_mov_b32 exec_hi, 0xffff
    buffer_load_dwordx4 v16, s[24:27], s33 offen lds
    s_mov_b32 exec_hi, -1
    s_nop 0
    s_add_u32 m0, s87, 28672
    s_add_u32 s33, s86, 802816
    buffer_load_dwordx4 v15, s[24:27], s33 offen lds
    s_add_u32 m0, s92, 21504
    s_add_u32 s33, s86, 802816
    s_mov_b32 exec_hi, 0xffff
    buffer_load_dwordx4 v16, s[24:27], s33 offen lds
    s_mov_b32 exec_hi, -1
    s_nop 0
    s_add_u32 m0, s87, 32768
    s_add_u32 s33, s86, 917504
    buffer_load_dwordx4 v15, s[24:27], s33 offen lds
    s_add_u32 m0, s92, 24576
    s_add_u32 s33, s86, 917504
    s_mov_b32 exec_hi, 0xffff
    buffer_load_dwordx4 v16, s[24:27], s33 offen lds
    s_mov_b32 exec_hi, -1
    s_nop 0
    s_add_u32 m0, s87, 36864
    s_add_u32 s33, s86, 1032192
    buffer_load_dwordx4 v15, s[24:27], s33 offen lds
    s_add_u32 m0, s92, 27648
    s_add_u32 s33, s86, 1032192
    s_mov_b32 exec_hi, 0xffff
    buffer_load_dwordx4 v16, s[24:27], s33 offen lds
    s_mov_b32 exec_hi, -1
    s_nop 0
    s_add_u32 m0, s87, 40960
    s_add_u32 s33, s86, 1146880
    buffer_load_dwordx4 v15, s[24:27], s33 offen lds
    s_add_u32 m0, s92, 30720
    s_add_u32 s33, s86, 1146880
    s_mov_b32 exec_hi, 0xffff
    buffer_load_dwordx4 v16, s[24:27], s33 offen lds
    s_mov_b32 exec_hi, -1
    s_nop 0
    s_add_u32 m0, s87, 45056
    s_add_u32 s33, s86, 1261568
    buffer_load_dwordx4 v15, s[24:27], s33 offen lds
    s_add_u32 m0, s92, 33792
    s_add_u32 s33, s86, 1261568
    s_mov_b32 exec_hi, 0xffff
    buffer_load_dwordx4 v16, s[24:27], s33 offen lds
    s_mov_b32 exec_hi, -1
    s_nop 0
    s_add_u32 m0, s87, 49152
    s_add_u32 s33, s86, 1376256
    buffer_load_dwordx4 v15, s[24:27], s33 offen lds
    s_add_u32 m0, s92, 36864
    s_add_u32 s33, s86, 1376256
    s_mov_b32 exec_hi, 0xffff
    buffer_load_dwordx4 v16, s[24:27], s33 offen lds
    s_mov_b32 exec_hi, -1
    s_nop 0
    s_add_u32 m0, s87, 53248
    s_add_u32 s33, s86, 1490944
    buffer_load_dwordx4 v15, s[24:27], s33 offen lds
    s_add_u32 m0, s92, 39936
    s_add_u32 s33, s86, 1490944
    s_mov_b32 exec_hi, 0xffff
    buffer_load_dwordx4 v16, s[24:27], s33 offen lds
    s_mov_b32 exec_hi, -1
    s_waitcnt vmcnt(0)
    s_barrier
    s_cmp_ge_u32 s3, 2
    s_cbranch_scc1 .Lcsb35
    s_nop 0
    ds_read_b64_tr_b16 v[64:65], v18 offset:0
    ds_read_b64_tr_b16 v[66:67], v18 offset:1024
    ds_read_b64_tr_b16 v[68:69], v18 offset:2048
    ds_read_b64_tr_b16 v[70:71], v18 offset:3072
    ds_read_b64_tr_b16 v[72:73], v18 offset:4096
    ds_read_b64_tr_b16 v[74:75], v18 offset:5120
    ds_read_b64_tr_b16 v[76:77], v18 offset:6144
    ds_read_b64_tr_b16 v[78:79], v18 offset:7168
    ds_read_b64_tr_b16 v[80:81], v18 offset:8192
    ds_read_b64_tr_b16 v[82:83], v18 offset:9216
    ds_read_b64_tr_b16 v[84:85], v18 offset:10240
    ds_read_b64_tr_b16 v[86:87], v18 offset:11264
    s_waitcnt lgkmcnt(10)
    v_mfma_f32_16x16x32_bf16 v[60:63], v[56:59], v[64:67], 0
    ds_read_b64_tr_b16 v[88:89], v18 offset:12288
    ds_read_b64_tr_b16 v[90:91], v18 offset:13312
    s_waitcnt lgkmcnt(10)
    v_mfma_f32_16x16x32_bf16 v[60:63], v[56:59], v[68:71], v[60:63]
    ds_read_b64_tr_b16 v[92:93], v18 offset:14336
    ds_read_b64_tr_b16 v[94:95], v18 offset:15360
    s_waitcnt lgkmcnt(10)
    v_mfma_f32_16x16x32_bf16 v[60:63], v[56:59], v[72:75], v[60:63]
    ds_read_b64_tr_b16 v[64:65], v18 offset:16384
    ds_read_b64_tr_b16 v[66:67], v18 offset:17408
    s_waitcnt lgkmcnt(10)
    v_mfma_f32_16x16x32_bf16 v[60:63], v[56:59], v[76:79], v[60:63]
    ds_read_b64_tr_b16 v[68:69], v18 offset:18432
    ds_read_b64_tr_b16 v[70:71], v18 offset:19456
    s_waitcnt lgkmcnt(10)
    v_mfma_f32_16x16x32_bf16 v[60:63], v[56:59], v[80:83], v[60:63]
    ds_read_b64_tr_b16 v[72:73], v18 offset:20480
    ds_read_b64_tr_b16 v[74:75], v18 offset:21504
    s_waitcnt lgkmcnt(10)
    v_mfma_f32_16x16x32_bf16 v[60:63], v[56:59], v[84:87], v[60:63]
    ds_read_b64_tr_b16 v[76:77], v18 offset:22528
    ds_read_b64_tr_b16 v[78:79], v18 offset:23552
    s_waitcnt lgkmcnt(10)
    v_mfma_f32_16x16x32_bf16 v[60:63], v[56:59], v[88:91], v[60:63]
    ds_read_b64_tr_b16 v[80:81], v18 offset:24576
    ds_read_b64_tr_b16 v[82:83], v18 offset:25600
    s_waitcnt lgkmcnt(10)
    v_mfma_f32_16x16x32_bf16 v[60:63], v[56:59], v[92:95], v[60:63]
    ds_read_b64_tr_b16 v[84:85], v18 offset:26624
    ds_read_b64_tr_b16 v[86:87], v18 offset:27648
    s_waitcnt lgkmcnt(10)
    v_mfma_f32_16x16x32_bf16 v[60:63], v[56:59], v[64:67], v[60:63]
    ds_read_b64_tr_b16 v[88:89], v18 offset:28672
    ds_read_b64_tr_b16 v[90:91], v18 offset:29696
    s_waitcnt lgkmcnt(10)
    v_mfma_f32_16x16x32_bf16 v[60:63], v[56:59], v[68:71], v[60:63]
    ds_read_b64_tr_b16 v[92:93], v18 offset:30720
    ds_read_b64_tr_b16 v[94:95], v18 offset:31744
    s_waitcnt lgkmcnt(10)
    v_mfma_f32_16x16x32_bf16 v[60:63], v[56:59], v[72:75], v[60:63]
    ds_read_b64_tr_b16 v[64:65], v18 offset:32768
    ds_read_b64_tr_b16 v[66:67], v18 offset:33792
    s_waitcnt lgkmcnt(10)
    v_mfma_f32_16x16x32_bf16 v[60:63], v[56:59], v[76:79], v[60:63]
    ds_read_b64_tr_b16 v[68:69], v18 offset:34816
    ds_read_b64_tr_b16 v[70:71], v18 offset:35840
    s_waitcnt lgkmcnt(10)
    v_mfma_f32_16x16x32_bf16 v[60:63], v[56:59], v[80:83], v[60:63]
    ds_read_b64_tr_b16 v[72:73], v18 offset:36864
    ds_read_b64_tr_b16 v[74:75], v18 offset:37888
    s_waitcnt lgkmcnt(10)
    v_mfma_f32_16x16x32_bf16 v[60:63], v[56:59], v[84:87], v[60:63]
    ds_read_b64_tr_b16 v[76:77], v18 offset:38912
    ds_read_b64_tr_b16 v[78:79], v18 offset:39936
    s_waitcnt lgkmcnt(10)
    v_mfma_f32_16x16x32_bf16 v[60:63], v[56:59], v[88:91], v[60:63]
    ds_read_b64_tr_b16 v[80:81], v18 offset:40960
    ds_read_b64_tr_b16 v[82:83], v18 offset:41984
    s_waitcnt lgkmcnt(10)
    v_mfma_f32_16x16x32_bf16 v[60:63], v[56:59], v[92:95], v[60:63]
    ds_read_b64_tr_b16 v[84:85], v18 offset:43008
    ds_read_b64_tr_b16 v[86:87], v18 offset:44032
    s_waitcnt lgkmcnt(10)
    v_mfma_f32_16x16x32_bf16 v[60:63], v[56:59], v[64:67], v[60:63]
    ds_read_b64_tr_b16 v[88:89], v18 offset:45056
    ds_read_b64_tr_b16 v[90:91], v18 offset:46080
    s_waitcnt lgkmcnt(10)
    v_mfma_f32_16x16x32_bf16 v[60:63], v[56:59], v[68:71], v[60:63]
    ds_read_b64_tr_b16 v[92:93], v18 offset:47104
    ds_read_b64_tr_b16 v[94:95], v18 offset:48128
    s_waitcnt lgkmcnt(10)
    v_mfma_f32_16x16x32_bf16 v[60:63], v[56:59], v[72:75], v[60:63]
    ds_read_b64_tr_b16 v[64:65], v18 offset:49152
    ds_read_b64_tr_b16 v[66:67], v18 offset:50176
    s_waitcnt lgkmcnt(10)
    v_mfma_f32_16x16x32_bf16 v[60:63], v[56:59], v[76:79], v[60:63]
    ds_read_b64_tr_b16 v[68:69], v18 offset:51200
    ds_read_b64_tr_b16 v[70:71], v18 offset:52224
    s_waitcnt lgkmcnt(10)
    v_mfma_f32_16x16x32_bf16 v[60:63], v[56:59], v[80:83], v[60:63]
    ds_read_b64_tr_b16 v[72:73], v18 offset:53248
    ds_read_b64_tr_b16 v[74:75], v18 offset:54272
    s_waitcnt lgkmcnt(10)
    v_mfma_f32_16x16x32_bf16 v[60:63], v[56:59], v[84:87], v[60:63]
    ds_read_b64_tr_b16 v[76:77], v18 offset:55296
    ds_read_b64_tr_b16 v[78:79], v18 offset:56320
    s_waitcnt lgkmcnt(10)
    v_mfma_f32_16x16x32_bf16 v[60:63], v[56:59], v[88:91], v[60:63]
    s_waitcnt lgkmcnt(8)
    v_mfma_f32_16x16x32_bf16 v[60:63], v[56:59], v[92:95], v[60:63]
    s_waitcnt lgkmcnt(6)
    v_mfma_f32_16x16x32_bf16 v[60:63], v[56:59], v[64:67], v[60:63]
    s_waitcnt lgkmcnt(4)
    v_mfma_f32_16x16x32_bf16 v[60:63], v[56:59], v[68:71], v[60:63]
    s_waitcnt lgkmcnt(2)
    v_mfma_f32_16x16x32_bf16 v[60:63], v[56:59], v[72:75], v[60:63]
    s_waitcnt lgkmcnt(0)
    v_mfma_f32_16x16x32_bf16 v[60:63], v[56:59], v[76:79], v[60:63]
    s_nop 7
    v_mov_b32_e64 v61, s30
    s_branch .Lcse36
.Lcsb35:
    ds_read_b64_tr_b16 v[64:65], v54 offset:0
    ds_read_b64_tr_b16 v[66:67], v54 offset:768
    ds_read_b64_tr_b16 v[68:69], v54 offset:1536
    ds_read_b64_tr_b16 v[70:71], v54 offset:2304
    ds_read_b64_tr_b16 v[72:73], v54 offset:3072
    ds_read_b64_tr_b16 v[74:75], v54 offset:3840
    ds_read_b64_tr_b16 v[76:77], v54 offset:4608
    ds_read_b64_tr_b16 v[78:79], v54 offset:5376
    ds_read_b64_tr_b16 v[80:81], v54 offset:6144
    ds_read_b64_tr_b16 v[82:83], v54 offset:6912
    ds_read_b64_tr_b16 v[84:85], v54 offset:7680
    ds_read_b64_tr_b16 v[86:87], v54 offset:8448
    s_waitcnt lgkmcnt(10)
    v_mfma_f32_16x16x32_bf16 v[60:63], v[56:59], v[64:67], 0
    ds_read_b64_tr_b16 v[88:89], v54 offset:9216
    ds_read_b64_tr_b16 v[90:91], v54 offset:9984
    s_waitcnt lgkmcnt(10)
    v_mfma_f32_16x16x32_bf16 v[60:63], v[56:59], v[68:71], v[60:63]
    ds_read_b64_tr_b16 v[92:93], v54 offset:10752
    ds_read_b64_tr_b16 v[94:95], v54 offset:11520
    s_waitcnt lgkmcnt(10)
    v_mfma_f32_16x16x32_bf16 v[60:63], v[56:59], v[72:75], v[60:63]
    ds_read_b64_tr_b16 v[64:65], v54 offset:12288
    ds_read_b64_tr_b16 v[66:67], v54 offset:13056
    s_waitcnt lgkmcnt(10)
    v_mfma_f32_16x16x32_bf16 v[60:63], v[56:59], v[76:79], v[60:63]
    ds_read_b64_tr_b16 v[68:69], v54 offset:13824
    ds_read_b64_tr_b16 v[70:71], v54 offset:14592
    s_waitcnt lgkmcnt(10)
    v_mfma_f32_16x16x32_bf16 v[60:63], v[56:59], v[80:83], v[60:63]
    ds_read_b64_tr_b16 v[72:73], v54 offset:15360
    ds_read_b64_tr_b16 v[74:75], v54 offset:16128
    s_waitcnt lgkmcnt(10)
    v_mfma_f32_16x16x32_bf16 v[60:63], v[56:59], v[84:87], v[60:63]
    ds_read_b64_tr_b16 v[76:77], v54 offset:16896
    ds_read_b64_tr_b16 v[78:79], v54 offset:17664
    s_waitcnt lgkmcnt(10)
    v_mfma_f32_16x16x32_bf16 v[60:63], v[56:59], v[88:91], v[60:63]
    ds_read_b64_tr_b16 v[80:81], v54 offset:18432
    ds_read_b64_tr_b16 v[82:83], v54 offset:19200
    s_waitcnt lgkmcnt(10)
    v_mfma_f32_16x16x32_bf16 v[60:63], v[56:59], v[92:95], v[60:63]
    ds_read_b64_tr_b16 v[84:85], v54 offset:19968
    ds_read_b64_tr_b16 v[86:87], v54 offset:20736
    s_waitcnt lgkmcnt(10)
    v_mfma_f32_16x16x32_bf16 v[60:63], v[56:59], v[64:67], v[60:63]
    ds_read_b64_tr_b16 v[88:89], v54 offset:21504
    ds_read_b64_tr_b16 v[90:91], v54 offset:22272
    s_waitcnt lgkmcnt(10)
    v_mfma_f32_16x16x32_bf16 v[60:63], v[56:59], v[68:71], v[60:63]
    ds_read_b64_tr_b16 v[92:93], v54 offset:23040
    ds_read_b64_tr_b16 v[94:95], v54 offset:23808
    s_waitcnt lgkmcnt(10)
    v_mfma_f32_16x16x32_bf16 v[60:63], v[56:59], v[72:75], v[60:63]
    ds_read_b64_tr_b16 v[64:65], v54 offset:24576
    ds_read_b64_tr_b16 v[66:67], v54 offset:25344
    s_waitcnt lgkmcnt(10)
    v_mfma_f32_16x16x32_bf16 v[60:63], v[56:59], v[76:79], v[60:63]
    ds_read_b64_tr_b16 v[68:69], v54 offset:26112
    ds_read_b64_tr_b16 v[70:71], v54 offset:26880
    s_waitcnt lgkmcnt(10)
    v_mfma_f32_16x16x32_bf16 v[60:63], v[56:59], v[80:83], v[60:63]
    ds_read_b64_tr_b16 v[72:73], v54 offset:27648
    ds_read_b64_tr_b16 v[74:75], v54 offset:28416
    s_waitcnt lgkmcnt(10)
    v_mfma_f32_16x16x32_bf16 v[60:63], v[56:59], v[84:87], v[60:63]
    ds_read_b64_tr_b16 v[76:77], v54 offset:29184
    ds_read_b64_tr_b16 v[78:79], v54 offset:29952
    s_waitcnt lgkmcnt(10)
    v_mfma_f32_16x16x32_bf16 v[60:63], v[56:59], v[88:91], v[60:63]
    ds_read_b64_tr_b16 v[80:81], v54 offset:30720
    ds_read_b64_tr_b16 v[82:83], v54 offset:31488
    s_waitcnt lgkmcnt(10)
    v_mfma_f32_16x16x32_bf16 v[60:63], v[56:59], v[92:95], v[60:63]
    ds_read_b64_tr_b16 v[84:85], v54 offset:32256
    ds_read_b64_tr_b16 v[86:87], v54 offset:33024
    s_waitcnt lgkmcnt(10)
    v_mfma_f32_16x16x32_bf16 v[60:63], v[56:59], v[64:67], v[60:63]
    ds_read_b64_tr_b16 v[88:89], v54 offset:33792
    ds_read_b64_tr_b16 v[90:91], v54 offset:34560
    s_waitcnt lgkmcnt(10)
    v_mfma_f32_16x16x32_bf16 v[60:63], v[56:59], v[68:71], v[60:63]
    ds_read_b64_tr_b16 v[92:93], v54 offset:35328
    ds_read_b64_tr_b16 v[94:95], v54 offset:36096
    s_waitcnt lgkmcnt(10)
    v_mfma_f32_16x16x32_bf16 v[60:63], v[56:59], v[72:75], v[60:63]
    ds_read_b64_tr_b16 v[64:65], v54 offset:36864
    ds_read_b64_tr_b16 v[66:67], v54 offset:37632
    s_waitcnt lgkmcnt(10)
    v_mfma_f32_16x16x32_bf16 v[60:63], v[56:59], v[76:79], v[60:63]
    ds_read_b64_tr_b16 v[68:69], v54 offset:38400
    ds_read_b64_tr_b16 v[70:71], v54 offset:39168
    s_waitcnt lgkmcnt(10)
    v_mfma_f32_16x16x32_bf16 v[60:63], v[56:59], v[80:83], v[60:63]
    ds_read_b64_tr_b16 v[72:73], v54 offset:39936
    ds_read_b64_tr_b16 v[74:75], v54 offset:40704
    s_waitcnt lgkmcnt(10)
    v_mfma_f32_16x16x32_bf16 v[60:63], v[56:59], v[84:87], v[60:63]
    ds_read_b64_tr_b16 v[76:77], v54 offset:41472
    ds_read_b64_tr_b16 v[78:79], v54 offset:42240
    s_waitcnt lgkmcnt(10)
    v_mfma_f32_16x16x32_bf16 v[60:63], v[56:59], v[88:91], v[60:63]
    s_waitcnt lgkmcnt(8)
    v_mfma_f32_16x16x32_bf16 v[60:63], v[56:59], v[92:95], v[60:63]
    s_waitcnt lgkmcnt(6)
    v_mfma_f32_16x16x32_bf16 v[60:63], v[56:59], v[64:67], v[60:63]
    s_waitcnt lgkmcnt(4)
    v_mfma_f32_16x16x32_bf16 v[60:63], v[56:59], v[68:71], v[60:63]
    s_waitcnt lgkmcnt(2)
    v_mfma_f32_16x16x32_bf16 v[60:63], v[56:59], v[72:75], v[60:63]
    s_waitcnt lgkmcnt(0)
    v_mfma_f32_16x16x32_bf16 v[60:63], v[56:59], v[76:79], v[60:63]
    s_nop 7
    v_mov_b32 v61, s30
.Lcse36:
    s_mul_i32 s31, s93, 896
    s_add_u32 s31, s31, 2260992
    buffer_store_dwordx2 v[60:61], v53, s[12:15], s31 offen sc1
.Ls34:
    s_nop 1
    s_nop 0
    s_mul_i32 s31, s93, 896
    s_add_u32 s31, s31, 2260992
    v_lshl_add_u32 v18, v12, 3, s31
    buffer_load_dwordx2 v[52:53], v18, s[12:15], 0 offen offset:0 sc1
    buffer_load_dwordx2 v[54:55], v18, s[12:15], 0 offen offset:256 sc1
    buffer_load_dwordx2 v[56:57], v18, s[12:15], 0 offen offset:512 sc1
    buffer_load_dwordx2 v[58:59], v18, s[12:15], 0 offen offset:768 sc1
    s_lshr_b32 s31, s29, 3
    s_and_b32 s35, s28, 6
    s_lshl_b32 s35, s35, 1
    s_add_u32 s35, s35, s31
    s_mov_b32 s36, s93
    s_lshl_b32 s38, s35, 2
    s_add_u32 s38, s38, s3
    s_lshl_b32 s39, s35, 4
    s_add_u32 s39, s39, s36
    v_bfe_u32 v4, v1, 2, 2
    v_lshrrev_b32 v5, 5, v1
    v_lshl_add_u32 v4, v5, 2, v4
    v_lshlrev_b32_e64 v4, 7, v4
    v_bfe_u32 v5, v1, 3, 1
    v_lshl_add_u32 v4, v5, 6, v4
    v_bfe_u32 v5, v1, 4, 1
    v_lshl_add_u32 v4, v5, 5, v4
    v_and_b32_e64 v5, 3, v1
    v_lshl_add_u32 v19, v5, 3, v4
    v_xor_b32_e64 v60, 64, v19
    v_bfe_u32 v5, v1, 2, 2
    v_lshl_add_u32 v5, v5, 1, v13
    v_mul_u32_u24 v5, 96, v5
    v_add_u32 v5, 57344, v5
    v_bfe_u32 v6, v1, 4, 1
    v_lshlrev_b32 v6, 5, v6
    v_and_b32 v7, 3, v1
    v_lshl_add_u32 v6, v7, 3, v6
    v_add_u32 v61, v6, v5
    v_add_u32 v7, 64, v6
    v_min_u32 v7, 88, v7
    v_add_u32_e64 v62, v7, v5
    s_mov_b32 s56, -1
    s_mov_b32 s57, 0
    s_mul_i32 s37, s38, 28672
    s_add_u32 s37, s37, 6553600
    s_lshl_b32 s40, s28, 2
    s_and_b32 s31, s29, 3
    s_add_u32 s40, s40, s31
    s_lshr_b32 s41, s29, 2
    s_and_b32 s46, s3, 1
    s_lshr_b32 s47, s3, 1
    s_lshl_b32 s44, s40, 1
    s_add_u32 s44, s44, s46
    s_lshl_b32 s45, s3, 10
    s_mov_b32 s16, s76
    s_mov_b32 s17, s77
    s_mov_b32 s18, 0x188000
    s_mov_b32 s19, 0x00020000
    s_mov_b32 s8, s78
    s_mov_b32 s9, s79
    s_mov_b32 s10, 0x1c0000
    s_mov_b32 s11, 0x00020000
    s_mul_i32 s43, s47, 802816
    s_mul_i32 s31, s46, 7168
    s_add_u32 s43, s43, s31
    s_lshl_b32 s31, s41, 7
    s_add_u32 s43, s43, s31
    s_mul_i32 s42, s44, 114688
    s_mul_i32 s31, s47, 57344
    s_add_u32 s42, s42, s31
    s_add_u32 s42, s42, 11534336
    s_cmp_ge_u32 s29, 28
    s_cselect_b32 s43, 0x40000000, s43
    s_cselect_b32 s42, 0x40000000, s42
    s_sub_u32 s50, s29, 14
    s_lshl_b32 s31, s47, 6
    v_xor_b32 v7, s31, v19
    s_lshl_b32 s31, s47, 11
    v_add_u32_e64 v15, s31, v7
    v_add_u32 v17, 0x10000, v15
    v_add_u32 v188, 0x20000, v15
    s_mul_i32 s31, s47, 28672
    s_add_u32 s31, s31, 100352
    v_add_u32 v190, s31, v7
    v_xor_b32 v16, 64, v15
    v_xor_b32 v63, 64, v17
    v_xor_b32 v189, 64, v188
    v_xor_b32 v191, 64, v190
    s_lshl_b32 s32, s35, 3
    v_add_u32 v8, s32, v1
    v_lshlrev_b32 v8, 7, v8
    v_add_u32 v8, 6389760, v8
    v_cmp_gt_u32_e64 vcc, 7, v0
    v_mov_b32 v192, 0x7fff0000
    s_nop 0
    v_cndmask_b32 v192, v192, v8, vcc
    buffer_load_dword v193, v192, s[12:15], 0 offen sc1
    s_lshl_b32 s31, s38, 11
    s_add_u32 s31, s31, 8388608
    v_lshl_add_u32 v204, v1, 3, s31
    s_mul_i32 s52, s38, 114688
    s_mul_i32 s32, s36, 7168
    s_add_u32 s52, s52, s32
    s_add_u32 s52, s52, 11534336
    s_lshl_b32 s53, s90, 3
    s_add_u32 s53, s53, s91
    s_mov_b32 s31, 0x800000
    s_lshl_b32 s54, s91, 4
    s_add_u32 s54, s54, s90
    s_add_u32 s54, s54, 128
    s_cmp_lt_u32 s50, 16
    s_cselect_b32 s53, s53, s31
    s_cselect_b32 s54, s54, s31
    s_lshl_b32 s49, s44, 15
    s_lshl_b32 s31, s47, 14
    s_add_u32 s49, s49, s31
    s_add_u32 s49, s49, 8912896
    s_mul_i32 s48, s44, 28672
    s_lshl_b32 s31, s41, 7
    s_add_u32 s48, s48, s31
    s_lshl_b32 s31, s47, 6
    s_add_u32 s48, s48, s31
    s_mul_i32 s86, s44, 28672
    s_lshl_b32 s32, s41, 12
    s_add_u32 s86, s86, s32
    s_lshl_b32 s32, s47, 11
    s_add_u32 s86, s86, s32
    s_add_u32 s86, s86, 2359296
    s_lshl_b32 s31, s90, 2
    s_add_u32 s31, s31, s3
    s_lshr_b32 s32, s31, 5
    s_lshl_b32 s33, s91, 1
    s_add_u32 s32, s32, s33
    s_and_b32 s31, s31, 31
    s_lshl_b32 s31, s31, 7
    s_lshl_b32 s51, s32, 16
    s_add_u32 s51, s51, s31
    s_add_u32 s51, s51, 4194304
    s_lshl_b32 s55, s32, 12
    s_add_u32 s55, s55, s31
    s_add_u32 s55, s55, 2097152
    s_add_u32 s88, s33, s47
    s_lshl_b32 s89, s90, 2
    s_lshl_b32 s32, s46, 1
    s_add_u32 s89, s89, s32
    s_lshl_b32 s89, s89, 4
    s_add_u32 s89, s89, s88
    s_lshl_b32 s89, s89, 11
    s_add_u32 s89, s89, 8912896
    s_lshl_b32 s88, s88, 12
    s_add_u32 s88, s88, 2097152
    s_cmp_lt_u32 s50, 16
    s_cselect_b32 s51, s51, 0x40000000
    s_cselect_b32 s55, s55, 0x40000000
    s_cselect_b32 s88, s88, 0x40000000
    v_lshrrev_b32 v4, 3, v1
    v_lshlrev_b32 v4, 12, v4
    v_and_b32 v5, 7, v1
    v_lshl_add_u32 v205, v5, 4, v4
    v_lshrrev_b32 v4, 4, v1
    v_lshlrev_b32 v4, 2, v4
    v_lshl_add_u32 v206, v5, 4, v4
    s_lshl_b32 s31, s3, 2
    s_add_u32 s31, s31, 163824
    v_mov_b32 v207, s31
    v_mov_b32 v216, 163824
    s_lshl_b32 s31, s3, 12
    s_add_u32 s31, s31, 16384
    v_add_u32 v219, s31, v3
    v_xor_b32 v224, 0x2000, v219
    v_mul_u32_u24 v218, 896, v12
    v_lshl_add_u32 v218, v13, 4, v218
    ds_read_b64_tr_b16 v[96:97], v19 offset:0
    ds_read_b64_tr_b16 v[98:99], v19 offset:1024
    ds_read_b64_tr_b16 v[100:101], v60 offset:0
    ds_read_b64_tr_b16 v[102:103], v60 offset:1024
    ds_read_b64_tr_b16 v[104:105], v19 offset:2048
    ds_read_b64_tr_b16 v[106:107], v19 offset:3072
    ds_read_b64_tr_b16 v[108:109], v60 offset:2048
    ds_read_b64_tr_b16 v[110:111], v60 offset:3072
    s_waitcnt vmcnt(0)
    s_waitcnt lgkmcnt(0)
    s_cmp_lg_u32 s3, 0
    s_cbranch_scc1 .Lpoll37
    s_mov_b32 exec_lo, 0x7f
    s_mov_b32 exec_hi, 0
    v_cmp_ne_u32_e64 vcc, s30, v193
    s_nop 1
    s_cbranch_vccz .Lpollx38
    s_mov_b32 s34, 0
.Lspin39:
    buffer_load_dword v193, v192, s[12:15], 0 offen sc1
    s_add_u32 s34, s34, 1
    s_waitcnt vmcnt(0)
    v_cmp_ne_u32_e64 vcc, s30, v193
    s_cmp_ge_u32 s34, 200000
    s_cbranch_scc1 .Lspun40
    s_cbranch_vccnz .Lspin39
.Lspun40:
    s_nop 1
.Lpollx38:
    s_mov_b64 exec, -1
.Lpoll37:
    s_barrier
    s_nop 0
    buffer_load_dwordx4 a[0:3], v3, s[12:15], s37 offen offset:0 sc1
    buffer_load_dwordx4 a[4:7], v3, s[12:15], s37 offen offset:1024 sc1
    buffer_load_dwordx4 a[8:11], v3, s[12:15], s37 offen offset:2048 sc1
    buffer_load_dwordx4 a[12:15], v3, s[12:15], s37 offen offset:3072 sc1
    s_add_u32 s37, s37, 4096
    buffer_load_dwordx4 a[16:19], v3, s[12:15], s37 offen offset:0 sc1
    buffer_load_dwordx4 a[20:23], v3, s[12:15], s37 offen offset:1024 sc1
    buffer_load_dwordx4 a[24:27], v3, s[12:15], s37 offen offset:2048 sc1
    buffer_load_dwordx4 a[28:31], v3, s[12:15], s37 offen offset:3072 sc1
    s_add_u32 s37, s37, 4096
    buffer_load_dwordx4 a[32:35], v3, s[12:15], s37 offen offset:0 sc1
    buffer_load_dwordx4 a[36:39], v3, s[12:15], s37 offen offset:1024 sc1
    buffer_load_dwordx4 a[40:43], v3, s[12:15], s37 offen offset:2048 sc1
    buffer_load_dwordx4 a[44:47], v3, s[12:15], s37 offen offset:3072 sc1
    ds_read_b64_tr_b16 a[128:129], v190 offset:0
    ds_read_b64_tr_b16 a[130:131], v190 offset:1024
    ds_read_b64_tr_b16 a[132:133], v191 offset:0
    ds_read_b64_tr_b16 a[134:135], v191 offset:1024
    ds_read_b64_tr_b16 a[136:137], v190 offset:2048
    ds_read_b64_tr_b16 a[138:139], v190 offset:3072
    ds_read_b64_tr_b16 a[140:141], v191 offset:2048
    ds_read_b64_tr_b16 a[142:143], v191 offset:3072
    ds_read_b64_tr_b16 a[144:145], v190 offset:3584
    ds_read_b64_tr_b16 a[146:147], v190 offset:4608
    ds_read_b64_tr_b16 a[148:149], v191 offset:3584
    ds_read_b64_tr_b16 a[150:151], v191 offset:4608
    s_mov_b32 s58, 0xffff
    s_mov_b32 s59, 0
    v_xor_b32 v4, s30, v53
    v_xor_b32 v5, s30, v55
    v_or_b32 v4, v4, v5
    v_xor_b32 v5, s30, v57
    v_or_b32 v4, v4, v5
    v_xor_b32_e64 v5, s30, v59
    v_cndmask_b32 v5, 0, v5, s[58:59]
    v_or_b32 v4, v4, v5
    v_cmp_ne_u32 vcc, 0, v4
    s_nop 1
    s_cbranch_vccz .Lgrok41
    s_waitcnt vmcnt(0) lgkmcnt(0)
    s_mov_b32 s34, 0
.Lspin42:
    buffer_load_dwordx2 v[52:53], v18, s[12:15], 0 offen offset:0 sc1
    buffer_load_dwordx2 v[54:55], v18, s[12:15], 0 offen offset:256 sc1
    buffer_load_dwordx2 v[56:57], v18, s[12:15], 0 offen offset:512 sc1
    buffer_load_dwordx2 v[58:59], v18, s[12:15], 0 offen offset:768 sc1
    s_add_u32 s34, s34, 1
    s_waitcnt vmcnt(0)
    v_xor_b32 v4, s30, v53
    v_xor_b32 v5, s30, v55
    v_or_b32 v4, v4, v5
    v_xor_b32 v5, s30, v57
    v_or_b32 v4, v4, v5
    v_xor_b32 v5, s30, v59
    v_cndmask_b32 v5, 0, v5, s[58:59]
    v_or_b32 v4, v4, v5
    v_cmp_ne_u32 vcc, 0, v4
    s_cmp_ge_u32 s34, 200000
    s_cbranch_scc1 .Lspun43
    s_cbranch_vccnz .Lspin42
.Lspun43:
    s_nop 1
.Lgrok41:
    v_cndmask_b32 v6, 0, v52, s[56:57]
    v_cvt_pk_bf16_f32 v121, v6, 0
    v_lshlrev_b32 v122, 16, v121
    v_sub_f32_e64 v122, v6, v122
    v_cvt_pk_bf16_f32 v120, v6, v122
    v_mov_b32 v122, 0
    v_mov_b32 v123, 0
    v_cndmask_b32 v6, 0, v54, s[56:57]
    v_cvt_pk_bf16_f32 v125, v6, 0
    v_lshlrev_b32 v126, 16, v125
    v_sub_f32 v126, v6, v126
    v_cvt_pk_bf16_f32 v124, v6, v126
    v_mov_b32 v126, 0
    v_mov_b32 v127, 0
    v_cndmask_b32 v6, 0, v56, s[56:57]
    v_cvt_pk_bf16_f32 v129, v6, 0
    v_lshlrev_b32 v130, 16, v129
    v_sub_f32 v130, v6, v130
    v_cvt_pk_bf16_f32 v128, v6, v130
    v_mov_b32 v130, 0
    v_mov_b32 v131, 0
    v_cndmask_b32 v6, 0, v58, s[56:57]
    v_cvt_pk_bf16_f32 v133, v6, 0
    v_lshlrev_b32 v134, 16, v133
    v_sub_f32 v134, v6, v134
    v_cvt_pk_bf16_f32 v132, v6, v134
    v_mov_b32 v134, 0
    v_mov_b32_e64 v135, 0
    s_waitcnt vmcnt(11)
    v_mfma_f32_32x32x16_bf16 v[64:79], v[96:99], a[0:3], 0
    ds_read_b64_tr_b16 v[112:113], v19 offset:4096
    ds_read_b64_tr_b16 v[114:115], v19 offset:5120
    ds_read_b64_tr_b16 v[116:117], v60 offset:4096
    ds_read_b64_tr_b16 v[118:119], v60 offset:5120
    ds_read_b64_tr_b16 a[152:153], v190 offset:5632
    ds_read_b64_tr_b16 a[154:155], v190 offset:6656
    v_mfma_f32_32x32x16_bf16 v[80:95], v[100:103], a[0:3], 0
    ds_read_b64_tr_b16 a[156:157], v191 offset:5632
    ds_read_b64_tr_b16 a[158:159], v191 offset:6656
    s_add_u32 s37, s37, 4096
    buffer_load_dwordx4 a[48:51], v3, s[12:15], s37 offen offset:0 sc1
    s_waitcnt vmcnt(11)
    s_nop 0
    v_mfma_f32_32x32x16_bf16 v[64:79], v[104:107], a[4:7], v[64:79]
    ds_read_b64_tr_b16 v[96:97], v19 offset:6144
    ds_read_b64_tr_b16 v[98:99], v19 offset:7168
    ds_read_b64_tr_b16 v[100:101], v60 offset:6144
    ds_read_b64_tr_b16 v[102:103], v60 offset:7168
    ds_read_b64_tr_b16 a[160:161], v190 offset:7168
    ds_read_b64_tr_b16 a[162:163], v190 offset:8192
    v_mfma_f32_32x32x16_bf16 v[80:95], v[108:111], a[4:7], v[80:95]
    ds_read_b64_tr_b16 a[164:165], v191 offset:7168
    ds_read_b64_tr_b16 a[166:167], v191 offset:8192
    buffer_load_dwordx4 a[52:55], v3, s[12:15], s37 offen offset:1024 sc1
    s_waitcnt vmcnt(11) lgkmcnt(12)
    s_nop 0
    v_mfma_f32_32x32x16_bf16 v[64:79], v[112:115], a[8:11], v[64:79]
    ds_read_b64_tr_b16 v[104:105], v19 offset:8192
    ds_read_b64_tr_b16 v[106:107], v19 offset:9216
    ds_read_b64_tr_b16 v[108:109], v60 offset:8192
    ds_read_b64_tr_b16 v[110:111], v60 offset:9216
    ds_read_b64_tr_b16 a[168:169], v190 offset:9216
    ds_read_b64_tr_b16 a[170:171], v190 offset:10240
    v_mfma_f32_32x32x16_bf16 v[80:95], v[116:119], a[8:11], v[80:95]
    ds_read_b64_tr_b16 a[172:173], v191 offset:9216
    ds_read_b64_tr_b16 a[174:175], v191 offset:10240
    buffer_load_dwordx4 a[56:59], v3, s[12:15], s37 offen offset:2048 sc1
    s_waitcnt vmcnt(11) lgkmcnt(12)
    s_nop 0
    v_mfma_f32_32x32x16_bf16 v[64:79], v[96:99], a[12:15], v[64:79]
    ds_read_b64_tr_b16 v[112:113], v19 offset:10240
    ds_read_b64_tr_b16 v[114:115], v19 offset:11264
    ds_read_b64_tr_b16 v[116:117], v60 offset:10240
    ds_read_b64_tr_b16 v[118:119], v60 offset:11264
    ds_read_b64_tr_b16 a[176:177], v190 offset:10752
    ds_read_b64_tr_b16 a[178:179], v190 offset:11776
    v_mfma_f32_32x32x16_bf16 v[80:95], v[100:103], a[12:15], v[80:95]
    ds_read_b64_tr_b16 a[180:181], v191 offset:10752
    ds_read_b64_tr_b16 a[182:183], v191 offset:11776
    buffer_load_dwordx4 a[60:63], v3, s[12:15], s37 offen offset:3072 sc1
    s_waitcnt vmcnt(11) lgkmcnt(12)
    s_nop 0
    v_mfma_f32_32x32x16_bf16 v[64:79], v[104:107], a[16:19], v[64:79]
    ds_read_b64_tr_b16 v[96:97], v19 offset:12288
    ds_read_b64_tr_b16 v[98:99], v19 offset:13312
    ds_read_b64_tr_b16 v[100:101], v60 offset:12288
    ds_read_b64_tr_b16 v[102:103], v60 offset:13312
    ds_read_b64_tr_b16 a[184:185], v190 offset:12800
    ds_read_b64_tr_b16 a[186:187], v190 offset:13824
    v_mfma_f32_32x32x16_bf16 v[80:95], v[108:111], a[16:19], v[80:95]
    ds_read_b64_tr_b16 a[188:189], v191 offset:12800
    ds_read_b64_tr_b16 a[190:191], v191 offset:13824
    s_add_u32 s37, s37, 4096
    buffer_load_dwordx4 a[64:67], v3, s[12:15], s37 offen offset:0 sc1
    s_waitcnt vmcnt(11) lgkmcnt(12)
    s_nop 0
    v_mfma_f32_32x32x16_bf16 v[64:79], v[112:115], a[20:23], v[64:79]
    ds_read_b64_tr_b16 v[104:105], v19 offset:14336
    ds_read_b64_tr_b16 v[106:107], v19 offset:15360
    ds_read_b64_tr_b16 v[108:109], v60 offset:14336
    ds_read_b64_tr_b16 v[110:111], v60 offset:15360
    ds_read_b64_tr_b16 a[192:193], v190 offset:14336
    ds_read_b64_tr_b16 a[194:195], v190 offset:15360
    v_mfma_f32_32x32x16_bf16 v[80:95], v[116:119], a[20:23], v[80:95]
    ds_read_b64_tr_b16 a[196:197], v191 offset:14336
    ds_read_b64_tr_b16 a[198:199], v191 offset:15360
    buffer_load_dwordx4 a[68:71], v3, s[12:15], s37 offen offset:1024 sc1
    s_waitcnt vmcnt(11) lgkmcnt(12)
    s_nop 0
    v_mfma_f32_32x32x16_bf16 v[64:79], v[96:99], a[24:27], v[64:79]
    ds_read_b64_tr_b16 v[112:113], v19 offset:16384
    ds_read_b64_tr_b16 v[114:115], v19 offset:17408
    ds_read_b64_tr_b16 v[116:117], v60 offset:16384
    ds_read_b64_tr_b16 v[118:119], v60 offset:17408
    ds_read_b64_tr_b16 a[200:201], v190 offset:16384
    ds_read_b64_tr_b16 a[202:203], v190 offset:17408
    v_mfma_f32_32x32x16_bf16 v[80:95], v[100:103], a[24:27], v[80:95]
    ds_read_b64_tr_b16 a[204:205], v191 offset:16384
    ds_read_b64_tr_b16 a[206:207], v191 offset:17408
    buffer_load_dwordx4 a[72:75], v3, s[12:15], s37 offen offset:2048 sc1
    s_waitcnt vmcnt(11) lgkmcnt(12)
    s_nop 0
    v_mfma_f32_32x32x16_bf16 v[64:79], v[104:107], a[28:31], v[64:79]
    ds_read_b64_tr_b16 v[96:97], v19 offset:18432
    ds_read_b64_tr_b16 v[98:99], v19 offset:19456
    ds_read_b64_tr_b16 v[100:101], v60 offset:18432
    ds_read_b64_tr_b16 v[102:103], v60 offset:19456
    ds_read_b64_tr_b16 a[208:209], v190 offset:17920
    ds_read_b64_tr_b16 a[210:211], v190 offset:18944
    v_mfma_f32_32x32x16_bf16 v[80:95], v[108:111], a[28:31], v[80:95]
    ds_read_b64_tr_b16 a[212:213], v191 offset:17920
    ds_read_b64_tr_b16 a[214:215], v191 offset:18944
    buffer_load_dwordx4 a[76:79], v3, s[12:15], s37 offen offset:3072 sc1
    s_waitcnt vmcnt(11) lgkmcnt(12)
    s_nop 0
    v_mfma_f32_32x32x16_bf16 v[64:79], v[112:115], a[32:35], v[64:79]
    ds_read_b64_tr_b16 v[104:105], v19 offset:20480
    ds_read_b64_tr_b16 v[106:107], v19 offset:21504
    ds_read_b64_tr_b16 v[108:109], v60 offset:20480
    ds_read_b64_tr_b16 v[110:111], v60 offset:21504
    ds_read_b64_tr_b16 a[216:217], v190 offset:19968
    ds_read_b64_tr_b16 a[218:219], v190 offset:20992
    v_mfma_f32_32x32x16_bf16 v[80:95], v[116:119], a[32:35], v[80:95]
    ds_read_b64_tr_b16 a[220:221], v191 offset:19968
    ds_read_b64_tr_b16 a[222:223], v191 offset:20992
    s_add_u32 s37, s37, 4096
    buffer_load_dwordx4 a[80:83], v3, s[12:15], s37 offen offset:0 sc1
    s_waitcnt vmcnt(11) lgkmcnt(12)
    s_nop 0
    v_mfma_f32_32x32x16_bf16 v[64:79], v[96:99], a[36:39], v[64:79]
    ds_read_b64_tr_b16 v[112:113], v19 offset:22528
    ds_read_b64_tr_b16 v[114:115], v19 offset:23552
    ds_read_b64_tr_b16 v[116:117], v60 offset:22528
    ds_read_b64_tr_b16 v[118:119], v60 offset:23552
    ds_read_b64_tr_b16 a[224:225], v190 offset:21504
    ds_read_b64_tr_b16 a[226:227], v190 offset:22528
    v_mfma_f32_32x32x16_bf16 v[80:95], v[100:103], a[36:39], v[80:95]
    ds_read_b64_tr_b16 a[228:229], v191 offset:21504
    ds_read_b64_tr_b16 a[230:231], v191 offset:22528
    buffer_load_dwordx4 a[84:87], v3, s[12:15], s37 offen offset:1024 sc1
    s_waitcnt vmcnt(11) lgkmcnt(12)
    s_nop 0
    v_mfma_f32_32x32x16_bf16 v[64:79], v[104:107], a[40:43], v[64:79]
    ds_read_b64_tr_b16 v[96:97], v19 offset:24576
    ds_read_b64_tr_b16 v[98:99], v19 offset:25600
    ds_read_b64_tr_b16 v[100:101], v60 offset:24576
    ds_read_b64_tr_b16 v[102:103], v60 offset:25600
    ds_read_b64_tr_b16 a[232:233], v190 offset:23552
    ds_read_b64_tr_b16 a[234:235], v190 offset:24576
    v_mfma_f32_32x32x16_bf16 v[80:95], v[108:111], a[40:43], v[80:95]
    ds_read_b64_tr_b16 a[236:237], v191 offset:23552
    ds_read_b64_tr_b16 a[238:239], v191 offset:24576
    buffer_load_dwordx4 a[88:91], v3, s[12:15], s37 offen offset:2048 sc1
    s_waitcnt vmcnt(11) lgkmcnt(12)
    s_nop 0
    v_mfma_f32_32x32x16_bf16 v[64:79], v[112:115], a[44:47], v[64:79]
    ds_read_b64_tr_b16 v[104:105], v19 offset:26624
    ds_read_b64_tr_b16 v[106:107], v19 offset:27648
    ds_read_b64_tr_b16 v[108:109], v60 offset:26624
    ds_read_b64_tr_b16 v[110:111], v60 offset:27648
    ds_read_b64_tr_b16 a[240:241], v190 offset:25088
    ds_read_b64_tr_b16 a[242:243], v190 offset:26112
    v_mfma_f32_32x32x16_bf16 v[80:95], v[116:119], a[44:47], v[80:95]
    ds_read_b64_tr_b16 a[244:245], v191 offset:25088
    ds_read_b64_tr_b16 a[246:247], v191 offset:26112
    buffer_load_dwordx4 a[92:95], v3, s[12:15], s37 offen offset:3072 sc1
    s_waitcnt vmcnt(11) lgkmcnt(12)
    s_nop 0
    v_mfma_f32_32x32x16_bf16 v[64:79], v[96:99], a[48:51], v[64:79]
    ds_read_b64_tr_b16 v[112:113], v19 offset:28672
    ds_read_b64_tr_b16 v[114:115], v19 offset:29696
    ds_read_b64_tr_b16 v[116:117], v60 offset:28672
    ds_read_b64_tr_b16 v[118:119], v60 offset:29696
    ds_read_b64_tr_b16 a[248:249], v190 offset:27136
    ds_read_b64_tr_b16 a[250:251], v190 offset:28160
    s_lshl_b32 s32, s35, 3
    s_add_u32 s32, s32, 256
    s_lshl_b32 s33, s91, 4
    s_add_u32 s33, s33, 128
    v_add_u32 v8, s33, v1
    v_mov_b32 v9, s32
    s_cmp_lt_u32 s50, 16
    s_cselect_b32 s33, 16, 0
    v_cmp_gt_u32 vcc, s33, v1
    s_nop 1
    v_cndmask_b32 v8, v9, v8, vcc
    v_lshlrev_b32 v8, 7, v8
    v_add_u32 v8, 6356992, v8
    v_cmp_gt_u32_e64 vcc, 16, v0
    v_mov_b32 v18, 0x7fff0000
    s_nop 0
    v_cndmask_b32 v18, v18, v8, vcc
    buffer_load_dword v52, v18, s[12:15], 0 offen sc1
    v_mfma_f32_32x32x16_bf16 v[80:95], v[100:103], a[48:51], v[80:95]
    ds_read_b64_tr_b16 a[252:253], v191 offset:27136
    ds_read_b64_tr_b16 a[254:255], v191 offset:28160
    s_add_u32 s37, s37, 4096
    buffer_load_dwordx4 a[96:99], v3, s[12:15], s37 offen offset:0 sc1
    s_waitcnt vmcnt(12) lgkmcnt(12)
    v_mfma_f32_32x32x16_bf16 v[64:79], v[104:107], a[52:55], v[64:79]
    ds_read_b64_tr_b16 v[96:97], v19 offset:30720
    ds_read_b64_tr_b16 v[98:99], v19 offset:31744
    ds_read_b64_tr_b16 v[100:101], v60 offset:30720
    ds_read_b64_tr_b16 v[102:103], v60 offset:31744
    v_mov_b32 v217, 1
    ds_write_b32 v207, v217
    v_mfma_f32_32x32x16_bf16 v[80:95], v[108:111], a[52:55], v[80:95]
    buffer_load_dwordx4 a[100:103], v3, s[12:15], s37 offen offset:1024 sc1
    s_waitcnt vmcnt(12) lgkmcnt(9)
    s_nop 0
    v_mfma_f32_32x32x16_bf16 v[64:79], v[112:115], a[56:59], v[64:79]
    ds_read_b64_tr_b16 v[104:105], v19 offset:32768
    ds_read_b64_tr_b16 v[106:107], v19 offset:33792
    ds_read_b64_tr_b16 v[108:109], v60 offset:32768
    ds_read_b64_tr_b16 v[110:111], v60 offset:33792
    v_mfma_f32_32x32x16_bf16 v[80:95], v[116:119], a[56:59], v[80:95]
    buffer_load_dwordx4 a[104:107], v3, s[12:15], s37 offen offset:2048 sc1
    s_waitcnt vmcnt(12) lgkmcnt(5)
    s_nop 0
    v_mfma_f32_32x32x16_bf16 v[64:79], v[96:99], a[60:63], v[64:79]
    ds_read_b64_tr_b16 v[112:113], v19 offset:34816
    ds_read_b64_tr_b16 v[114:115], v19 offset:35840
    ds_read_b64_tr_b16 v[116:117], v60 offset:34816
    ds_read_b64_tr_b16 v[118:119], v60 offset:35840
    ds_read_b128 v[220:223], v216
    v_mfma_f32_32x32x16_bf16 v[80:95], v[100:103], a[60:63], v[80:95]
    buffer_load_dwordx4 a[108:111], v3, s[12:15], s37 offen offset:3072 sc1
    s_waitcnt vmcnt(12) lgkmcnt(5)
    v_mfma_f32_32x32x16_bf16 v[64:79], v[104:107], a[64:67], v[64:79]
    ds_read_b64_tr_b16 v[96:97], v19 offset:36864
    ds_read_b64_tr_b16 v[98:99], v19 offset:37888
    ds_read_b64_tr_b16 v[100:101], v60 offset:36864
    ds_read_b64_tr_b16 v[102:103], v60 offset:37888
    s_waitcnt lgkmcnt(4)
    v_min3_u32 v220, v220, v221, v222
    v_min_u32 v220, v220, v223
    v_cmp_gt_u32_e64 vcc, 1, v220
    s_nop 0
    s_cbranch_vccz .Lck44
    s_mov_b32 s34, 0
.Lckl45:
    ds_read_b128 v[220:223], v216
    s_add_u32 s34, s34, 1
    s_waitcnt lgkmcnt(0)
    v_min3_u32 v220, v220, v221, v222
    v_min_u32 v220, v220, v223
    v_cmp_gt_u32 vcc, 1, v220
    s_cmp_ge_u32 s34, 3000000
    s_cbranch_scc1 .Lck44
    s_cbranch_vccnz .Lckl45
.Lck44:
    v_mfma_f32_32x32x16_bf16 v[80:95], v[108:111], a[64:67], v[80:95]
    buffer_load_dwordx2 v[194:195], v204, s[12:15], 0 offen offset:0 sc1
    buffer_load_dwordx2 v[196:197], v204, s[12:15], 0 offen offset:512 sc1
    s_waitcnt vmcnt(13)
    s_nop 0
    v_mfma_f32_32x32x16_bf16 v[64:79], v[112:115], a[68:71], v[64:79]
    ds_read_b64_tr_b16 v[104:105], v19 offset:38912
    ds_read_b64_tr_b16 v[106:107], v19 offset:39936
    ds_read_b64_tr_b16 v[108:109], v60 offset:38912
    ds_read_b64_tr_b16 v[110:111], v60 offset:39936
    v_mfma_f32_32x32x16_bf16 v[80:95], v[116:119], a[68:71], v[80:95]
    buffer_load_dwordx2 v[198:199], v204, s[12:15], 0 offen offset:1024 sc1
    buffer_load_dwordx2 v[200:201], v204, s[12:15], 0 offen offset:1536 sc1
    s_waitcnt vmcnt(14) lgkmcnt(4)
    s_nop 0
    v_mfma_f32_32x32x16_bf16 v[64:79], v[96:99], a[72:75], v[64:79]
    ds_read_b64_tr_b16 v[112:113], v19 offset:40960
    ds_read_b64_tr_b16 v[114:115], v19 offset:41984
    ds_read_b64_tr_b16 v[116:117], v60 offset:40960
    ds_read_b64_tr_b16 v[118:119], v60 offset:41984
    v_mfma_f32_32x32x16_bf16 v[80:95], v[100:103], a[72:75], v[80:95]
    s_add_u32 m0, s45, 102400
    s_add_u32 s33, s43, 0
    buffer_load_dwordx4 v14, s[16:19], s33 offen lds
    s_waitcnt vmcnt(14) lgkmcnt(4)
    v_mfma_f32_32x32x16_bf16 v[64:79], v[104:107], a[76:79], v[64:79]
    ds_read_b64_tr_b16 v[96:97], v19 offset:43008
    ds_read_b64_tr_b16 v[98:99], v19 offset:44032
    ds_read_b64_tr_b16 v[100:101], v60 offset:43008
    ds_read_b64_tr_b16 v[102:103], v60 offset:44032
    v_mfma_f32_32x32x16_bf16 v[80:95], v[108:111], a[76:79], v[80:95]
    s_add_u32 m0, s45, 106496
    s_add_u32 s33, s43, 14336
    buffer_load_dwordx4 v14, s[16:19], s33 offen lds
    s_waitcnt vmcnt(14) lgkmcnt(4)
    s_nop 0
    v_mfma_f32_32x32x16_bf16 v[64:79], v[112:115], a[80:83], v[64:79]
    ds_read_b64_tr_b16 v[104:105], v19 offset:45056
    ds_read_b64_tr_b16 v[106:107], v19 offset:46080
    ds_read_b64_tr_b16 v[108:109], v60 offset:45056
    ds_read_b64_tr_b16 v[110:111], v60 offset:46080
    v_mfma_f32_32x32x16_bf16 v[80:95], v[116:119], a[80:83], v[80:95]
    s_add_u32 m0, s45, 110592
    s_add_u32 s33, s43, 28672
    buffer_load_dwordx4 v14, s[16:19], s33 offen lds
    s_waitcnt vmcnt(14) lgkmcnt(4)
    v_mfma_f32_32x32x16_bf16 v[64:79], v[96:99], a[84:87], v[64:79]
    ds_read_b64_tr_b16 v[112:113], v19 offset:47104
    ds_read_b64_tr_b16 v[114:115], v19 offset:48128
    ds_read_b64_tr_b16 v[116:117], v60 offset:47104
    ds_read_b64_tr_b16 v[118:119], v60 offset:48128
    s_cmp_lg_u32 s3, 0
    s_cbranch_scc1 .Lpoll46
    s_mov_b32 exec_lo, 0xffff
    s_mov_b32 exec_hi, 0
    s_waitcnt vmcnt(11)
    v_cmp_ne_u32 vcc, s30, v52
    s_nop 1
    s_cbranch_vccz .Lpollx47
    s_waitcnt vmcnt(0) lgkmcnt(0)
    s_mov_b32 s34, 0
.Lspin48:
    buffer_load_dword v52, v18, s[12:15], 0 offen sc1
    s_add_u32 s34, s34, 1
    s_waitcnt vmcnt(0)
    v_cmp_ne_u32_e64 vcc, s30, v52
    s_cmp_ge_u32 s34, 200000
    s_cbranch_scc1 .Lspun49
    s_cbranch_vccnz .Lspin48
.Lspun49:
    s_nop 1
.Lpollx47:
    s_mov_b64 exec, -1
.Lpoll46:
    v_mov_b32_e64 v217, 2
    ds_write_b32 v207, v217
    v_mfma_f32_32x32x16_bf16 v[80:95], v[100:103], a[84:87], v[80:95]
    s_add_u32 m0, s45, 114688
    s_add_u32 s33, s43, 43008
    buffer_load_dwordx4 v14, s[16:19], s33 offen lds
    s_waitcnt vmcnt(14) lgkmcnt(5)
    s_nop 0
    v_mfma_f32_32x32x16_bf16 v[64:79], v[104:107], a[88:91], v[64:79]
    ds_read_b64_tr_b16 v[96:97], v19 offset:49152
    ds_read_b64_tr_b16 v[98:99], v19 offset:50176
    ds_read_b64_tr_b16 v[100:101], v60 offset:49152
    ds_read_b64_tr_b16 v[102:103], v60 offset:50176
    v_mfma_f32_32x32x16_bf16 v[80:95], v[108:111], a[88:91], v[80:95]
    s_add_u32 m0, s45, 118784
    s_add_u32 s33, s43, 100352
    buffer_load_dwordx4 v14, s[16:19], s33 offen lds
    s_waitcnt vmcnt(14) lgkmcnt(5)
    s_nop 0
    v_mfma_f32_32x32x16_bf16 v[64:79], v[112:115], a[92:95], v[64:79]
    ds_read_b64_tr_b16 v[104:105], v19 offset:51200
    ds_read_b64_tr_b16 v[106:107], v19 offset:52224
    ds_read_b64_tr_b16 v[108:109], v60 offset:51200
    ds_read_b64_tr_b16 v[110:111], v60 offset:52224
    ds_read_b128 v[220:223], v216
    v_mfma_f32_32x32x16_bf16 v[80:95], v[116:119], a[92:95], v[80:95]
    s_add_u32 m0, s45, 122880
    s_add_u32 s33, s43, 114688
    buffer_load_dwordx4 v14, s[16:19], s33 offen lds
    s_waitcnt vmcnt(13) lgkmcnt(5)
    v_mfma_f32_32x32x16_bf16 v[64:79], v[96:99], a[96:99], v[64:79]
    ds_read_b64_tr_b16 v[112:113], v19 offset:53248
    ds_read_b64_tr_b16 v[114:115], v19 offset:54272
    ds_read_b64_tr_b16 v[116:117], v60 offset:53248
    ds_read_b64_tr_b16 v[118:119], v60 offset:54272
    s_waitcnt lgkmcnt(4)
    v_min3_u32 v220, v220, v221, v222
    v_min_u32 v220, v220, v223
    v_cmp_gt_u32_e64 vcc, 2, v220
    s_nop 0
    s_cbranch_vccz .Lck50
    s_mov_b32 s34, 0
.Lckl51:
    ds_read_b128 v[220:223], v216
    s_add_u32 s34, s34, 1
    s_waitcnt lgkmcnt(0)
    v_min3_u32 v220, v220, v221, v222
    v_min_u32 v220, v220, v223
    v_cmp_gt_u32 vcc, 2, v220
    s_cmp_ge_u32 s34, 3000000
    s_cbranch_scc1 .Lck50
    s_cbranch_vccnz .Lckl51
.Lck50:
    s_waitcnt vmcnt(6)
    v_cndmask_b32 v200, 0, v200, s[56:57]
    v_cndmask_b32 v201, 0, v201, s[56:57]
    v_add_f32 v194, v194, v196
    v_add_f32_e64 v198, v198, v200
    v_mfma_f32_32x32x16_bf16 v[80:95], v[100:103], a[96:99], v[80:95]
    buffer_load_dwordx4 v[208:211], v205, s[12:15], s51 offen sc1
    s_add_u32 s51, s51, 32768
    v_add_f32 v194, v194, v198
    v_add_f32 v195, v195, v197
    v_add_f32 v199, v199, v201
    v_add_f32 v195, v195, v199
    v_mfma_f32_32x32x16_bf16 v[64:79], v[104:107], a[100:103], v[64:79]
    ds_read_b64_tr_b16 v[96:97], v19 offset:55296
    ds_read_b64_tr_b16 v[98:99], v19 offset:56320
    ds_read_b64_tr_b16 v[100:101], v60 offset:55296
    ds_read_b64_tr_b16 v[102:103], v60 offset:56320
    v_mov_b32 v4, v194
    s_nop 1
    v_permlane32_swap_b32 v194, v4
    v_add_f32 v194, v194, v4
    v_mov_b32_e64 v5, v195
    v_mfma_f32_32x32x16_bf16 v[80:95], v[108:111], a[100:103], v[80:95]
    buffer_load_dwordx4 v[212:215], v205, s[12:15], s51 offen sc1
    v_permlane32_swap_b32 v195, v5
    v_add_f32 v195, v195, v5
    v_mul_f32 v196, 0x3b124925, v194
    v_mul_f32 v4, 0x3b124925, v195
    s_waitcnt lgkmcnt(4)
    s_nop 0
    v_mfma_f32_32x32x16_bf16 v[64:79], v[112:115], a[104:107], v[64:79]
    ds_read_b64_tr_b16 v[104:105], v61 offset:0
    ds_read_b64_tr_b16 v[106:107], v61 offset:768
    ds_read_b64_tr_b16 v[108:109], v61 offset:1536
    ds_read_b64_tr_b16 v[110:111], v61 offset:2304
    v_fma_f32 v4, -v196, v196, v4
    v_max_f32_e64 v4, 0, v4
    v_cvt_pk_bf16_f32 v136, -v196, -v196
    v_and_b32 v5, 0xffff0000, v136
    v_mfma_f32_32x32x16_bf16 v[80:95], v[116:119], a[104:107], v[80:95]
    s_add_u32 m0, s45, 126976
    s_add_u32 s33, s43, 129024
    buffer_load_dwordx4 v14, s[16:19], s33 offen lds
    v_add_f32_e64 v5, v196, v5
    v_cvt_pk_bf16_f32 v137, -v5, 0
    v_mov_b32 v138, 0
    v_mov_b32_e64 v139, 0
    s_waitcnt lgkmcnt(4)
    v_mfma_f32_32x32x16_bf16 v[64:79], v[96:99], a[108:111], v[64:79]
    ds_read_b64_tr_b16 v[112:113], v61 offset:3072
    ds_read_b64_tr_b16 v[114:115], v61 offset:3840
    ds_read_b64_tr_b16 v[116:117], v61 offset:4608
    ds_read_b64_tr_b16 v[118:119], v61 offset:5376
    v_add_f32 v4, 0x3727c5ac, v4
    v_rsq_f32 v197, v4
    s_nop 0
    v_mul_f32_e64 v200, v4, v197
    v_mul_f32 v198, 0xc0135761, v197
    v_mfma_f32_32x32x16_bf16 v[80:95], v[100:103], a[108:111], v[80:95]
    s_add_u32 m0, s45, 131072
    s_add_u32 s33, s43, 143360
    buffer_load_dwordx4 v14, s[16:19], s33 offen lds
    v_mul_f32_e64 v4, v197, v197
    v_mul_f32 v4, 0x3d372713, v4
    v_mul_f32_e64 v199, v4, v198
    v_mfma_f32_32x32x16_bf16 v[64:79], v[120:123], v[136:139], v[64:79]
    v_mfma_f32_32x32x16_bf16 v[80:95], v[124:127], v[136:139], v[80:95]
    s_add_u32 m0, s45, 135168
    s_add_u32 s33, s43, 200704
    buffer_load_dwordx4 v14, s[16:19], s33 offen lds
    s_nop 7
    s_nop 0
    v_pk_mul_f32 v[140:141], v[64:65], v[64:65]
    v_pk_mul_f32 v[142:143], v[66:67], v[66:67]
    v_pk_mul_f32 v[144:145], v[68:69], v[68:69]
    v_pk_mul_f32 v[146:147], v[70:71], v[70:71]
    v_pk_mul_f32 v[148:149], v[72:73], v[72:73]
    v_pk_mul_f32 v[150:151], v[74:75], v[74:75]
    v_pk_mul_f32 v[152:153], v[76:77], v[76:77]
    v_pk_mul_f32 v[154:155], v[78:79], v[78:79]
    v_pk_fma_f32 v[140:141], v[140:141], v[198:199], v[198:199] op_sel:[0,1,0] op_sel_hi:[1,1,0]
    v_pk_fma_f32 v[142:143], v[142:143], v[198:199], v[198:199] op_sel:[0,1,0] op_sel_hi:[1,1,0]
    v_pk_fma_f32 v[144:145], v[144:145], v[198:199], v[198:199] op_sel:[0,1,0] op_sel_hi:[1,1,0]
    v_pk_fma_f32 v[146:147], v[146:147], v[198:199], v[198:199] op_sel:[0,1,0] op_sel_hi:[1,1,0]
    v_pk_fma_f32 v[148:149], v[148:149], v[198:199], v[198:199] op_sel:[0,1,0] op_sel_hi:[1,1,0]
    v_pk_fma_f32 v[150:151], v[150:151], v[198:199], v[198:199] op_sel:[0,1,0] op_sel_hi:[1,1,0]
    s_waitcnt vmcnt(8)
    v_mov_b32 v217, 3
    ds_write_b32 v207, v217
    s_add_u32 m0, s45, 139264
    s_add_u32 s33, s43, 215040
    buffer_load_dwordx4 v14, s[16:19], s33 offen lds
    v_pk_fma_f32 v[152:153], v[152:153], v[198:199], v[198:199] op_sel:[0,1,0] op_sel_hi:[1,1,0]
    v_pk_fma_f32 v[154:155], v[154:155], v[198:199], v[198:199] op_sel:[0,1,0] op_sel_hi:[1,1,0]
    v_pk_mul_f32 v[140:141], v[140:141], v[64:65]
    v_pk_mul_f32 v[142:143], v[142:143], v[66:67]
    v_pk_mul_f32 v[144:145], v[144:145], v[68:69]
    v_pk_mul_f32 v[146:147], v[146:147], v[70:71]
    v_pk_mul_f32 v[148:149], v[148:149], v[72:73]
    v_pk_mul_f32 v[150:151], v[150:151], v[74:75]
    v_pk_mul_f32 v[152:153], v[152:153], v[76:77]
    v_pk_mul_f32 v[154:155], v[154:155], v[78:79]
    v_exp_f32 v140, v140
    v_exp_f32 v141, v141
    v_exp_f32 v142, v142
    v_exp_f32 v143, v143
    s_add_u32 m0, s45, 143360
    s_add_u32 s33, s43, 229376
    buffer_load_dwordx4 v14, s[16:19], s33 offen lds
    v_exp_f32 v144, v144
    v_exp_f32 v145, v145
    v_exp_f32 v146, v146
    v_exp_f32 v147, v147
    v_exp_f32 v148, v148
    v_exp_f32 v149, v149
    v_exp_f32 v150, v150
    v_exp_f32 v151, v151
    v_exp_f32 v152, v152
    v_exp_f32 v153, v153
    v_exp_f32 v154, v154
    v_exp_f32 v155, v155
    v_pk_fma_f32 v[140:141], v[140:141], v[200:201], v[200:201] op_sel_hi:[1,0,0]
    v_pk_fma_f32 v[142:143], v[142:143], v[200:201], v[200:201] op_sel_hi:[1,0,0]
    ds_read_b128 v[220:223], v216
    s_add_u32 m0, s45, 147456
    s_add_u32 s33, s43, 243712
    buffer_load_dwordx4 v14, s[16:19], s33 offen lds
    v_pk_fma_f32 v[144:145], v[144:145], v[200:201], v[200:201] op_sel_hi:[1,0,0]
    v_pk_fma_f32 v[146:147], v[146:147], v[200:201], v[200:201] op_sel_hi:[1,0,0]
    v_pk_fma_f32 v[148:149], v[148:149], v[200:201], v[200:201] op_sel_hi:[1,0,0]
    v_pk_fma_f32 v[150:151], v[150:151], v[200:201], v[200:201] op_sel_hi:[1,0,0]
    v_pk_fma_f32 v[152:153], v[152:153], v[200:201], v[200:201] op_sel_hi:[1,0,0]
    v_pk_fma_f32 v[154:155], v[154:155], v[200:201], v[200:201] op_sel_hi:[1,0,0]
    v_rcp_f32 v140, v140
    v_rcp_f32 v141, v141
    v_rcp_f32 v142, v142
    v_rcp_f32 v143, v143
    v_rcp_f32 v144, v144
    v_rcp_f32 v145, v145
    v_rcp_f32 v146, v146
    v_rcp_f32_e64 v147, v147
    s_waitcnt lgkmcnt(0)
    v_min3_u32 v220, v220, v221, v222
    v_min_u32 v220, v220, v223
    v_cmp_gt_u32_e64 vcc, 3, v220
    s_nop 0
    s_cbranch_vccz .Lck52
    s_mov_b32 s34, 0
.Lckl53:
    ds_read_b128 v[220:223], v216
    s_add_u32 s34, s34, 1
    s_waitcnt lgkmcnt(0)
    v_min3_u32 v220, v220, v221, v222
    v_min_u32 v220, v220, v223
    v_cmp_gt_u32 vcc, 3, v220
    s_cmp_ge_u32 s34, 3000000
    s_cbranch_scc1 .Lck52
    s_cbranch_vccnz .Lckl53
.Lck52:
    s_add_u32 m0, s45, 151552
    s_add_u32 s33, s43, 301056
    buffer_load_dwordx4 v14, s[16:19], s33 offen lds
    v_rcp_f32 v148, v148
    v_rcp_f32 v149, v149
    v_rcp_f32 v150, v150
    v_rcp_f32 v151, v151
    v_rcp_f32 v152, v152
    v_rcp_f32 v153, v153
    v_rcp_f32 v154, v154
    v_rcp_f32 v155, v155
    v_pk_mul_f32 v[140:141], v[140:141], v[64:65]
    v_pk_mul_f32 v[142:143], v[142:143], v[66:67]
    v_pk_mul_f32 v[144:145], v[144:145], v[68:69]
    v_pk_mul_f32 v[146:147], v[146:147], v[70:71]
    v_pk_mul_f32 v[148:149], v[148:149], v[72:73]
    v_pk_mul_f32 v[150:151], v[150:151], v[74:75]
    s_add_u32 m0, s45, 155648
    s_add_u32 s33, s43, 315392
    buffer_load_dwordx4 v14, s[16:19], s33 offen lds
    v_pk_mul_f32 v[152:153], v[152:153], v[76:77]
    v_pk_mul_f32 v[154:155], v[154:155], v[78:79]
    v_cvt_pk_bf16_f32 v156, v140, v141
    v_cvt_pk_bf16_f32 v157, v142, v143
    v_cvt_pk_bf16_f32 v158, v144, v145
    v_cvt_pk_bf16_f32 v159, v146, v147
    v_cvt_pk_bf16_f32 v160, v148, v149
    v_cvt_pk_bf16_f32 v161, v150, v151
    v_cvt_pk_bf16_f32 v162, v152, v153
    v_cvt_pk_bf16_f32 v163, v154, v155
    buffer_store_dwordx4 v[156:159], v3, s[12:15], s52 offen offset:0 sc1
    buffer_store_dwordx4 v[160:163], v3, s[12:15], s52 offen offset:1024 sc1
    v_pk_mul_f32 v[140:141], v[80:81], v[80:81]
    v_pk_mul_f32 v[142:143], v[82:83], v[82:83]
    s_add_u32 m0, s45, 0
    s_nop 0
    s_add_u32 s33, s43, 329728
    buffer_load_dwordx4 v14, s[16:19], s33 offen lds
    v_pk_mul_f32 v[144:145], v[84:85], v[84:85]
    v_pk_mul_f32 v[146:147], v[86:87], v[86:87]
    v_pk_mul_f32 v[148:149], v[88:89], v[88:89]
    v_pk_mul_f32 v[150:151], v[90:91], v[90:91]
    v_pk_mul_f32 v[152:153], v[92:93], v[92:93]
    v_pk_mul_f32 v[154:155], v[94:95], v[94:95]
    v_pk_fma_f32 v[140:141], v[140:141], v[198:199], v[198:199] op_sel:[0,1,0] op_sel_hi:[1,1,0]
    v_pk_fma_f32 v[142:143], v[142:143], v[198:199], v[198:199] op_sel:[0,1,0] op_sel_hi:[1,1,0]
    v_pk_fma_f32 v[144:145], v[144:145], v[198:199], v[198:199] op_sel:[0,1,0] op_sel_hi:[1,1,0]
    v_pk_fma_f32 v[146:147], v[146:147], v[198:199], v[198:199] op_sel:[0,1,0] op_sel_hi:[1,1,0]
    v_pk_fma_f32 v[148:149], v[148:149], v[198:199], v[198:199] op_sel:[0,1,0] op_sel_hi:[1,1,0]
    v_pk_fma_f32 v[150:151], v[150:151], v[198:199], v[198:199] op_sel:[0,1,0] op_sel_hi:[1,1,0]
    v_pk_fma_f32 v[152:153], v[152:153], v[198:199], v[198:199] op_sel:[0,1,0] op_sel_hi:[1,1,0]
    v_pk_fma_f32 v[154:155], v[154:155], v[198:199], v[198:199] op_sel:[0,1,0] op_sel_hi:[1,1,0]
    s_add_u32 m0, s45, 4096
    s_add_u32 s33, s43, 344064
    buffer_load_dwordx4 v14, s[16:19], s33 offen lds
    v_pk_mul_f32 v[140:141], v[140:141], v[80:81]
    v_pk_mul_f32 v[142:143], v[142:143], v[82:83]
    v_pk_mul_f32 v[144:145], v[144:145], v[84:85]
    v_pk_mul_f32 v[146:147], v[146:147], v[86:87]
    v_pk_mul_f32 v[148:149], v[148:149], v[88:89]
    v_pk_mul_f32 v[150:151], v[150:151], v[90:91]
    v_pk_mul_f32 v[152:153], v[152:153], v[92:93]
    v_pk_mul_f32 v[154:155], v[154:155], v[94:95]
    v_exp_f32 v140, v140
    v_exp_f32 v141, v141
    v_exp_f32 v142, v142
    v_exp_f32 v143, v143
    v_exp_f32 v144, v144
    v_exp_f32 v145, v145
    s_add_u32 m0, s45, 8192
    s_add_u32 s33, s43, 401408
    buffer_load_dwordx4 v14, s[16:19], s33 offen lds
    v_exp_f32 v146, v146
    v_exp_f32 v147, v147
    v_exp_f32 v148, v148
    v_exp_f32 v149, v149
    v_exp_f32 v150, v150
    v_exp_f32 v151, v151
    v_exp_f32 v152, v152
    v_exp_f32 v153, v153
    v_exp_f32 v154, v154
    v_exp_f32 v155, v155
    v_pk_fma_f32 v[140:141], v[140:141], v[200:201], v[200:201] op_sel_hi:[1,0,0]
    v_pk_fma_f32 v[142:143], v[142:143], v[200:201], v[200:201] op_sel_hi:[1,0,0]
    v_pk_fma_f32 v[144:145], v[144:145], v[200:201], v[200:201] op_sel_hi:[1,0,0]
    v_pk_fma_f32 v[146:147], v[146:147], v[200:201], v[200:201] op_sel_hi:[1,0,0]
    s_add_u32 m0, s45, 12288
    s_add_u32 s33, s43, 415744
    buffer_load_dwordx4 v14, s[16:19], s33 offen lds
    v_pk_fma_f32 v[148:149], v[148:149], v[200:201], v[200:201] op_sel_hi:[1,0,0]
    v_pk_fma_f32 v[150:151], v[150:151], v[200:201], v[200:201] op_sel_hi:[1,0,0]
    v_pk_fma_f32 v[152:153], v[152:153], v[200:201], v[200:201] op_sel_hi:[1,0,0]
    v_pk_fma_f32 v[154:155], v[154:155], v[200:201], v[200:201] op_sel_hi:[1,0,0]
    v_rcp_f32 v140, v140
    v_rcp_f32 v141, v141
    v_rcp_f32 v142, v142
    v_rcp_f32 v143, v143
    v_rcp_f32 v144, v144
    v_rcp_f32 v145, v145
    v_rcp_f32 v146, v146
    v_rcp_f32 v147, v147
    v_rcp_f32 v148, v148
    v_rcp_f32 v149, v149
    s_add_u32 m0, s45, 16384
    s_add_u32 s33, s43, 430080
    buffer_load_dwordx4 v14, s[16:19], s33 offen lds
    v_rcp_f32 v150, v150
    v_rcp_f32 v151, v151
    v_rcp_f32 v152, v152
    v_rcp_f32 v153, v153
    v_rcp_f32 v154, v154
    v_rcp_f32 v155, v155
    v_pk_mul_f32 v[140:141], v[140:141], v[80:81]
    v_pk_mul_f32 v[142:143], v[142:143], v[82:83]
    v_pk_mul_f32 v[144:145], v[144:145], v[84:85]
    v_pk_mul_f32 v[146:147], v[146:147], v[86:87]
    v_pk_mul_f32 v[148:149], v[148:149], v[88:89]
    v_pk_mul_f32 v[150:151], v[150:151], v[90:91]
    v_pk_mul_f32 v[152:153], v[152:153], v[92:93]
    v_pk_mul_f32 v[154:155], v[154:155], v[94:95]
    s_add_u32 m0, s45, 20480
    s_add_u32 s33, s43, 444416
    buffer_load_dwordx4 v14, s[16:19], s33 offen lds
    v_cvt_pk_bf16_f32 v164, v140, v141
    v_cvt_pk_bf16_f32 v165, v142, v143
    v_cvt_pk_bf16_f32 v166, v144, v145
    v_cvt_pk_bf16_f32 v167, v146, v147
    v_cvt_pk_bf16_f32 v168, v148, v149
    v_cvt_pk_bf16_f32 v169, v150, v151
    v_cvt_pk_bf16_f32 v170, v152, v153
    v_cvt_pk_bf16_f32 v171, v154, v155
    buffer_store_dwordx4 v[164:167], v3, s[12:15], s52 offen offset:2048 sc1
    buffer_store_dwordx4 v[168:171], v3, s[12:15], s52 offen offset:3072 sc1
    s_add_u32 s52, s52, 4096
    s_mov_b32 s58, 0x3f80
    s_mov_b32 s59, 0x3f800000
    s_waitcnt vmcnt(19)
    v_dot2_f32_bf16 v140, v208, s58, 0
    v_dot2_f32_bf16 v141, v208, s59, 0
    v_dot2_f32_bf16 v142, v209, s58, 0
    v_dot2_f32_bf16 v143, v209, s59, 0
    v_dot2_f32_bf16 v144, v210, s58, 0
    v_dot2_f32_bf16 v145, v210, s59, 0
    v_dot2_f32_bf16 v146, v211, s58, 0
    v_dot2_f32_bf16 v147, v211, s59, 0
    s_waitcnt vmcnt(18)
    s_nop 0
    v_dot2_f32_bf16 v140, v212, s58, v140
    v_dot2_f32_bf16 v141, v212, s59, v141
    v_dot2_f32_bf16 v142, v213, s58, v142
    v_dot2_f32_bf16 v143, v213, s59, v143
    v_dot2_f32_bf16 v144, v214, s58, v144
    v_dot2_f32_bf16 v145, v214, s59, v145
    v_dot2_f32_bf16 v146, v215, s58, v146
    v_dot2_f32_bf16 v147, v215, s59, v147
    v_permlane32_swap_b32 v140, v144
    v_permlane32_swap_b32 v141, v145
    v_permlane32_swap_b32 v142, v146
    v_permlane32_swap_b32 v143, v147
    v_add_f32 v140, v140, v144
    v_add_f32 v141, v141, v145
    v_add_f32 v142, v142, v146
    v_add_f32 v143, v143, v147
    s_nop 0
    v_permlane16_swap_b32 v140, v142
    v_permlane16_swap_b32 v141, v143
    v_add_f32 v140, v140, v142
    v_add_f32 v141, v141, v143
    s_nop 0
    v_add_f32_dpp v140, v140, v140 row_ror:8 row_mask:0xf bank_mask:0xf
    v_add_f32_dpp v141, v141, v141 row_ror:8 row_mask:0xf bank_mask:0xf
    v_cvt_pk_bf16_f32 v208, v140, v141
    buffer_store_dword v208, v206, s[12:15], s55 offen sc1
    v_mfma_f32_32x32x16_bf16 v[64:79], v[104:107], a[0:3], 0
    ds_read_b64_tr_b16 v[96:97], v61 offset:6144
    ds_read_b64_tr_b16 v[98:99], v61 offset:6912
    ds_read_b64_tr_b16 v[100:101], v61 offset:7680
    ds_read_b64_tr_b16 v[102:103], v61 offset:8448
    s_waitcnt vmcnt(13)
    v_mov_b32 v217, 4
    ds_write_b32 v207, v217
    v_mfma_f32_32x32x16_bf16 v[64:79], v[108:111], a[4:7], v[64:79]
    s_add_u32 m0, s45, 24576
    s_add_u32 s33, s43, 501760
    buffer_load_dwordx4 v14, s[16:19], s33 offen lds
    ds_read_b64_tr_b16 v[172:173], v17 offset:36864
    ds_read_b64_tr_b16 v[174:175], v17 offset:37888
    ds_read_b64_tr_b16 v[176:177], v63 offset:36864
    ds_read_b64_tr_b16 v[178:179], v63 offset:37888
    v_mfma_f32_32x32x16_bf16 v[64:79], v[112:115], a[8:11], v[64:79]
    ds_read_b64_tr_b16 v[104:105], v61 offset:9216
    ds_read_b64_tr_b16 v[106:107], v61 offset:9984
    ds_read_b64_tr_b16 v[108:109], v61 offset:10752
    ds_read_b64_tr_b16 v[110:111], v61 offset:11520
    v_mfma_f32_32x32x16_bf16 v[64:79], v[116:119], a[12:15], v[64:79]
    s_add_u32 m0, s45, 28672
    s_add_u32 s33, s43, 516096
    buffer_load_dwordx4 v14, s[16:19], s33 offen lds
    ds_read_b64_tr_b16 v[180:181], v17 offset:40960
    ds_read_b64_tr_b16 v[182:183], v17 offset:41984
    ds_read_b64_tr_b16 v[184:185], v63 offset:40960
    ds_read_b64_tr_b16 v[186:187], v63 offset:41984
    s_waitcnt lgkmcnt(13)
    s_nop 0
    v_mfma_f32_32x32x16_bf16 v[64:79], v[96:99], a[16:19], v[64:79]
    ds_read_b64_tr_b16 v[112:113], v61 offset:12288
    ds_read_b64_tr_b16 v[114:115], v61 offset:13056
    ds_read_b64_tr_b16 v[116:117], v61 offset:13824
    ds_read_b64_tr_b16 v[118:119], v61 offset:14592
    ds_read_b128 v[220:223], v216
    v_mfma_f32_32x32x16_bf16 v[64:79], v[100:103], a[20:23], v[64:79]
    s_add_u32 m0, s45, 32768
    s_add_u32 s33, s43, 530432
    buffer_load_dwordx4 v14, s[16:19], s33 offen lds
    ds_read_b64_tr_b16 v[52:53], v17 offset:45056
    ds_read_b64_tr_b16 v[54:55], v17 offset:46080
    ds_read_b64_tr_b16 v[56:57], v63 offset:45056
    ds_read_b64_tr_b16 v[58:59], v63 offset:46080
    s_waitcnt lgkmcnt(13)
    v_mfma_f32_32x32x16_bf16 v[64:79], v[104:107], a[24:27], v[64:79]
    ds_read_b64_tr_b16 v[96:97], v61 offset:15360
    ds_read_b64_tr_b16 v[98:99], v61 offset:16128
    ds_read_b64_tr_b16 v[100:101], v61 offset:16896
    ds_read_b64_tr_b16 v[102:103], v61 offset:17664
    s_waitcnt lgkmcnt(8)
    v_min3_u32 v220, v220, v221, v222
    v_min_u32 v220, v220, v223
    v_cmp_gt_u32_e64 vcc, 4, v220
    s_nop 0
    s_cbranch_vccz .Lck54
    s_mov_b32 s34, 0
.Lckl55:
    ds_read_b128 v[220:223], v216
    s_add_u32 s34, s34, 1
    s_waitcnt lgkmcnt(0)
    v_min3_u32 v220, v220, v221, v222
    v_min_u32 v220, v220, v223
    v_cmp_gt_u32 vcc, 4, v220
    s_cmp_ge_u32 s34, 3000000
    s_cbranch_scc1 .Lck54
    s_cbranch_vccnz .Lckl55
.Lck54:
    v_mfma_f32_32x32x16_bf16 v[64:79], v[108:111], a[28:31], v[64:79]
    s_add_u32 m0, s45, 36864
    s_add_u32 s33, s43, 544768
    buffer_load_dwordx4 v14, s[16:19], s33 offen lds
    ds_read_b64_tr_b16 v[120:121], v17 offset:49152
    ds_read_b64_tr_b16 v[122:123], v17 offset:50176
    ds_read_b64_tr_b16 v[124:125], v63 offset:49152
    ds_read_b64_tr_b16 v[126:127], v63 offset:50176
    v_mfma_f32_32x32x16_bf16 v[64:79], v[112:115], a[32:35], v[64:79]
    ds_read_b64_tr_b16 v[104:105], v61 offset:18432
    ds_read_b64_tr_b16 v[106:107], v61 offset:19200
    ds_read_b64_tr_b16 v[108:109], v61 offset:19968
    ds_read_b64_tr_b16 v[110:111], v61 offset:20736
    v_mfma_f32_32x32x16_bf16 v[64:79], v[116:119], a[36:39], v[64:79]
    s_add_u32 m0, s45, 40960
    s_add_u32 s33, s43, 602112
    buffer_load_dwordx4 v14, s[16:19], s33 offen lds
    ds_read_b64_tr_b16 v[208:209], v17 offset:53248
    ds_read_b64_tr_b16 v[210:211], v17 offset:54272
    ds_read_b64_tr_b16 v[212:213], v63 offset:53248
    ds_read_b64_tr_b16 v[214:215], v63 offset:54272
    s_waitcnt lgkmcnt(12)
    s_nop 0
    v_mfma_f32_32x32x16_bf16 v[64:79], v[96:99], a[40:43], v[64:79]
    ds_read_b64_tr_b16 v[112:113], v61 offset:21504
    ds_read_b64_tr_b16 v[114:115], v61 offset:22272
    ds_read_b64_tr_b16 v[116:117], v61 offset:23040
    ds_read_b64_tr_b16 v[118:119], v61 offset:23808
    v_mfma_f32_32x32x16_bf16 v[64:79], v[100:103], a[44:47], v[64:79]
    s_add_u32 m0, s45, 45056
    s_add_u32 s33, s43, 616448
    buffer_load_dwordx4 v14, s[16:19], s33 offen lds
    ds_read_b64_tr_b16 v[228:229], v17 offset:57344
    ds_read_b64_tr_b16 v[230:231], v17 offset:58368
    ds_read_b64_tr_b16 v[232:233], v63 offset:57344
    ds_read_b64_tr_b16 v[234:235], v63 offset:58368
    s_waitcnt lgkmcnt(12)
    v_mfma_f32_32x32x16_bf16 v[64:79], v[104:107], a[48:51], v[64:79]
    ds_read_b64_tr_b16 v[96:97], v61 offset:24576
    ds_read_b64_tr_b16 v[98:99], v61 offset:25344
    ds_read_b64_tr_b16 v[100:101], v61 offset:26112
    ds_read_b64_tr_b16 v[102:103], v61 offset:26880
    s_waitcnt vmcnt(11)
    v_mov_b32_e64 v217, 5
    ds_write_b32 v207, v217
    v_mfma_f32_32x32x16_bf16 v[64:79], v[108:111], a[52:55], v[64:79]
    s_add_u32 m0, s45, 49152
    s_add_u32 s33, s43, 630784
    buffer_load_dwordx4 v14, s[16:19], s33 offen lds
    ds_read_b64_tr_b16 v[236:237], v17 offset:61440
    ds_read_b64_tr_b16 v[238:239], v17 offset:62464
    ds_read_b64_tr_b16 v[240:241], v63 offset:61440
    ds_read_b64_tr_b16 v[242:243], v63 offset:62464
    s_waitcnt lgkmcnt(13)
    s_nop 0
    v_mfma_f32_32x32x16_bf16 v[64:79], v[112:115], a[56:59], v[64:79]
    ds_read_b64_tr_b16 v[104:105], v61 offset:27648
    ds_read_b64_tr_b16 v[106:107], v61 offset:28416
    ds_read_b64_tr_b16 v[108:109], v61 offset:29184
    ds_read_b64_tr_b16 v[110:111], v61 offset:29952
    v_mfma_f32_32x32x16_bf16 v[64:79], v[116:119], a[60:63], v[64:79]
    s_add_u32 m0, s45, 53248
    s_add_u32 s33, s43, 645120
    buffer_load_dwordx4 v14, s[16:19], s33 offen lds
    ds_read_b64_tr_b16 v[244:245], v188 offset:0
    ds_read_b64_tr_b16 v[246:247], v188 offset:1024
    ds_read_b64_tr_b16 v[248:249], v189 offset:0
    ds_read_b64_tr_b16 v[250:251], v189 offset:1024
    s_waitcnt lgkmcnt(13)
    s_nop 0
    v_mfma_f32_32x32x16_bf16 v[64:79], v[96:99], a[64:67], v[64:79]
    ds_read_b64_tr_b16 v[112:113], v61 offset:30720
    ds_read_b64_tr_b16 v[114:115], v61 offset:31488
    ds_read_b64_tr_b16 v[116:117], v61 offset:32256
    ds_read_b64_tr_b16 v[118:119], v61 offset:33024
    ds_read_b128 v[220:223], v216
    v_mfma_f32_32x32x16_bf16 v[64:79], v[100:103], a[68:71], v[64:79]
    s_waitcnt lgkmcnt(9)
    v_mfma_f32_32x32x16_bf16 v[64:79], v[104:107], a[72:75], v[64:79]
    ds_read_b64_tr_b16 v[96:97], v61 offset:33792
    ds_read_b64_tr_b16 v[98:99], v61 offset:34560
    ds_read_b64_tr_b16 v[100:101], v61 offset:35328
    ds_read_b64_tr_b16 v[102:103], v61 offset:36096
    s_waitcnt lgkmcnt(4)
    v_min3_u32 v220, v220, v221, v222
    v_min_u32 v220, v220, v223
    v_cmp_gt_u32_e64 vcc, 5, v220
    s_nop 0
    s_cbranch_vccz .Lck56
    s_mov_b32 s34, 0
.Lckl57:
    ds_read_b128 v[220:223], v216
    s_add_u32 s34, s34, 1
    s_waitcnt lgkmcnt(0)
    v_min3_u32 v220, v220, v221, v222
    v_min_u32 v220, v220, v223
    v_cmp_gt_u32 vcc, 5, v220
    s_cmp_ge_u32 s34, 3000000
    s_cbranch_scc1 .Lck56
    s_cbranch_vccnz .Lckl57
.Lck56:
    s_waitcnt vmcnt(7)
    v_mov_b32 v217, 6
    ds_write_b32 v207, v217
    v_mfma_f32_32x32x16_bf16 v[64:79], v[108:111], a[76:79], v[64:79]
    s_add_u32 m0, s45, 102400
    s_add_u32 s33, s43, 702464
    buffer_load_dwordx4 v14, s[16:19], s33 offen lds
    v_mfma_f32_32x32x16_bf16 v[64:79], v[112:115], a[80:83], v[64:79]
    ds_read_b64_tr_b16 v[104:105], v61 offset:36864
    ds_read_b64_tr_b16 v[106:107], v61 offset:37632
    ds_read_b64_tr_b16 v[108:109], v61 offset:38400
    ds_read_b64_tr_b16 v[110:111], v61 offset:39168
    v_mfma_f32_32x32x16_bf16 v[64:79], v[116:119], a[84:87], v[64:79]
    s_add_u32 m0, s45, 106496
    s_add_u32 s33, s43, 716800
    buffer_load_dwordx4 v14, s[16:19], s33 offen lds
    s_waitcnt lgkmcnt(5)
    s_nop 0
    v_mfma_f32_32x32x16_bf16 v[64:79], v[96:99], a[88:91], v[64:79]
    ds_read_b64_tr_b16 v[112:113], v61 offset:39936
    ds_read_b64_tr_b16 v[114:115], v61 offset:40704
    ds_read_b64_tr_b16 v[116:117], v61 offset:41472
    ds_read_b64_tr_b16 v[118:119], v61 offset:42240
    ds_read_b128 v[220:223], v216
    v_mfma_f32_32x32x16_bf16 v[64:79], v[100:103], a[92:95], v[64:79]
    s_add_u32 m0, s45, 110592
    s_add_u32 s33, s43, 731136
    buffer_load_dwordx4 v14, s[16:19], s33 offen lds
    s_waitcnt lgkmcnt(5)
    v_mfma_f32_32x32x16_bf16 v[64:79], v[104:107], a[96:99], v[64:79]
    ds_read_b64_tr_b16 v[96:97], v62 offset:0
    ds_read_b64_tr_b16 v[98:99], v62 offset:768
    ds_read_b64_tr_b16 v[100:101], v62 offset:1536
    ds_read_b64_tr_b16 v[102:103], v62 offset:2304
    s_waitcnt lgkmcnt(4)
    v_min3_u32 v220, v220, v221, v222
    v_min_u32 v220, v220, v223
    v_cmp_gt_u32_e64 vcc, 6, v220
    s_nop 0
    s_cbranch_vccz .Lck58
    s_mov_b32 s34, 0
.Lckl59:
    ds_read_b128 v[220:223], v216
    s_add_u32 s34, s34, 1
    s_waitcnt lgkmcnt(0)
    v_min3_u32 v220, v220, v221, v222
    v_min_u32 v220, v220, v223
    v_cmp_gt_u32 vcc, 6, v220
    s_cmp_ge_u32 s34, 3000000
    s_cbranch_scc1 .Lck58
    s_cbranch_vccnz .Lckl59
.Lck58:
    s_cmp_lg_u32 s3, 0
    s_cbranch_scc1 .Lpub60
    s_lshl_b32 s31, s39, 7
    s_add_u32 s31, s31, 6422528
    v_mov_b32 v10, s30
    v_mov_b32 v11, s31
    s_lshl_b32 s31, s54, 7
    s_add_u32 s31, s31, 6455296
    v_writelane_b32 v11, s31, 1
    s_mov_b64 exec, 3
    buffer_store_dword v10, v11, s[12:15], 0 offen sc1
    s_mov_b64 exec, -1
.Lpub60:
    v_mfma_f32_32x32x16_bf16 v[64:79], v[108:111], a[100:103], v[64:79]
    s_add_u32 m0, s45, 114688
    s_add_u32 s33, s43, 745472
    buffer_load_dwordx4 v14, s[16:19], s33 offen lds
    v_mfma_f32_32x32x16_bf16 v[64:79], v[112:115], a[104:107], v[64:79]
    ds_read_b64_tr_b16 v[104:105], v62 offset:3072
    ds_read_b64_tr_b16 v[106:107], v62 offset:3840
    ds_read_b64_tr_b16 v[108:109], v62 offset:4608
    ds_read_b64_tr_b16 v[110:111], v62 offset:5376
    v_mfma_f32_32x32x16_bf16 v[64:79], v[116:119], a[108:111], v[64:79]
    s_add_u32 m0, s45, 118784
    s_add_u32 s33, s43, 57344
    buffer_load_dwordx4 v14, s[16:19], s33 offen lds
    v_mfma_f32_32x32x16_bf16 v[64:79], v[128:131], v[136:139], v[64:79]
    s_add_u32 m0, s45, 122880
    s_add_u32 s33, s43, 71680
    buffer_load_dwordx4 v14, s[16:19], s33 offen lds
    s_nop 8
    s_nop 0
    v_pk_mul_f32 v[140:141], v[64:65], v[64:65]
    v_pk_mul_f32 v[142:143], v[66:67], v[66:67]
    v_pk_mul_f32 v[144:145], v[68:69], v[68:69]
    v_pk_mul_f32 v[146:147], v[70:71], v[70:71]
    v_pk_mul_f32 v[148:149], v[72:73], v[72:73]
    v_pk_mul_f32 v[150:151], v[74:75], v[74:75]
    v_pk_mul_f32 v[152:153], v[76:77], v[76:77]
    v_pk_mul_f32 v[154:155], v[78:79], v[78:79]
    v_pk_fma_f32 v[140:141], v[140:141], v[198:199], v[198:199] op_sel:[0,1,0] op_sel_hi:[1,1,0]
    v_pk_fma_f32 v[142:143], v[142:143], v[198:199], v[198:199] op_sel:[0,1,0] op_sel_hi:[1,1,0]
    v_pk_fma_f32 v[144:145], v[144:145], v[198:199], v[198:199] op_sel:[0,1,0] op_sel_hi:[1,1,0]
    v_pk_fma_f32 v[146:147], v[146:147], v[198:199], v[198:199] op_sel:[0,1,0] op_sel_hi:[1,1,0]
    v_pk_fma_f32 v[148:149], v[148:149], v[198:199], v[198:199] op_sel:[0,1,0] op_sel_hi:[1,1,0]
    v_pk_fma_f32 v[150:151], v[150:151], v[198:199], v[198:199] op_sel:[0,1,0] op_sel_hi:[1,1,0]
    s_add_u32 m0, s45, 126976
    s_add_u32 s33, s43, 157696
    buffer_load_dwordx4 v14, s[16:19], s33 offen lds
    v_pk_fma_f32 v[152:153], v[152:153], v[198:199], v[198:199] op_sel:[0,1,0] op_sel_hi:[1,1,0]
    v_pk_fma_f32 v[154:155], v[154:155], v[198:199], v[198:199] op_sel:[0,1,0] op_sel_hi:[1,1,0]
    v_pk_mul_f32 v[140:141], v[140:141], v[64:65]
    v_pk_mul_f32 v[142:143], v[142:143], v[66:67]
    v_pk_mul_f32 v[144:145], v[144:145], v[68:69]
    v_pk_mul_f32 v[146:147], v[146:147], v[70:71]
    v_pk_mul_f32 v[148:149], v[148:149], v[72:73]
    v_pk_mul_f32 v[150:151], v[150:151], v[74:75]
    v_pk_mul_f32 v[152:153], v[152:153], v[76:77]
    v_pk_mul_f32 v[154:155], v[154:155], v[78:79]
    v_exp_f32 v140, v140
    v_exp_f32 v141, v141
    v_exp_f32 v142, v142
    v_exp_f32 v143, v143
    s_add_u32 m0, s45, 131072
    s_add_u32 s33, s43, 172032
    buffer_load_dwordx4 v14, s[16:19], s33 offen lds
    v_exp_f32 v144, v144
    v_exp_f32 v145, v145
    v_exp_f32 v146, v146
    v_exp_f32 v147, v147
    v_exp_f32 v148, v148
    v_exp_f32 v149, v149
    v_exp_f32 v150, v150
    v_exp_f32 v151, v151
    v_exp_f32 v152, v152
    v_exp_f32 v153, v153
    v_exp_f32 v154, v154
    v_exp_f32 v155, v155
    v_pk_fma_f32 v[140:141], v[140:141], v[200:201], v[200:201] op_sel_hi:[1,0,0]
    v_pk_fma_f32 v[142:143], v[142:143], v[200:201], v[200:201] op_sel_hi:[1,0,0]
    v_pk_fma_f32 v[144:145], v[144:145], v[200:201], v[200:201] op_sel_hi:[1,0,0]
    v_pk_fma_f32 v[146:147], v[146:147], v[200:201], v[200:201] op_sel_hi:[1,0,0]
    v_pk_fma_f32 v[148:149], v[148:149], v[200:201], v[200:201] op_sel_hi:[1,0,0]
    v_pk_fma_f32 v[150:151], v[150:151], v[200:201], v[200:201] op_sel_hi:[1,0,0]
    v_pk_fma_f32 v[152:153], v[152:153], v[200:201], v[200:201] op_sel_hi:[1,0,0]
    v_pk_fma_f32 v[154:155], v[154:155], v[200:201], v[200:201] op_sel_hi:[1,0,0]
    v_rcp_f32 v140, v140
    v_rcp_f32 v141, v141
    v_rcp_f32 v142, v142
    v_rcp_f32 v143, v143
    v_rcp_f32 v144, v144
    v_rcp_f32 v145, v145
    v_rcp_f32 v146, v146
    v_rcp_f32 v147, v147
    v_rcp_f32 v148, v148
    v_rcp_f32 v149, v149
    v_rcp_f32 v150, v150
    v_rcp_f32 v151, v151
    v_rcp_f32 v152, v152
    v_rcp_f32 v153, v153
    v_rcp_f32 v154, v154
    v_rcp_f32 v155, v155
    v_pk_mul_f32 v[140:141], v[140:141], v[64:65]
    v_pk_mul_f32 v[142:143], v[142:143], v[66:67]
    v_pk_mul_f32 v[144:145], v[144:145], v[68:69]
    v_pk_mul_f32 v[146:147], v[146:147], v[70:71]
    v_pk_mul_f32 v[148:149], v[148:149], v[72:73]
    v_pk_mul_f32 v[150:151], v[150:151], v[74:75]
    v_pk_mul_f32 v[152:153], v[152:153], v[76:77]
    v_pk_mul_f32 v[154:155], v[154:155], v[78:79]
    v_cvt_pk_bf16_f32 v156, v140, v141
    v_cvt_pk_bf16_f32 v157, v142, v143
    v_cvt_pk_bf16_f32 v158, v144, v145
    v_cvt_pk_bf16_f32 v159, v146, v147
    v_cvt_pk_bf16_f32 v160, v148, v149
    v_cvt_pk_bf16_f32 v161, v150, v151
    v_cvt_pk_bf16_f32 v162, v152, v153
    v_cvt_pk_bf16_f32 v163, v154, v155
    buffer_store_dwordx4 v[156:159], v3, s[12:15], s52 offen offset:0 sc1
    buffer_store_dwordx4 v[160:163], v3, s[12:15], s52 offen offset:1024 sc1
    s_waitcnt lgkmcnt(4)
    s_nop 0
    v_mfma_f32_32x32x16_bf16 v[80:95], v[96:99], a[0:3], 0
    ds_read_b64_tr_b16 v[112:113], v62 offset:6144
    ds_read_b64_tr_b16 v[114:115], v62 offset:6912
    ds_read_b64_tr_b16 v[116:117], v62 offset:7680
    ds_read_b64_tr_b16 v[118:119], v62 offset:8448
    v_mfma_f32_32x32x16_bf16 v[80:95], v[100:103], a[4:7], v[80:95]
    s_waitcnt lgkmcnt(4)
    s_nop 0
    v_mfma_f32_32x32x16_bf16 v[80:95], v[104:107], a[8:11], v[80:95]
    ds_read_b64_tr_b16 v[96:97], v62 offset:9216
    ds_read_b64_tr_b16 v[98:99], v62 offset:9984
    ds_read_b64_tr_b16 v[100:101], v62 offset:10752
    ds_read_b64_tr_b16 v[102:103], v62 offset:11520
    v_mfma_f32_32x32x16_bf16 v[80:95], v[108:111], a[12:15], v[80:95]
    ds_read_b64_tr_b16 a[0:1], v188 offset:4096
    ds_read_b64_tr_b16 a[2:3], v188 offset:5120
    ds_read_b64_tr_b16 a[4:5], v189 offset:4096
    ds_read_b64_tr_b16 a[6:7], v189 offset:5120
    s_waitcnt lgkmcnt(8)
    s_nop 0
    v_mfma_f32_32x32x16_bf16 v[80:95], v[112:115], a[16:19], v[80:95]
    ds_read_b64_tr_b16 v[104:105], v62 offset:12288
    ds_read_b64_tr_b16 v[106:107], v62 offset:13056
    ds_read_b64_tr_b16 v[108:109], v62 offset:13824
    ds_read_b64_tr_b16 v[110:111], v62 offset:14592
    v_mfma_f32_32x32x16_bf16 v[80:95], v[116:119], a[20:23], v[80:95]
    ds_read_b64_tr_b16 a[8:9], v188 offset:8192
    ds_read_b64_tr_b16 a[10:11], v188 offset:9216
    ds_read_b64_tr_b16 a[12:13], v189 offset:8192
    ds_read_b64_tr_b16 a[14:15], v189 offset:9216
    s_waitcnt lgkmcnt(12)
    v_mfma_f32_32x32x16_bf16 v[80:95], v[96:99], a[24:27], v[80:95]
    ds_read_b64_tr_b16 v[112:113], v62 offset:15360
    ds_read_b64_tr_b16 v[114:115], v62 offset:16128
    ds_read_b64_tr_b16 v[116:117], v62 offset:16896
    ds_read_b64_tr_b16 v[118:119], v62 offset:17664
    s_waitcnt vmcnt(4)
    v_mov_b32_e64 v217, 7
    ds_write_b32 v207, v217
    v_mfma_f32_32x32x16_bf16 v[80:95], v[100:103], a[28:31], v[80:95]
    ds_read_b64_tr_b16 a[16:17], v188 offset:12288
    ds_read_b64_tr_b16 a[18:19], v188 offset:13312
    ds_read_b64_tr_b16 a[20:21], v189 offset:12288
    ds_read_b64_tr_b16 a[22:23], v189 offset:13312
    s_waitcnt lgkmcnt(13)
    v_mfma_f32_32x32x16_bf16 v[80:95], v[104:107], a[32:35], v[80:95]
    ds_read_b64_tr_b16 v[96:97], v62 offset:18432
    ds_read_b64_tr_b16 v[98:99], v62 offset:19200
    ds_read_b64_tr_b16 v[100:101], v62 offset:19968
    ds_read_b64_tr_b16 v[102:103], v62 offset:20736
    s_lshr_b32 s32, s40, 1
    s_lshl_b32 s32, s32, 4
    s_lshl_b32 s33, s91, 4
    s_add_u32 s33, s33, 384
    s_cmp_lt_u32 s50, 16
    s_cselect_b32 s33, s33, s32
    s_sub_u32 s33, s33, 16
    v_mov_b32 v8, s32
    v_mov_b32 v9, s33
    v_cmp_gt_u32 vcc, 16, v1
    s_nop 1
    v_cndmask_b32 v8, v9, v8, vcc
    v_add_u32 v8, v8, v1
    v_lshlrev_b32 v8, 7, v8
    v_add_u32 v8, 6422528, v8
    v_cmp_gt_u32_e64 vcc, 32, v0
    v_mov_b32 v18, 0x7fff0000
    s_nop 0
    v_cndmask_b32 v18, v18, v8, vcc
    buffer_load_dword v19, v18, s[12:15], 0 offen sc1
    v_mfma_f32_32x32x16_bf16 v[80:95], v[108:111], a[36:39], v[80:95]
    ds_read_b64_tr_b16 a[24:25], v188 offset:16384
    ds_read_b64_tr_b16 a[26:27], v188 offset:17408
    ds_read_b64_tr_b16 a[28:29], v189 offset:16384
    ds_read_b64_tr_b16 a[30:31], v189 offset:17408
    s_waitcnt lgkmcnt(13)
    s_nop 0
    v_mfma_f32_32x32x16_bf16 v[80:95], v[112:115], a[40:43], v[80:95]
    ds_read_b64_tr_b16 v[104:105], v62 offset:21504
    ds_read_b64_tr_b16 v[106:107], v62 offset:22272
    ds_read_b64_tr_b16 v[108:109], v62 offset:23040
    ds_read_b64_tr_b16 v[110:111], v62 offset:23808
    ds_read_b128 v[220:223], v216
    v_mfma_f32_32x32x16_bf16 v[80:95], v[116:119], a[44:47], v[80:95]
    ds_read_b64_tr_b16 a[32:33], v188 offset:20480
    ds_read_b64_tr_b16 a[34:35], v188 offset:21504
    ds_read_b64_tr_b16 a[36:37], v189 offset:20480
    ds_read_b64_tr_b16 a[38:39], v189 offset:21504
    s_waitcnt lgkmcnt(13)
    v_mfma_f32_32x32x16_bf16 v[80:95], v[96:99], a[48:51], v[80:95]
    ds_read_b64_tr_b16 v[112:113], v62 offset:24576
    ds_read_b64_tr_b16 v[114:115], v62 offset:25344
    ds_read_b64_tr_b16 v[116:117], v62 offset:26112
    ds_read_b64_tr_b16 v[118:119], v62 offset:26880
    s_waitcnt lgkmcnt(8)
    v_min3_u32 v220, v220, v221, v222
    v_min_u32 v220, v220, v223
    v_cmp_gt_u32_e64 vcc, 7, v220
    s_nop 0
    s_cbranch_vccz .Lck61
    s_mov_b32 s34, 0
.Lckl62:
    ds_read_b128 v[220:223], v216
    s_add_u32 s34, s34, 1
    s_waitcnt lgkmcnt(0)
    v_min3_u32 v220, v220, v221, v222
    v_min_u32 v220, v220, v223
    v_cmp_gt_u32 vcc, 7, v220
    s_cmp_ge_u32 s34, 3000000
    s_cbranch_scc1 .Lck61
    s_cbranch_vccnz .Lckl62
.Lck61:
    v_mfma_f32_32x32x16_bf16 v[80:95], v[100:103], a[52:55], v[80:95]
    s_add_u32 m0, s45, 135168
    s_add_u32 s33, s43, 258048
    buffer_load_dwordx4 v14, s[16:19], s33 offen lds
    ds_read_b64_tr_b16 a[40:41], v188 offset:24576
    ds_read_b64_tr_b16 a[42:43], v188 offset:25600
    ds_read_b64_tr_b16 a[44:45], v189 offset:24576
    ds_read_b64_tr_b16 a[46:47], v189 offset:25600
    v_mfma_f32_32x32x16_bf16 v[80:95], v[104:107], a[56:59], v[80:95]
    ds_read_b64_tr_b16 v[96:97], v62 offset:27648
    ds_read_b64_tr_b16 v[98:99], v62 offset:28416
    ds_read_b64_tr_b16 v[100:101], v62 offset:29184
    ds_read_b64_tr_b16 v[102:103], v62 offset:29952
    s_waitcnt vmcnt(4)
    v_mov_b32 v217, 8
    ds_write_b32 v207, v217
    v_mfma_f32_32x32x16_bf16 v[80:95], v[108:111], a[60:63], v[80:95]
    s_add_u32 m0, s45, 139264
    s_add_u32 s33, s43, 272384
    buffer_load_dwordx4 v14, s[16:19], s33 offen lds
    ds_read_b64_tr_b16 a[48:49], v15 offset:0
    ds_read_b64_tr_b16 a[50:51], v15 offset:1024
    ds_read_b64_tr_b16 a[52:53], v16 offset:0
    ds_read_b64_tr_b16 a[54:55], v16 offset:1024
    s_waitcnt lgkmcnt(13)
    s_nop 0
    v_mfma_f32_32x32x16_bf16 v[80:95], v[112:115], a[64:67], v[80:95]
    ds_read_b64_tr_b16 v[104:105], v62 offset:30720
    ds_read_b64_tr_b16 v[106:107], v62 offset:31488
    ds_read_b64_tr_b16 v[108:109], v62 offset:32256
    ds_read_b64_tr_b16 v[110:111], v62 offset:33024
    v_mfma_f32_32x32x16_bf16 v[80:95], v[116:119], a[68:71], v[80:95]
    s_add_u32 m0, s45, 57344
    s_add_u32 s33, s43, 358400
    buffer_load_dwordx4 v14, s[16:19], s33 offen lds
    s_waitcnt lgkmcnt(9)
    s_nop 0
    v_mfma_f32_32x32x16_bf16 v[80:95], v[96:99], a[72:75], v[80:95]
    ds_read_b64_tr_b16 v[112:113], v62 offset:33792
    ds_read_b64_tr_b16 v[114:115], v62 offset:34560
    ds_read_b64_tr_b16 v[116:117], v62 offset:35328
    ds_read_b64_tr_b16 v[118:119], v62 offset:36096
    ds_read_b128 v[220:223], v216
    v_mfma_f32_32x32x16_bf16 v[80:95], v[100:103], a[76:79], v[80:95]
    s_add_u32 m0, s45, 61440
    s_add_u32 s33, s43, 372736
    buffer_load_dwordx4 v14, s[16:19], s33 offen lds
    s_waitcnt lgkmcnt(5)
    v_mfma_f32_32x32x16_bf16 v[80:95], v[104:107], a[80:83], v[80:95]
    ds_read_b64_tr_b16 v[96:97], v62 offset:36864
    ds_read_b64_tr_b16 v[98:99], v62 offset:37632
    ds_read_b64_tr_b16 v[100:101], v62 offset:38400
    ds_read_b64_tr_b16 v[102:103], v62 offset:39168
    s_waitcnt lgkmcnt(4)
    v_min3_u32 v220, v220, v221, v222
    v_min_u32 v220, v220, v223
    v_cmp_gt_u32_e64 vcc, 8, v220
    s_nop 0
    s_cbranch_vccz .Lck63
    s_mov_b32 s34, 0
.Lckl64:
    ds_read_b128 v[220:223], v216
    s_add_u32 s34, s34, 1
    s_waitcnt lgkmcnt(0)
    v_min3_u32 v220, v220, v221, v222
    v_min_u32 v220, v220, v223
    v_cmp_gt_u32 vcc, 8, v220
    s_cmp_ge_u32 s34, 3000000
    s_cbranch_scc1 .Lck63
    s_cbranch_vccnz .Lckl64
.Lck63:
    s_add_u32 m0, s45, 143360
    s_add_u32 s33, s43, 458752
    buffer_load_dwordx4 v14, s[16:19], s33 offen lds
    v_mfma_f32_32x32x16_bf16 v[80:95], v[108:111], a[84:87], v[80:95]
    s_add_u32 m0, s45, 147456
    s_add_u32 s33, s43, 473088
    buffer_load_dwordx4 v14, s[16:19], s33 offen lds
    v_mfma_f32_32x32x16_bf16 v[80:95], v[112:115], a[88:91], v[80:95]
    ds_read_b64_tr_b16 v[104:105], v62 offset:39936
    ds_read_b64_tr_b16 v[106:107], v62 offset:40704
    ds_read_b64_tr_b16 v[108:109], v62 offset:41472
    ds_read_b64_tr_b16 v[110:111], v62 offset:42240
    s_waitcnt vmcnt(7)
    s_cmp_lg_u32 s3, 0
    s_cbranch_scc1 .Lpoll65
    s_mov_b32 exec_lo, 0xffffffff
    s_mov_b32 exec_hi, 0
    s_waitcnt vmcnt(6)
    v_cmp_ne_u32_e64 vcc, s30, v19
    s_nop 1
    s_cbranch_vccz .Lpollx66
    s_waitcnt vmcnt(0) lgkmcnt(0)
    s_mov_b32 s34, 0
.Lspin67:
    buffer_load_dword v19, v18, s[12:15], 0 offen sc1
    s_add_u32 s34, s34, 1
    s_waitcnt vmcnt(0)
    v_cmp_ne_u32_e64 vcc, s30, v19
    s_cmp_ge_u32 s34, 200000
    s_cbranch_scc1 .Lspun68
    s_cbranch_vccnz .Lspin67
.Lspun68:
    s_nop 1
.Lpollx66:
    s_mov_b64 exec, -1
.Lpoll65:
    v_mov_b32_e64 v217, 9
    ds_write_b32 v207, v217
    s_add_u32 m0, s45, 151552
    s_add_u32 s33, s43, 559104
    buffer_load_dwordx4 v14, s[16:19], s33 offen lds
    v_mfma_f32_32x32x16_bf16 v[80:95], v[116:119], a[92:95], v[80:95]
    s_add_u32 m0, s45, 155648
    s_add_u32 s33, s43, 573440
    buffer_load_dwordx4 v14, s[16:19], s33 offen lds
    s_waitcnt lgkmcnt(5)
    s_nop 0
    v_mfma_f32_32x32x16_bf16 v[80:95], v[96:99], a[96:99], v[80:95]
    s_add_u32 m0, s45, 65536
    s_add_u32 s33, s43, 659456
    buffer_load_dwordx4 v14, s[16:19], s33 offen lds
    v_mfma_f32_32x32x16_bf16 v[80:95], v[100:103], a[100:103], v[80:95]
    s_add_u32 m0, s45, 69632
    s_add_u32 s33, s43, 673792
    buffer_load_dwordx4 v14, s[16:19], s33 offen lds
    s_waitcnt lgkmcnt(1)
    s_nop 0
    v_mfma_f32_32x32x16_bf16 v[80:95], v[104:107], a[104:107], v[80:95]
    ds_read_b128 v[220:223], v216
    s_add_u32 m0, s45, 73728
    s_add_u32 s33, s43, 759808
    buffer_load_dwordx4 v14, s[16:19], s33 offen lds
    v_mfma_f32_32x32x16_bf16 v[80:95], v[108:111], a[108:111], v[80:95]
    s_add_u32 m0, s45, 77824
    s_add_u32 s33, s43, 774144
    buffer_load_dwordx4 v14, s[16:19], s33 offen lds
    v_mfma_f32_32x32x16_bf16 v[80:95], v[132:135], v[136:139], v[80:95]
    s_waitcnt lgkmcnt(0)
    v_min3_u32 v220, v220, v221, v222
    v_min_u32 v220, v220, v223
    v_cmp_gt_u32 vcc, 9, v220
    s_nop 0
    s_cbranch_vccz .Lck69
    s_mov_b32 s34, 0
.Lckl70:
    ds_read_b128 v[220:223], v216
    s_add_u32 s34, s34, 1
    s_waitcnt lgkmcnt(0)
    v_min3_u32 v220, v220, v221, v222
    v_min_u32 v220, v220, v223
    v_cmp_gt_u32 vcc, 9, v220
    s_cmp_ge_u32 s34, 3000000
    s_cbranch_scc1 .Lck69
    s_cbranch_vccnz .Lckl70
.Lck69:
    s_cmp_lg_u32 s3, 0
    s_cbranch_scc1 .Lpub71
    s_lshl_b32 s31, s39, 7
    s_add_u32 s31, s31, 6488064
    v_mov_b32 v10, s30
    v_mov_b32 v11, s31
    s_mov_b64 exec, 1
    buffer_store_dword v10, v11, s[12:15], 0 offen sc1
    s_mov_b64 exec, -1
    s_nop 0
.Lpub71:
    buffer_load_dwordx4 a[112:115], v3, s[12:15], s88 offen offset:0 sc1
    buffer_load_dwordx4 a[116:119], v3, s[12:15], s88 offen offset:1024 sc1
    buffer_load_dwordx4 a[120:123], v3, s[12:15], s88 offen offset:2048 sc1
    buffer_load_dwordx4 a[124:127], v3, s[12:15], s88 offen offset:3072 sc1
    v_pk_mul_f32 v[140:141], v[80:81], v[80:81]
    v_pk_mul_f32 v[142:143], v[82:83], v[82:83]
    v_pk_mul_f32 v[144:145], v[84:85], v[84:85]
    v_pk_mul_f32 v[146:147], v[86:87], v[86:87]
    v_pk_fma_f32 v[140:141], v[140:141], v[198:199], v[198:199] op_sel:[0,1,0] op_sel_hi:[1,1,0]
    v_pk_fma_f32 v[142:143], v[142:143], v[198:199], v[198:199] op_sel:[0,1,0] op_sel_hi:[1,1,0]
    v_pk_fma_f32 v[144:145], v[144:145], v[198:199], v[198:199] op_sel:[0,1,0] op_sel_hi:[1,1,0]
    v_pk_fma_f32 v[146:147], v[146:147], v[198:199], v[198:199] op_sel:[0,1,0] op_sel_hi:[1,1,0]
    v_pk_mul_f32 v[140:141], v[140:141], v[80:81]
    v_pk_mul_f32 v[142:143], v[142:143], v[82:83]
    v_pk_mul_f32 v[144:145], v[144:145], v[84:85]
    v_pk_mul_f32 v[146:147], v[146:147], v[86:87]
    v_exp_f32 v140, v140
    v_exp_f32 v141, v141
    s_waitcnt vmcnt(15)
    v_mov_b32 v217, 10
    ds_write_b32 v207, v217
    s_add_u32 s37, s42, 0
    buffer_load_dwordx4 a[56:59], v3, s[12:15], s37 offen offset:0 sc1
    buffer_load_dwordx4 a[60:63], v3, s[12:15], s37 offen offset:1024 sc1
    v_exp_f32 v142, v142
    v_exp_f32 v143, v143
    v_exp_f32 v144, v144
    v_exp_f32 v145, v145
    v_exp_f32 v146, v146
    v_exp_f32_e64 v147, v147
    v_pk_fma_f32 v[140:141], v[140:141], v[200:201], v[200:201] op_sel_hi:[1,0,0]
    v_pk_fma_f32 v[142:143], v[142:143], v[200:201], v[200:201] op_sel_hi:[1,0,0]
    v_pk_fma_f32 v[144:145], v[144:145], v[200:201], v[200:201] op_sel_hi:[1,0,0]
    v_pk_fma_f32 v[146:147], v[146:147], v[200:201], v[200:201] op_sel_hi:[1,0,0]
    v_rcp_f32 v140, v140
    v_rcp_f32 v141, v141
    v_rcp_f32 v142, v142
    v_rcp_f32 v143, v143
    buffer_load_dwordx4 a[64:67], v3, s[12:15], s37 offen offset:2048 sc1
    buffer_load_dwordx4 a[68:71], v3, s[12:15], s37 offen offset:3072 sc1
    v_rcp_f32 v144, v144
    v_rcp_f32 v145, v145
    v_rcp_f32 v146, v146
    v_rcp_f32 v147, v147
    v_pk_mul_f32 v[140:141], v[140:141], v[80:81]
    v_pk_mul_f32 v[142:143], v[142:143], v[82:83]
    v_pk_mul_f32 v[144:145], v[144:145], v[84:85]
    v_pk_mul_f32 v[146:147], v[146:147], v[86:87]
    v_cvt_pk_bf16_f32 v164, v140, v141
    v_cvt_pk_bf16_f32 v165, v142, v143
    v_cvt_pk_bf16_f32 v166, v144, v145
    v_cvt_pk_bf16_f32 v167, v146, v147
    buffer_store_dwordx4 v[164:167], v3, s[12:15], s52 offen offset:2048 sc1
    ds_read_b128 v[220:223], v216
    s_add_u32 s37, s42, 7168
    buffer_load_dwordx4 a[72:75], v3, s[12:15], s37 offen offset:0 sc1
    buffer_load_dwordx4 a[76:79], v3, s[12:15], s37 offen offset:1024 sc1
    s_waitcnt lgkmcnt(0)
    v_min3_u32 v220, v220, v221, v222
    v_min_u32 v220, v220, v223
    v_cmp_gt_u32 vcc, 10, v220
    s_nop 0
    s_cbranch_vccz .Lck74
    s_mov_b32 s34, 0
.Lckl75:
    ds_read_b128 v[220:223], v216
    s_add_u32 s34, s34, 1
    s_waitcnt lgkmcnt(0)
    v_min3_u32 v220, v220, v221, v222
    v_min_u32 v220, v220, v223
    v_cmp_gt_u32 vcc, 10, v220
    s_cmp_ge_u32 s34, 3000000
    s_cbranch_scc1 .Lck74
    s_cbranch_vccnz .Lckl75
.Lck74:
    buffer_load_dwordx4 a[80:83], v3, s[12:15], s37 offen offset:2048 sc1
    buffer_load_dwordx4 a[84:87], v3, s[12:15], s37 offen offset:3072 sc1
    s_add_u32 s37, s42, 14336
    buffer_load_dwordx4 a[88:91], v3, s[12:15], s37 offen offset:0 sc1
    buffer_load_dwordx4 a[92:95], v3, s[12:15], s37 offen offset:1024 sc1
    buffer_load_dwordx4 a[96:99], v3, s[12:15], s37 offen offset:2048 sc1
    buffer_load_dwordx4 a[100:103], v3, s[12:15], s37 offen offset:3072 sc1
    s_cmp_ge_u32 s29, 28
    s_cbranch_scc1 .Lidle73
    s_cmp_ge_u32 s50, 16
    s_cbranch_scc1 .Lnoo76
    s_waitcnt vmcnt(16)
    v_mfma_f32_32x32x16_bf16 v[64:79], a[112:115], v[20:23], 0
    s_waitcnt vmcnt(15)
    v_mfma_f32_32x32x16_bf16 v[64:79], a[116:119], v[24:27], v[64:79]
    s_waitcnt vmcnt(14)
    v_mfma_f32_32x32x16_bf16 v[64:79], a[120:123], v[28:31], v[64:79]
    s_waitcnt vmcnt(13)
    v_mfma_f32_32x32x16_bf16 v[64:79], a[124:127], v[32:35], v[64:79]
    v_mfma_f32_32x32x16_bf16 v[80:95], a[112:115], v[36:39], 0
    v_mfma_f32_32x32x16_bf16 v[80:95], a[116:119], v[40:43], v[80:95]
    v_mfma_f32_32x32x16_bf16 v[80:95], a[120:123], v[44:47], v[80:95]
    v_mfma_f32_32x32x16_bf16 v[80:95], a[124:127], v[48:51], v[80:95]
    s_nop 7
    v_mov_b32 v226, v76
    v_mov_b32_e64 v227, v76
    s_nop 1
    v_permlane32_swap_b32 v227, v226
    v_add_f32 v226, 0x358637bd, v226
    v_rcp_f32 v226, v226
    s_nop 0
    v_pk_mul_f32 v[64:65], v[64:65], v[226:227] op_sel_hi:[1,0]
    v_pk_mul_f32 v[66:67], v[66:67], v[226:227] op_sel_hi:[1,0]
    v_pk_mul_f32 v[68:69], v[68:69], v[226:227] op_sel_hi:[1,0]
    v_pk_mul_f32 v[70:71], v[70:71], v[226:227] op_sel_hi:[1,0]
    v_pk_mul_f32 v[72:73], v[72:73], v[226:227] op_sel_hi:[1,0]
    v_pk_mul_f32 v[74:75], v[74:75], v[226:227] op_sel_hi:[1,0]
    v_pk_mul_f32 v[76:77], v[76:77], v[226:227] op_sel_hi:[1,0]
    v_pk_mul_f32 v[78:79], v[78:79], v[226:227] op_sel_hi:[1,0]
    v_cvt_pk_bf16_f32 v20, v64, v65
    v_cvt_pk_bf16_f32 v21, v66, v67
    v_cvt_pk_bf16_f32 v22, v68, v69
    v_cvt_pk_bf16_f32 v23, v70, v71
    v_cvt_pk_bf16_f32 v24, v72, v73
    v_cvt_pk_bf16_f32 v25, v74, v75
    v_cvt_pk_bf16_f32 v26, v76, v77
    v_cvt_pk_bf16_f32 v27, v78, v79
    v_cndmask_b32 v26, 0, v26, s[56:57]
    v_cndmask_b32 v27, 0, v27, s[56:57]
    buffer_store_dwordx4 v[20:23], v3, s[12:15], s89 offen offset:0 sc1
    buffer_store_dwordx4 v[24:27], v3, s[12:15], s89 offen offset:1024 sc1
    v_mov_b32 v226, v92
    v_mov_b32 v227, v92
    s_nop 1
    v_permlane32_swap_b32 v227, v226
    v_add_f32 v226, 0x358637bd, v226
    v_rcp_f32 v226, v226
    s_nop 0
    v_pk_mul_f32 v[80:81], v[80:81], v[226:227] op_sel_hi:[1,0]
    v_pk_mul_f32 v[82:83], v[82:83], v[226:227] op_sel_hi:[1,0]
    v_pk_mul_f32 v[84:85], v[84:85], v[226:227] op_sel_hi:[1,0]
    v_pk_mul_f32 v[86:87], v[86:87], v[226:227] op_sel_hi:[1,0]
    v_pk_mul_f32 v[88:89], v[88:89], v[226:227] op_sel_hi:[1,0]
    v_pk_mul_f32 v[90:91], v[90:91], v[226:227] op_sel_hi:[1,0]
    v_pk_mul_f32 v[92:93], v[92:93], v[226:227] op_sel_hi:[1,0]
    v_pk_mul_f32 v[94:95], v[94:95], v[226:227] op_sel_hi:[1,0]
    v_cvt_pk_bf16_f32 v28, v80, v81
    v_cvt_pk_bf16_f32 v29, v82, v83
    v_cvt_pk_bf16_f32 v30, v84, v85
    v_cvt_pk_bf16_f32 v31, v86, v87
    v_cvt_pk_bf16_f32 v32, v88, v89
    v_cvt_pk_bf16_f32 v33, v90, v91
    v_cvt_pk_bf16_f32 v34, v92, v93
    v_cvt_pk_bf16_f32 v35, v94, v95
    v_cndmask_b32 v34, 0, v34, s[56:57]
    v_cndmask_b32 v35, 0, v35, s[56:57]
    s_add_u32 s89, s89, 32768
    buffer_store_dwordx4 v[28:31], v3, s[12:15], s89 offen offset:0 sc1
    buffer_store_dwordx4 v[32:35], v3, s[12:15], s89 offen offset:1024 sc1
    s_nop 1
.Lnoo76:
    s_waitcnt vmcnt(12)
    v_mfma_f32_32x32x16_bf16 v[64:79], v[172:175], a[56:59], 0
    s_add_u32 m0, s45, 0
    s_add_u32 s33, s43, 86016
    buffer_load_dwordx4 v14, s[16:19], s33 offen lds
    v_mfma_f32_32x32x16_bf16 v[80:95], v[176:179], a[56:59], 0
    s_add_u32 s37, s42, 21504
    buffer_load_dwordx4 a[104:107], v3, s[12:15], s37 offen offset:0 sc1
    s_waitcnt vmcnt(13)
    v_mfma_f32_32x32x16_bf16 v[64:79], v[180:183], a[60:63], v[64:79]
    v_mfma_f32_32x32x16_bf16 v[80:95], v[184:187], a[60:63], v[80:95]
    buffer_load_dwordx4 a[108:111], v3, s[12:15], s37 offen offset:1024 sc1
    s_waitcnt vmcnt(13)
    s_nop 0
    v_mfma_f32_32x32x16_bf16 v[64:79], v[52:55], a[64:67], v[64:79]
    s_add_u32 m0, s45, 81920
    s_add_u32 s33, s43, 186368
    buffer_load_dwordx4 v14, s[16:19], s33 offen lds
    v_mfma_f32_32x32x16_bf16 v[80:95], v[56:59], a[64:67], v[80:95]
    buffer_load_dwordx4 a[56:59], v3, s[12:15], s37 offen offset:2048 sc1
    s_waitcnt vmcnt(14)
    v_mfma_f32_32x32x16_bf16 v[64:79], v[120:123], a[68:71], v[64:79]
    v_mfma_f32_32x32x16_bf16 v[80:95], v[124:127], a[68:71], v[80:95]
    buffer_load_dwordx4 a[60:63], v3, s[12:15], s37 offen offset:3072 sc1
    s_waitcnt vmcnt(13)
    v_mfma_f32_32x32x16_bf16 v[64:79], v[208:211], a[72:75], v[64:79]
    s_add_u32 m0, s45, 86016
    s_add_u32 s33, s43, 286720
    buffer_load_dwordx4 v14, s[16:19], s33 offen lds
    v_mfma_f32_32x32x16_bf16 v[80:95], v[212:215], a[72:75], v[80:95]
    s_add_u32 s37, s42, 28672
    buffer_load_dwordx4 a[64:67], v3, s[12:15], s37 offen offset:0 sc1
    s_waitcnt vmcnt(14)
    v_mfma_f32_32x32x16_bf16 v[64:79], v[228:231], a[76:79], v[64:79]
    v_mfma_f32_32x32x16_bf16 v[80:95], v[232:235], a[76:79], v[80:95]
    buffer_load_dwordx4 a[68:71], v3, s[12:15], s37 offen offset:1024 sc1
    s_waitcnt vmcnt(14)
    v_mfma_f32_32x32x16_bf16 v[64:79], v[236:239], a[80:83], v[64:79]
    s_add_u32 m0, s45, 90112
    s_add_u32 s33, s43, 387072
    buffer_load_dwordx4 v14, s[16:19], s33 offen lds
    v_mfma_f32_32x32x16_bf16 v[80:95], v[240:243], a[80:83], v[80:95]
    buffer_load_dwordx4 a[72:75], v3, s[12:15], s37 offen offset:2048 sc1
    s_waitcnt vmcnt(15)
    v_mfma_f32_32x32x16_bf16 v[64:79], v[244:247], a[84:87], v[64:79]
    v_mfma_f32_32x32x16_bf16 v[80:95], v[248:251], a[84:87], v[80:95]
    buffer_load_dwordx4 a[76:79], v3, s[12:15], s37 offen offset:3072 sc1
    s_waitcnt vmcnt(15)
    v_mfma_f32_32x32x16_bf16 v[64:79], a[0:3], a[88:91], v[64:79]
    s_lshr_b32 s32, s40, 1
    s_lshl_b32 s32, s32, 4
    v_add_u32 v8, s32, v1
    v_lshlrev_b32 v8, 7, v8
    v_add_u32 v8, 6488064, v8
    v_cmp_gt_u32_e64 vcc, 16, v0
    v_mov_b32 v18, 0x7fff0000
    s_nop 0
    v_cndmask_b32 v18, v18, v8, vcc
    buffer_load_dword v19, v18, s[12:15], 0 offen sc1
    s_add_u32 m0, s45, 94208
    s_add_u32 s33, s43, 487424
    buffer_load_dwordx4 v14, s[16:19], s33 offen lds
    v_mfma_f32_32x32x16_bf16 v[80:95], a[4:7], a[88:91], v[80:95]
    s_add_u32 s37, s42, 35840
    buffer_load_dwordx4 a[80:83], v3, s[12:15], s37 offen offset:0 sc1
    s_waitcnt vmcnt(17)
    v_mfma_f32_32x32x16_bf16 v[64:79], a[8:11], a[92:95], v[64:79]
    s_waitcnt vmcnt(14)
    s_waitcnt vmcnt(13)
    v_mov_b32 v217, 11
    ds_write_b32 v207, v217
    v_mfma_f32_32x32x16_bf16 v[80:95], a[12:15], a[92:95], v[80:95]
    buffer_load_dwordx4 a[84:87], v3, s[12:15], s37 offen offset:1024 sc1
    v_mfma_f32_32x32x16_bf16 v[64:79], a[16:19], a[96:99], v[64:79]
    s_add_u32 m0, s45, 98304
    s_add_u32 s33, s43, 587776
    buffer_load_dwordx4 v14, s[16:19], s33 offen lds
    v_mfma_f32_32x32x16_bf16 v[80:95], a[20:23], a[96:99], v[80:95]
    buffer_load_dwordx4 a[88:91], v3, s[12:15], s37 offen offset:2048 sc1
    v_mfma_f32_32x32x16_bf16 v[64:79], a[24:27], a[100:103], v[64:79]
    ds_read_b128 v[220:223], v216
    v_mfma_f32_32x32x16_bf16 v[80:95], a[28:31], a[100:103], v[80:95]
    buffer_load_dwordx4 a[92:95], v3, s[12:15], s37 offen offset:3072 sc1
    v_mfma_f32_32x32x16_bf16 v[64:79], a[32:35], a[104:107], v[64:79]
    s_waitcnt lgkmcnt(0)
    v_min3_u32 v220, v220, v221, v222
    v_min_u32 v220, v220, v223
    v_cmp_gt_u32 vcc, 11, v220
    s_nop 0
    s_cbranch_vccz .Lck77
    s_mov_b32 s34, 0
.Lckl78:
    ds_read_b128 v[220:223], v216
    s_add_u32 s34, s34, 1
    s_waitcnt lgkmcnt(0)
    v_min3_u32 v220, v220, v221, v222
    v_min_u32 v220, v220, v223
    v_cmp_gt_u32 vcc, 11, v220
    s_cmp_ge_u32 s34, 3000000
    s_cbranch_scc1 .Lck77
    s_cbranch_vccnz .Lckl78
.Lck77:
    s_cmp_lg_u32 s3, 0
    s_cbranch_scc1 .Lpub79
    s_lshl_b32 s31, s39, 7
    s_add_u32 s31, s31, 6520832
    v_mov_b32 v10, s30
    v_mov_b32 v11, s31
    s_lshl_b32 s31, s53, 7
    s_add_u32 s31, s31, 6455296
    v_writelane_b32 v11, s31, 1
    s_mov_b64 exec, 3
    buffer_store_dword v10, v11, s[12:15], 0 offen sc1
    s_mov_b64 exec, -1
.Lpub79:
    v_mfma_f32_32x32x16_bf16 v[80:95], a[36:39], a[104:107], v[80:95]
    s_add_u32 s37, s42, 43008
    buffer_load_dwordx4 a[96:99], v3, s[12:15], s37 offen offset:0 sc1
    s_waitcnt vmcnt(17)
    s_nop 0
    v_mfma_f32_32x32x16_bf16 v[64:79], a[40:43], a[108:111], v[64:79]
    ds_read_b64_tr_b16 v[96:97], v15 offset:4096
    ds_read_b64_tr_b16 v[98:99], v15 offset:5120
    ds_read_b64_tr_b16 v[100:101], v16 offset:4096
    ds_read_b64_tr_b16 v[102:103], v16 offset:5120
    v_mfma_f32_32x32x16_bf16 v[80:95], a[44:47], a[108:111], v[80:95]
    buffer_load_dwordx4 a[100:103], v3, s[12:15], s37 offen offset:1024 sc1
    s_waitcnt vmcnt(16)
    s_nop 0
    v_mfma_f32_32x32x16_bf16 v[64:79], a[48:51], a[56:59], v[64:79]
    ds_read_b64_tr_b16 v[104:105], v15 offset:8192
    ds_read_b64_tr_b16 v[106:107], v15 offset:9216
    ds_read_b64_tr_b16 v[108:109], v16 offset:8192
    ds_read_b64_tr_b16 v[110:111], v16 offset:9216
    v_mfma_f32_32x32x16_bf16 v[80:95], a[52:55], a[56:59], v[80:95]
    buffer_load_dwordx4 a[104:107], v3, s[12:15], s37 offen offset:2048 sc1
    s_waitcnt vmcnt(16) lgkmcnt(4)
    s_nop 0
    v_mfma_f32_32x32x16_bf16 v[64:79], v[96:99], a[60:63], v[64:79]
    ds_read_b64_tr_b16 v[112:113], v15 offset:12288
    ds_read_b64_tr_b16 v[114:115], v15 offset:13312
    ds_read_b64_tr_b16 v[116:117], v16 offset:12288
    ds_read_b64_tr_b16 v[118:119], v16 offset:13312
    v_mfma_f32_32x32x16_bf16 v[80:95], v[100:103], a[60:63], v[80:95]
    buffer_load_dwordx4 a[108:111], v3, s[12:15], s37 offen offset:3072 sc1
    s_waitcnt vmcnt(15) lgkmcnt(4)
    s_nop 0
    v_mfma_f32_32x32x16_bf16 v[64:79], v[104:107], a[64:67], v[64:79]
    ds_read_b64_tr_b16 v[96:97], v15 offset:16384
    ds_read_b64_tr_b16 v[98:99], v15 offset:17408
    ds_read_b64_tr_b16 v[100:101], v16 offset:16384
    ds_read_b64_tr_b16 v[102:103], v16 offset:17408
    v_mfma_f32_32x32x16_bf16 v[80:95], v[108:111], a[64:67], v[80:95]
    s_add_u32 s37, s42, 50176
    buffer_load_dwordx4 a[56:59], v3, s[12:15], s37 offen offset:0 sc1
    s_waitcnt vmcnt(15) lgkmcnt(4)
    v_mfma_f32_32x32x16_bf16 v[64:79], v[112:115], a[68:71], v[64:79]
    s_waitcnt vmcnt(10)
    s_cmp_lg_u32 s3, 0
    s_cbranch_scc1 .Lpoll80
    s_mov_b32 exec_lo, 0xffff
    s_mov_b32 exec_hi, 0
    v_cmp_ne_u32 vcc, s30, v19
    s_nop 1
    s_cbranch_vccz .Lpollx81
    s_waitcnt vmcnt(0) lgkmcnt(0)
    s_mov_b32 s34, 0
.Lspin82:
    buffer_load_dword v19, v18, s[12:15], 0 offen sc1
    s_add_u32 s34, s34, 1
    s_waitcnt vmcnt(0)
    v_cmp_ne_u32_e64 vcc, s30, v19
    s_cmp_ge_u32 s34, 200000
    s_cbranch_scc1 .Lspun83
    s_cbranch_vccnz .Lspin82
.Lspun83:
    s_nop 1
.Lpollx81:
    s_mov_b64 exec, -1
.Lpoll80:
    v_mov_b32_e64 v217, 12
    ds_write_b32 v207, v217
    ds_read_b64_tr_b16 v[104:105], v15 offset:20480
    ds_read_b64_tr_b16 v[106:107], v15 offset:21504
    ds_read_b64_tr_b16 v[108:109], v16 offset:20480
    ds_read_b64_tr_b16 v[110:111], v16 offset:21504
    v_mfma_f32_32x32x16_bf16 v[80:95], v[116:119], a[68:71], v[80:95]
    buffer_load_dwordx4 a[60:63], v3, s[12:15], s37 offen offset:1024 sc1
    s_waitcnt lgkmcnt(5)
    s_nop 0
    v_mfma_f32_32x32x16_bf16 v[64:79], v[96:99], a[72:75], v[64:79]
    ds_read_b64_tr_b16 v[112:113], v15 offset:24576
    ds_read_b64_tr_b16 v[114:115], v15 offset:25600
    ds_read_b64_tr_b16 v[116:117], v16 offset:24576
    ds_read_b64_tr_b16 v[118:119], v16 offset:25600
    v_mfma_f32_32x32x16_bf16 v[80:95], v[100:103], a[72:75], v[80:95]
    buffer_load_dwordx4 a[64:67], v3, s[12:15], s37 offen offset:2048 sc1
    s_waitcnt lgkmcnt(4)
    s_nop 0
    v_mfma_f32_32x32x16_bf16 v[64:79], v[104:107], a[76:79], v[64:79]
    ds_read_b128 v[220:223], v216
    ds_read_b64_tr_b16 v[96:97], v15 offset:28672
    ds_read_b64_tr_b16 v[98:99], v15 offset:29696
    ds_read_b64_tr_b16 v[100:101], v16 offset:28672
    ds_read_b64_tr_b16 v[102:103], v16 offset:29696
    v_mfma_f32_32x32x16_bf16 v[80:95], v[108:111], a[76:79], v[80:95]
    buffer_load_dwordx4 a[68:71], v3, s[12:15], s37 offen offset:3072 sc1
    s_waitcnt vmcnt(12) lgkmcnt(5)
    v_mfma_f32_32x32x16_bf16 v[64:79], v[112:115], a[80:83], v[64:79]
    s_waitcnt lgkmcnt(4)
    v_min3_u32 v220, v220, v221, v222
    v_min_u32 v220, v220, v223
    v_cmp_gt_u32_e64 vcc, 12, v220
    s_nop 0
    s_cbranch_vccz .Lck84
    s_mov_b32 s34, 0
.Lckl85:
    ds_read_b128 v[220:223], v216
    s_add_u32 s34, s34, 1
    s_waitcnt lgkmcnt(0)
    v_min3_u32 v220, v220, v221, v222
    v_min_u32 v220, v220, v223
    v_cmp_gt_u32 vcc, 12, v220
    s_cmp_ge_u32 s34, 3000000
    s_cbranch_scc1 .Lck84
    s_cbranch_vccnz .Lckl85
.Lck84:
    ds_read_b64_tr_b16 v[104:105], v15 offset:32768
    ds_read_b64_tr_b16 v[106:107], v15 offset:33792
    ds_read_b64_tr_b16 v[108:109], v16 offset:32768
    ds_read_b64_tr_b16 v[110:111], v16 offset:33792
    s_add_u32 m0, s45, 4096
    s_add_u32 s33, s43, 688128
    buffer_load_dwordx4 v14, s[16:19], s33 offen lds
    v_mfma_f32_32x32x16_bf16 v[80:95], v[116:119], a[80:83], v[80:95]
    s_add_u32 s37, s42, 4096
    buffer_load_dwordx4 a[72:75], v3, s[12:15], s37 offen offset:0 sc1
    s_waitcnt vmcnt(13) lgkmcnt(4)
    s_nop 0
    v_mfma_f32_32x32x16_bf16 v[64:79], v[96:99], a[84:87], v[64:79]
    ds_read_b64_tr_b16 v[112:113], v15 offset:36864
    ds_read_b64_tr_b16 v[114:115], v15 offset:37888
    ds_read_b64_tr_b16 v[116:117], v16 offset:36864
    ds_read_b64_tr_b16 v[118:119], v16 offset:37888
    v_mfma_f32_32x32x16_bf16 v[80:95], v[100:103], a[84:87], v[80:95]
    buffer_load_dwordx4 a[76:79], v3, s[12:15], s37 offen offset:1024 sc1
    s_waitcnt vmcnt(12) lgkmcnt(4)
    s_nop 0
    v_mfma_f32_32x32x16_bf16 v[64:79], v[104:107], a[88:91], v[64:79]
    ds_read_b64_tr_b16 v[96:97], v15 offset:40960
    ds_read_b64_tr_b16 v[98:99], v15 offset:41984
    ds_read_b64_tr_b16 v[100:101], v16 offset:40960
    ds_read_b64_tr_b16 v[102:103], v16 offset:41984
    s_add_u32 m0, s45, 8192
    s_add_u32 s33, s43, 788480
    buffer_load_dwordx4 v14, s[16:19], s33 offen lds
    v_mfma_f32_32x32x16_bf16 v[80:95], v[108:111], a[88:91], v[80:95]
    s_add_u32 s37, s42, 11264
    buffer_load_dwordx4 a[80:83], v3, s[12:15], s37 offen offset:0 sc1
    s_waitcnt vmcnt(13) lgkmcnt(4)
    s_nop 0
    v_mfma_f32_32x32x16_bf16 v[64:79], v[112:115], a[92:95], v[64:79]
    ds_read_b64_tr_b16 v[104:105], v15 offset:45056
    ds_read_b64_tr_b16 v[106:107], v15 offset:46080
    ds_read_b64_tr_b16 v[108:109], v16 offset:45056
    ds_read_b64_tr_b16 v[110:111], v16 offset:46080
    v_mfma_f32_32x32x16_bf16 v[80:95], v[116:119], a[92:95], v[80:95]
    buffer_load_dwordx4 a[84:87], v3, s[12:15], s37 offen offset:1024 sc1
    s_waitcnt vmcnt(13) lgkmcnt(4)
    s_nop 0
    v_mfma_f32_32x32x16_bf16 v[64:79], v[96:99], a[96:99], v[64:79]
    ds_read_b64_tr_b16 v[112:113], v15 offset:49152
    ds_read_b64_tr_b16 v[114:115], v15 offset:50176
    ds_read_b64_tr_b16 v[116:117], v16 offset:49152
    ds_read_b64_tr_b16 v[118:119], v16 offset:50176
    v_mfma_f32_32x32x16_bf16 v[80:95], v[100:103], a[96:99], v[80:95]
    s_add_u32 s37, s42, 18432
    buffer_load_dwordx4 a[88:91], v3, s[12:15], s37 offen offset:0 sc1
    s_waitcnt vmcnt(13) lgkmcnt(4)
    v_mfma_f32_32x32x16_bf16 v[64:79], v[104:107], a[100:103], v[64:79]
    v_mov_b32 v217, 13
    ds_write_b32 v207, v217
    ds_read_b64_tr_b16 v[96:97], v15 offset:53248
    ds_read_b64_tr_b16 v[98:99], v15 offset:54272
    ds_read_b64_tr_b16 v[100:101], v16 offset:53248
    ds_read_b64_tr_b16 v[102:103], v16 offset:54272
    v_mfma_f32_32x32x16_bf16 v[80:95], v[108:111], a[100:103], v[80:95]
    buffer_load_dwordx4 a[92:95], v3, s[12:15], s37 offen offset:1024 sc1
    s_waitcnt vmcnt(13) lgkmcnt(5)
    s_nop 0
    v_mfma_f32_32x32x16_bf16 v[64:79], v[112:115], a[104:107], v[64:79]
    ds_read_b64_tr_b16 v[104:105], v17 offset:36864
    ds_read_b64_tr_b16 v[106:107], v17 offset:37888
    ds_read_b64_tr_b16 v[108:109], v63 offset:36864
    ds_read_b64_tr_b16 v[110:111], v63 offset:37888
    v_mfma_f32_32x32x16_bf16 v[80:95], v[116:119], a[104:107], v[80:95]
    s_add_u32 s37, s42, 25600
    buffer_load_dwordx4 a[96:99], v3, s[12:15], s37 offen offset:0 sc1
    s_waitcnt vmcnt(13) lgkmcnt(4)
    v_mfma_f32_32x32x16_bf16 v[64:79], v[96:99], a[108:111], v[64:79]
    ds_read_b128 v[220:223], v216
    s_lshr_b32 s32, s40, 1
    s_lshl_b32 s33, s32, 3
    s_sub_u32 s33, s33, 16
    s_lshl_b32 s32, s32, 4
    s_add_u32 s32, s32, 512
    v_mov_b32 v8, s32
    v_mov_b32 v9, s33
    v_cmp_gt_u32 vcc, 16, v1
    s_nop 1
    v_cndmask_b32 v8, v9, v8, vcc
    v_add_u32 v8, v8, v1
    v_lshlrev_b32 v8, 7, v8
    v_add_u32 v8, 6455296, v8
    v_cmp_gt_u32_e64 vcc, 24, v0
    v_mov_b32 v18, 0x7fff0000
    s_nop 0
    v_cndmask_b32 v18, v18, v8, vcc
    buffer_load_dword v19, v18, s[12:15], 0 offen sc1
    ds_read_b64_tr_b16 v[112:113], v17 offset:40960
    ds_read_b64_tr_b16 v[114:115], v17 offset:41984
    ds_read_b64_tr_b16 v[116:117], v63 offset:40960
    ds_read_b64_tr_b16 v[118:119], v63 offset:41984
    v_mfma_f32_32x32x16_bf16 v[80:95], v[100:103], a[108:111], v[80:95]
    buffer_load_dwordx4 a[100:103], v3, s[12:15], s37 offen offset:1024 sc1
    s_waitcnt vmcnt(14) lgkmcnt(5)
    v_mfma_f32_32x32x16_bf16 v[64:79], v[104:107], a[56:59], v[64:79]
    s_waitcnt lgkmcnt(4)
    v_min3_u32 v220, v220, v221, v222
    v_min_u32 v220, v220, v223
    v_cmp_gt_u32_e64 vcc, 13, v220
    s_nop 0
    s_cbranch_vccz .Lck86
    s_mov_b32 s34, 0
.Lckl87:
    ds_read_b128 v[220:223], v216
    s_add_u32 s34, s34, 1
    s_waitcnt lgkmcnt(0)
    v_min3_u32 v220, v220, v221, v222
    v_min_u32 v220, v220, v223
    v_cmp_gt_u32 vcc, 13, v220
    s_cmp_ge_u32 s34, 3000000
    s_cbranch_scc1 .Lck86
    s_cbranch_vccnz .Lckl87
.Lck86:
    ds_read_b64_tr_b16 v[96:97], v17 offset:45056
    ds_read_b64_tr_b16 v[98:99], v17 offset:46080
    ds_read_b64_tr_b16 v[100:101], v63 offset:45056
    ds_read_b64_tr_b16 v[102:103], v63 offset:46080
    v_mfma_f32_32x32x16_bf16 v[80:95], v[108:111], a[56:59], v[80:95]
    s_add_u32 s37, s42, 32768
    buffer_load_dwordx4 a[104:107], v3, s[12:15], s37 offen offset:0 sc1
    s_waitcnt vmcnt(14) lgkmcnt(4)
    s_nop 0
    v_mfma_f32_32x32x16_bf16 v[64:79], v[112:115], a[60:63], v[64:79]
    ds_read_b64_tr_b16 v[104:105], v17 offset:49152
    ds_read_b64_tr_b16 v[106:107], v17 offset:50176
    ds_read_b64_tr_b16 v[108:109], v63 offset:49152
    ds_read_b64_tr_b16 v[110:111], v63 offset:50176
    v_mfma_f32_32x32x16_bf16 v[80:95], v[116:119], a[60:63], v[80:95]
    buffer_load_dwordx4 a[108:111], v3, s[12:15], s37 offen offset:1024 sc1
    s_waitcnt vmcnt(14) lgkmcnt(4)
    s_nop 0
    v_mfma_f32_32x32x16_bf16 v[64:79], v[96:99], a[64:67], v[64:79]
    ds_read_b64_tr_b16 v[112:113], v17 offset:53248
    ds_read_b64_tr_b16 v[114:115], v17 offset:54272
    ds_read_b64_tr_b16 v[116:117], v63 offset:53248
    ds_read_b64_tr_b16 v[118:119], v63 offset:54272
    buffer_load_dwordx4 v[140:143], v3, s[12:15], s86 offen offset:0 sc1
    buffer_load_dwordx4 v[144:147], v3, s[12:15], s86 offen offset:1024 sc1
    s_add_u32 s86, s86, 4194304
    v_mfma_f32_32x32x16_bf16 v[80:95], v[100:103], a[64:67], v[80:95]
    s_add_u32 s37, s42, 39936
    buffer_load_dwordx4 a[56:59], v3, s[12:15], s37 offen offset:0 sc1
    s_waitcnt vmcnt(16) lgkmcnt(4)
    s_nop 0
    v_mfma_f32_32x32x16_bf16 v[64:79], v[104:107], a[68:71], v[64:79]
    ds_read_b64_tr_b16 v[96:97], v17 offset:57344
    ds_read_b64_tr_b16 v[98:99], v17 offset:58368
    ds_read_b64_tr_b16 v[100:101], v63 offset:57344
    ds_read_b64_tr_b16 v[102:103], v63 offset:58368
    buffer_load_dwordx4 v[148:151], v3, s[12:15], s86 offen offset:0 sc1
    buffer_load_dwordx4 v[152:155], v3, s[12:15], s86 offen offset:1024 sc1
    v_mfma_f32_32x32x16_bf16 v[80:95], v[108:111], a[68:71], v[80:95]
    buffer_load_dwordx4 a[60:63], v3, s[12:15], s37 offen offset:1024 sc1
    s_waitcnt vmcnt(17) lgkmcnt(4)
    s_nop 0
    v_mfma_f32_32x32x16_bf16 v[64:79], v[112:115], a[72:75], v[64:79]
    ds_read_b64_tr_b16 v[104:105], v17 offset:61440
    ds_read_b64_tr_b16 v[106:107], v17 offset:62464
    ds_read_b64_tr_b16 v[108:109], v63 offset:61440
    ds_read_b64_tr_b16 v[110:111], v63 offset:62464
    v_mfma_f32_32x32x16_bf16 v[80:95], v[116:119], a[72:75], v[80:95]
    s_add_u32 s37, s42, 47104
    buffer_load_dwordx4 a[64:67], v3, s[12:15], s37 offen offset:0 sc1
    s_waitcnt vmcnt(17) lgkmcnt(4)
    s_nop 0
    v_mfma_f32_32x32x16_bf16 v[64:79], v[96:99], a[76:79], v[64:79]
    ds_read_b64_tr_b16 v[112:113], v188 offset:0
    ds_read_b64_tr_b16 v[114:115], v188 offset:1024
    ds_read_b64_tr_b16 v[116:117], v189 offset:0
    ds_read_b64_tr_b16 v[118:119], v189 offset:1024
    v_mfma_f32_32x32x16_bf16 v[80:95], v[100:103], a[76:79], v[80:95]
    buffer_load_dwordx4 a[68:71], v3, s[12:15], s37 offen offset:1024 sc1
    s_waitcnt vmcnt(16) lgkmcnt(4)
    s_nop 0
    v_mfma_f32_32x32x16_bf16 v[64:79], v[104:107], a[80:83], v[64:79]
    ds_read_b64_tr_b16 v[96:97], v188 offset:4096
    ds_read_b64_tr_b16 v[98:99], v188 offset:5120
    ds_read_b64_tr_b16 v[100:101], v189 offset:4096
    ds_read_b64_tr_b16 v[102:103], v189 offset:5120
    v_mfma_f32_32x32x16_bf16 v[80:95], v[108:111], a[80:83], v[80:95]
    s_add_u32 s37, s42, 54272
    buffer_load_dwordx4 a[72:75], v3, s[12:15], s37 offen offset:0 sc1
    s_waitcnt vmcnt(16) lgkmcnt(4)
    s_nop 0
    v_mfma_f32_32x32x16_bf16 v[64:79], v[112:115], a[84:87], v[64:79]
    ds_read_b64_tr_b16 v[104:105], v188 offset:8192
    ds_read_b64_tr_b16 v[106:107], v188 offset:9216
    ds_read_b64_tr_b16 v[108:109], v189 offset:8192
    ds_read_b64_tr_b16 v[110:111], v189 offset:9216
    v_mfma_f32_32x32x16_bf16 v[80:95], v[116:119], a[84:87], v[80:95]
    buffer_load_dwordx4 a[76:79], v3, s[12:15], s37 offen offset:1024 sc1
    s_waitcnt vmcnt(16) lgkmcnt(4)
    v_mfma_f32_32x32x16_bf16 v[64:79], v[96:99], a[88:91], v[64:79]
    s_cmp_lg_u32 s3, 0
    s_cbranch_scc1 .Lpoll88
    s_mov_b32 exec_lo, 0xffffff
    s_mov_b32 exec_hi, 0
    s_waitcnt vmcnt(13)
    v_cmp_ne_u32 vcc, s30, v19
    s_nop 1
    s_cbranch_vccz .Lpollx89
    s_waitcnt vmcnt(0) lgkmcnt(0)
    s_mov_b32 s34, 0
.Lspin90:
    buffer_load_dword v19, v18, s[12:15], 0 offen sc1
    s_add_u32 s34, s34, 1
    s_waitcnt vmcnt(0)
    v_cmp_ne_u32_e64 vcc, s30, v19
    s_cmp_ge_u32 s34, 200000
    s_cbranch_scc1 .Lspun91
    s_cbranch_vccnz .Lspin90
.Lspun91:
    s_nop 1
.Lpollx89:
    s_mov_b64 exec, -1
.Lpoll88:
    v_mov_b32_e64 v217, 14
    ds_write_b32 v207, v217
    ds_read_b64_tr_b16 v[112:113], v15 offset:57344
    ds_read_b64_tr_b16 v[114:115], v15 offset:58368
    ds_read_b64_tr_b16 v[116:117], v16 offset:57344
    ds_read_b64_tr_b16 v[118:119], v16 offset:58368
    v_mfma_f32_32x32x16_bf16 v[80:95], v[100:103], a[88:91], v[80:95]
    s_waitcnt vmcnt(15) lgkmcnt(5)
    s_nop 0
    v_mfma_f32_32x32x16_bf16 v[64:79], v[104:107], a[92:95], v[64:79]
    ds_read_b64_tr_b16 v[96:97], v15 offset:61440
    ds_read_b64_tr_b16 v[98:99], v15 offset:62464
    ds_read_b64_tr_b16 v[100:101], v16 offset:61440
    ds_read_b64_tr_b16 v[102:103], v16 offset:62464
    v_mfma_f32_32x32x16_bf16 v[80:95], v[108:111], a[92:95], v[80:95]
    s_waitcnt vmcnt(14) lgkmcnt(4)
    s_nop 0
    v_mfma_f32_32x32x16_bf16 v[64:79], v[112:115], a[96:99], v[64:79]
    ds_read_b128 v[220:223], v216
    ds_read_b64_tr_b16 v[104:105], v188 offset:12288
    ds_read_b64_tr_b16 v[106:107], v188 offset:13312
    ds_read_b64_tr_b16 v[108:109], v189 offset:12288
    ds_read_b64_tr_b16 v[110:111], v189 offset:13312
    v_mfma_f32_32x32x16_bf16 v[80:95], v[116:119], a[96:99], v[80:95]
    s_waitcnt vmcnt(12) lgkmcnt(5)
    v_mfma_f32_32x32x16_bf16 v[64:79], v[96:99], a[100:103], v[64:79]
    s_waitcnt lgkmcnt(4)
    v_min3_u32 v220, v220, v221, v222
    v_min_u32 v220, v220, v223
    v_cmp_gt_u32_e64 vcc, 14, v220
    s_nop 0
    s_cbranch_vccz .Lck92
    s_mov_b32 s34, 0
.Lckl93:
    ds_read_b128 v[220:223], v216
    s_add_u32 s34, s34, 1
    s_waitcnt lgkmcnt(0)
    v_min3_u32 v220, v220, v221, v222
    v_min_u32 v220, v220, v223
    v_cmp_gt_u32 vcc, 14, v220
    s_cmp_ge_u32 s34, 3000000
    s_cbranch_scc1 .Lck92
    s_cbranch_vccnz .Lckl93
.Lck92:
    ds_read_b64_tr_b16 v[112:113], v188 offset:16384
    ds_read_b64_tr_b16 v[114:115], v188 offset:17408
    ds_read_b64_tr_b16 v[116:117], v189 offset:16384
    ds_read_b64_tr_b16 v[118:119], v189 offset:17408
    s_add_u32 s37, s42, 6144
    buffer_load_dwordx4 a[80:83], v3, s[12:15], s37 offen offset:0 sc1
    v_mfma_f32_32x32x16_bf16 v[80:95], v[100:103], a[100:103], v[80:95]
    s_add_u32 s37, s42, 13312
    buffer_load_dwordx4 a[84:87], v3, s[12:15], s37 offen offset:0 sc1
    s_waitcnt vmcnt(13) lgkmcnt(4)
    s_nop 0
    v_mfma_f32_32x32x16_bf16 v[64:79], v[104:107], a[104:107], v[64:79]
    ds_read_b64_tr_b16 v[96:97], v188 offset:20480
    ds_read_b64_tr_b16 v[98:99], v188 offset:21504
    ds_read_b64_tr_b16 v[100:101], v189 offset:20480
    ds_read_b64_tr_b16 v[102:103], v189 offset:21504
    s_add_u32 s37, s42, 20480
    buffer_load_dwordx4 a[88:91], v3, s[12:15], s37 offen offset:0 sc1
    v_mfma_f32_32x32x16_bf16 v[80:95], v[108:111], a[104:107], v[80:95]
    s_add_u32 s37, s42, 27648
    buffer_load_dwordx4 a[92:95], v3, s[12:15], s37 offen offset:0 sc1
    s_waitcnt vmcnt(14) lgkmcnt(4)
    s_nop 0
    v_mfma_f32_32x32x16_bf16 v[64:79], v[112:115], a[108:111], v[64:79]
    ds_read_b64_tr_b16 v[104:105], v188 offset:24576
    ds_read_b64_tr_b16 v[106:107], v188 offset:25600
    ds_read_b64_tr_b16 v[108:109], v189 offset:24576
    ds_read_b64_tr_b16 v[110:111], v189 offset:25600
    s_add_u32 s37, s42, 34816
    buffer_load_dwordx4 a[96:99], v3, s[12:15], s37 offen offset:0 sc1
    v_mfma_f32_32x32x16_bf16 v[80:95], v[116:119], a[108:111], v[80:95]
    s_add_u32 s37, s42, 41984
    buffer_load_dwordx4 a[100:103], v3, s[12:15], s37 offen offset:0 sc1
    s_waitcnt vmcnt(13) lgkmcnt(4)
    s_nop 0
    v_mfma_f32_32x32x16_bf16 v[64:79], v[96:99], a[56:59], v[64:79]
    ds_read_b64_tr_b16 v[112:113], v17 offset:0
    ds_read_b64_tr_b16 v[114:115], v17 offset:1024
    ds_read_b64_tr_b16 v[116:117], v63 offset:0
    ds_read_b64_tr_b16 v[118:119], v63 offset:1024
    v_mfma_f32_32x32x16_bf16 v[80:95], v[100:103], a[56:59], v[80:95]
    s_add_u32 s37, s42, 49152
    buffer_load_dwordx4 a[104:107], v3, s[12:15], s37 offen offset:0 sc1
    s_waitcnt vmcnt(11) lgkmcnt(4)
    s_nop 0
    v_mfma_f32_32x32x16_bf16 v[64:79], v[104:107], a[60:63], v[64:79]
    ds_read_b64_tr_b16 v[96:97], v17 offset:4096
    ds_read_b64_tr_b16 v[98:99], v17 offset:5120
    ds_read_b64_tr_b16 v[100:101], v63 offset:4096
    ds_read_b64_tr_b16 v[102:103], v63 offset:5120
    v_mfma_f32_32x32x16_bf16 v[80:95], v[108:111], a[60:63], v[80:95]
    s_add_u32 s37, s42, 56320
    buffer_load_dwordx4 a[108:111], v3, s[12:15], s37 offen offset:0 sc1
    s_waitcnt vmcnt(11) lgkmcnt(4)
    v_mfma_f32_32x32x16_bf16 v[64:79], v[112:115], a[64:67], v[64:79]
    v_mov_b32 v217, 15
    ds_write_b32 v207, v217
    ds_read_b64_tr_b16 v[104:105], v17 offset:8192
    ds_read_b64_tr_b16 v[106:107], v17 offset:9216
    ds_read_b64_tr_b16 v[108:109], v63 offset:8192
    ds_read_b64_tr_b16 v[110:111], v63 offset:9216
    v_mfma_f32_32x32x16_bf16 v[80:95], v[116:119], a[64:67], v[80:95]
    buffer_load_dwordx4 a[56:59], v3, s[12:15], s49 offen offset:0 sc1
    s_waitcnt vmcnt(11) lgkmcnt(5)
    s_nop 0
    v_mfma_f32_32x32x16_bf16 v[64:79], v[96:99], a[68:71], v[64:79]
    ds_read_b64_tr_b16 v[112:113], v17 offset:12288
    ds_read_b64_tr_b16 v[114:115], v17 offset:13312
    ds_read_b64_tr_b16 v[116:117], v63 offset:12288
    ds_read_b64_tr_b16 v[118:119], v63 offset:13312
    v_mfma_f32_32x32x16_bf16 v[80:95], v[100:103], a[68:71], v[80:95]
    buffer_load_dwordx4 a[60:63], v3, s[12:15], s49 offen offset:1024 sc1
    s_waitcnt vmcnt(11) lgkmcnt(4)
    s_nop 0
    v_mfma_f32_32x32x16_bf16 v[64:79], v[104:107], a[72:75], v[64:79]
    ds_read_b128 v[220:223], v216
    ds_read_b64_tr_b16 v[96:97], v15 offset:0
    ds_read_b64_tr_b16 v[98:99], v15 offset:1024
    ds_read_b64_tr_b16 v[100:101], v16 offset:0
    ds_read_b64_tr_b16 v[102:103], v16 offset:1024
    v_mfma_f32_32x32x16_bf16 v[80:95], v[108:111], a[72:75], v[80:95]
    buffer_load_dwordx4 a[64:67], v3, s[12:15], s49 offen offset:2048 sc1
    s_waitcnt vmcnt(11) lgkmcnt(5)
    v_mfma_f32_32x32x16_bf16 v[64:79], v[112:115], a[76:79], v[64:79]
    s_waitcnt lgkmcnt(4)
    v_min3_u32 v220, v220, v221, v222
    v_min_u32 v220, v220, v223
    v_cmp_gt_u32_e64 vcc, 15, v220
    s_nop 0
    s_cbranch_vccz .Lck94
    s_mov_b32 s34, 0
.Lckl95:
    ds_read_b128 v[220:223], v216
    s_add_u32 s34, s34, 1
    s_waitcnt lgkmcnt(0)
    v_min3_u32 v220, v220, v221, v222
    v_min_u32 v220, v220, v223
    v_cmp_gt_u32 vcc, 15, v220
    s_cmp_ge_u32 s34, 3000000
    s_cbranch_scc1 .Lck94
    s_cbranch_vccnz .Lckl95
.Lck94:
    ds_read_b64_tr_b16 v[104:105], v17 offset:16384
    ds_read_b64_tr_b16 v[106:107], v17 offset:17408
    ds_read_b64_tr_b16 v[108:109], v63 offset:16384
    ds_read_b64_tr_b16 v[110:111], v63 offset:17408
    v_mfma_f32_32x32x16_bf16 v[80:95], v[116:119], a[76:79], v[80:95]
    buffer_load_dwordx4 a[68:71], v3, s[12:15], s49 offen offset:3072 sc1
    s_waitcnt vmcnt(11) lgkmcnt(4)
    s_nop 0
    v_mfma_f32_32x32x16_bf16 v[64:79], v[96:99], a[80:83], v[64:79]
    ds_read_b64_tr_b16 v[112:113], v17 offset:20480
    ds_read_b64_tr_b16 v[114:115], v17 offset:21504
    ds_read_b64_tr_b16 v[116:117], v63 offset:20480
    ds_read_b64_tr_b16 v[118:119], v63 offset:21504
    v_mfma_f32_32x32x16_bf16 v[80:95], v[100:103], a[80:83], v[80:95]
    s_add_u32 s49, s49, 4096
    buffer_load_dwordx4 a[72:75], v3, s[12:15], s49 offen offset:0 sc1
    v_lshlrev_b32_e64 v156, 16, v140
    v_and_b32 v157, 0xffff0000, v140
    v_lshlrev_b32_e64 v158, 16, v141
    v_and_b32 v159, 0xffff0000, v141
    s_waitcnt vmcnt(11) lgkmcnt(4)
    s_nop 0
    v_mfma_f32_32x32x16_bf16 v[64:79], v[104:107], a[84:87], v[64:79]
    ds_read_b64_tr_b16 v[96:97], v17 offset:24576
    ds_read_b64_tr_b16 v[98:99], v17 offset:25600
    ds_read_b64_tr_b16 v[100:101], v63 offset:24576
    ds_read_b64_tr_b16 v[102:103], v63 offset:25600
    v_mfma_f32_32x32x16_bf16 v[80:95], v[108:111], a[84:87], v[80:95]
    buffer_load_dwordx4 a[76:79], v3, s[12:15], s49 offen offset:1024 sc1
    v_lshlrev_b32_e64 v160, 16, v142
    v_and_b32 v161, 0xffff0000, v142
    v_lshlrev_b32_e64 v162, 16, v143
    v_and_b32 v163, 0xffff0000, v143
    s_waitcnt vmcnt(11) lgkmcnt(4)
    s_nop 0
    v_mfma_f32_32x32x16_bf16 v[64:79], v[112:115], a[88:91], v[64:79]
    ds_read_b64_tr_b16 v[104:105], v17 offset:28672
    ds_read_b64_tr_b16 v[106:107], v17 offset:29696
    ds_read_b64_tr_b16 v[108:109], v63 offset:28672
    ds_read_b64_tr_b16 v[110:111], v63 offset:29696
    v_mfma_f32_32x32x16_bf16 v[80:95], v[116:119], a[88:91], v[80:95]
    buffer_load_dwordx4 a[80:83], v3, s[12:15], s49 offen offset:2048 sc1
    v_lshlrev_b32_e64 v164, 16, v144
    v_and_b32 v165, 0xffff0000, v144
    v_lshlrev_b32_e64 v166, 16, v145
    v_and_b32 v167, 0xffff0000, v145
    s_waitcnt vmcnt(11) lgkmcnt(4)
    s_nop 0
    v_mfma_f32_32x32x16_bf16 v[64:79], v[96:99], a[92:95], v[64:79]
    ds_read_b64_tr_b16 v[112:113], v17 offset:32768
    ds_read_b64_tr_b16 v[114:115], v17 offset:33792
    ds_read_b64_tr_b16 v[116:117], v63 offset:32768
    ds_read_b64_tr_b16 v[118:119], v63 offset:33792
    v_mfma_f32_32x32x16_bf16 v[80:95], v[100:103], a[92:95], v[80:95]
    buffer_load_dwordx4 a[84:87], v3, s[12:15], s49 offen offset:3072 sc1
    v_lshlrev_b32_e64 v168, 16, v146
    v_and_b32 v169, 0xffff0000, v146
    v_lshlrev_b32_e64 v170, 16, v147
    v_and_b32 v171, 0xffff0000, v147
    s_waitcnt vmcnt(11) lgkmcnt(4)
    s_nop 0
    v_mfma_f32_32x32x16_bf16 v[64:79], v[104:107], a[96:99], v[64:79]
    ds_read_b64_tr_b16 v[96:97], v15 offset:4096
    ds_read_b64_tr_b16 v[98:99], v15 offset:5120
    ds_read_b64_tr_b16 v[100:101], v16 offset:4096
    ds_read_b64_tr_b16 v[102:103], v16 offset:5120
    v_mfma_f32_32x32x16_bf16 v[80:95], v[108:111], a[96:99], v[80:95]
    s_add_u32 s49, s49, 4096
    buffer_load_dwordx4 a[88:91], v3, s[12:15], s49 offen offset:0 sc1
    v_lshlrev_b32_e64 v172, 16, v148
    v_and_b32 v173, 0xffff0000, v148
    v_lshlrev_b32_e64 v174, 16, v149
    v_and_b32 v175, 0xffff0000, v149
    s_waitcnt vmcnt(11) lgkmcnt(4)
    s_nop 0
    v_mfma_f32_32x32x16_bf16 v[64:79], v[112:115], a[100:103], v[64:79]
    ds_read_b64_tr_b16 v[104:105], v15 offset:8192
    ds_read_b64_tr_b16 v[106:107], v15 offset:9216
    ds_read_b64_tr_b16 v[108:109], v16 offset:8192
    ds_read_b64_tr_b16 v[110:111], v16 offset:9216
    v_mfma_f32_32x32x16_bf16 v[80:95], v[116:119], a[100:103], v[80:95]
    buffer_load_dwordx4 a[92:95], v3, s[12:15], s49 offen offset:1024 sc1
    v_lshlrev_b32_e64 v176, 16, v150
    v_and_b32 v177, 0xffff0000, v150
    v_lshlrev_b32_e64 v178, 16, v151
    v_and_b32 v179, 0xffff0000, v151
    s_waitcnt vmcnt(11) lgkmcnt(4)
    v_mfma_f32_32x32x16_bf16 v[64:79], v[96:99], a[104:107], v[64:79]
    v_mfma_f32_32x32x16_bf16 v[80:95], v[100:103], a[104:107], v[80:95]
    buffer_load_dwordx4 a[96:99], v3, s[12:15], s49 offen offset:2048 sc1
    v_lshlrev_b32 v180, 16, v152
    v_and_b32 v181, 0xffff0000, v152
    v_lshlrev_b32_e64 v182, 16, v153
    v_and_b32 v183, 0xffff0000, v153
    s_waitcnt vmcnt(11) lgkmcnt(0)
    v_mfma_f32_32x32x16_bf16 v[64:79], v[104:107], a[108:111], v[64:79]
    v_mfma_f32_32x32x16_bf16 v[80:95], v[108:111], a[108:111], v[80:95]
    buffer_load_dwordx4 a[100:103], v3, s[12:15], s49 offen offset:3072 sc1
    v_lshlrev_b32 v184, 16, v154
    v_and_b32 v185, 0xffff0000, v154
    v_lshlrev_b32_e64 v186, 16, v155
    v_and_b32 v187, 0xffff0000, v155
    s_waitcnt vmcnt(11)
    v_mfma_f32_32x32x16_bf16 v[20:35], a[128:131], a[56:59], 0
    v_mfma_f32_32x32x16_bf16 v[36:51], a[132:135], a[56:59], 0
    s_add_u32 s49, s49, 4096
    buffer_load_dwordx4 a[104:107], v3, s[12:15], s49 offen offset:0 sc1
    s_waitcnt vmcnt(11)
    v_mfma_f32_32x32x16_bf16 v[20:35], a[136:139], a[60:63], v[20:35]
    v_mfma_f32_32x32x16_bf16 v[36:51], a[140:143], a[60:63], v[36:51]
    buffer_load_dwordx4 a[108:111], v3, s[12:15], s49 offen offset:1024 sc1
    ds_write_b128 v219, v[80:83] offset:16384
    s_waitcnt vmcnt(11)
    v_mfma_f32_32x32x16_bf16 v[20:35], a[144:147], a[64:67], v[20:35]
    v_mfma_f32_32x32x16_bf16 v[36:51], a[148:151], a[64:67], v[36:51]
    buffer_load_dwordx4 a[56:59], v3, s[12:15], s49 offen offset:2048 sc1
    ds_write_b128 v219, v[84:87] offset:17408
    s_waitcnt vmcnt(11)
    v_mfma_f32_32x32x16_bf16 v[20:35], a[152:155], a[68:71], v[20:35]
    v_mfma_f32_32x32x16_bf16 v[36:51], a[156:159], a[68:71], v[36:51]
    buffer_load_dwordx4 a[60:63], v3, s[12:15], s49 offen offset:3072 sc1
    ds_write_b128 v219, v[88:91] offset:18432
    s_waitcnt vmcnt(11)
    v_mfma_f32_32x32x16_bf16 v[20:35], a[160:163], a[72:75], v[20:35]
    v_mfma_f32_32x32x16_bf16 v[36:51], a[164:167], a[72:75], v[36:51]
    ds_write_b128 v219, v[92:95] offset:19456
    v_add_f32 v172, v172, v64
    v_add_f32 v173, v173, v65
    v_add_f32 v174, v174, v66
    v_add_f32 v175, v175, v67
    s_waitcnt vmcnt(10)
    v_mfma_f32_32x32x16_bf16 v[20:35], a[168:171], a[76:79], v[20:35]
    v_mov_b32_e64 v217, 16
    ds_write_b32 v207, v217
    v_mfma_f32_32x32x16_bf16 v[36:51], a[172:175], a[76:79], v[36:51]
    v_add_f32 v176, v176, v68
    v_add_f32 v177, v177, v69
    v_add_f32 v178, v178, v70
    v_add_f32_e64 v179, v179, v71
    s_waitcnt vmcnt(9)
    v_mfma_f32_32x32x16_bf16 v[20:35], a[176:179], a[80:83], v[20:35]
    v_mfma_f32_32x32x16_bf16 v[36:51], a[180:183], a[80:83], v[36:51]
    v_add_f32 v180, v180, v72
    v_add_f32 v181, v181, v73
    v_add_f32 v182, v182, v74
    v_add_f32_e64 v183, v183, v75
    s_waitcnt vmcnt(8)
    v_mfma_f32_32x32x16_bf16 v[20:35], a[184:187], a[84:87], v[20:35]
    ds_read_b128 v[220:223], v216
    v_mfma_f32_32x32x16_bf16 v[36:51], a[188:191], a[84:87], v[36:51]
    v_add_f32 v184, v184, v76
    v_add_f32 v185, v185, v77
    v_add_f32 v186, v186, v78
    v_add_f32_e64 v187, v187, v79
    s_waitcnt vmcnt(7)
    v_mfma_f32_32x32x16_bf16 v[20:35], a[192:195], a[88:91], v[20:35]
    s_waitcnt lgkmcnt(0)
    v_min3_u32 v220, v220, v221, v222
    v_min_u32 v220, v220, v223
    v_cmp_gt_u32 vcc, 16, v220
    s_nop 0
    s_cbranch_vccz .Lck96
    s_mov_b32 s34, 0
.Lckl97:
    ds_read_b128 v[220:223], v216
    s_add_u32 s34, s34, 1
    s_waitcnt lgkmcnt(0)
    v_min3_u32 v220, v220, v221, v222
    v_min_u32 v220, v220, v223
    v_cmp_gt_u32 vcc, 16, v220
    s_cmp_ge_u32 s34, 3000000
    s_cbranch_scc1 .Lck96
    s_cbranch_vccnz .Lckl97
.Lck96:
    ds_read_b128 v[80:83], v224 offset:16384
    ds_read_b128 v[84:87], v224 offset:17408
    ds_read_b128 v[88:91], v224 offset:18432
    ds_read_b128 v[92:95], v224 offset:19456
    v_mfma_f32_32x32x16_bf16 v[36:51], a[196:199], a[88:91], v[36:51]
    s_waitcnt vmcnt(6)
    v_mfma_f32_32x32x16_bf16 v[20:35], a[200:203], a[92:95], v[20:35]
    s_waitcnt lgkmcnt(3)
    v_add_f32_e64 v172, v172, v80
    v_mul_f32 v140, 0xbfb8aa3b, v172
    v_add_f32_e64 v173, v173, v81
    v_mul_f32 v141, 0xbfb8aa3b, v173
    v_add_f32_e64 v174, v174, v82
    v_mfma_f32_32x32x16_bf16 v[36:51], a[204:207], a[92:95], v[36:51]
    v_mul_f32 v142, 0xbfb8aa3b, v174
    v_add_f32_e64 v175, v175, v83
    v_mul_f32 v143, 0xbfb8aa3b, v175
    s_waitcnt lgkmcnt(2)
    v_add_f32 v176, v176, v84
    v_mul_f32 v144, 0xbfb8aa3b, v176
    s_waitcnt vmcnt(5)
    v_mfma_f32_32x32x16_bf16 v[20:35], a[208:211], a[96:99], v[20:35]
    v_add_f32 v177, v177, v85
    v_mul_f32 v145, 0xbfb8aa3b, v177
    v_add_f32_e64 v178, v178, v86
    v_mul_f32 v146, 0xbfb8aa3b, v178
    v_add_f32_e64 v179, v179, v87
    v_mfma_f32_32x32x16_bf16 v[36:51], a[212:215], a[96:99], v[36:51]
    v_mul_f32 v147, 0xbfb8aa3b, v179
    s_waitcnt lgkmcnt(1)
    v_add_f32 v180, v180, v88
    v_mul_f32 v148, 0xbfb8aa3b, v180
    v_add_f32_e64 v181, v181, v89
    v_mul_f32 v149, 0xbfb8aa3b, v181
    s_waitcnt vmcnt(4)
    v_mfma_f32_32x32x16_bf16 v[20:35], a[216:219], a[100:103], v[20:35]
    v_add_f32 v182, v182, v90
    v_mul_f32 v150, 0xbfb8aa3b, v182
    v_add_f32_e64 v183, v183, v91
    v_mul_f32 v151, 0xbfb8aa3b, v183
    s_waitcnt lgkmcnt(0)
    v_add_f32 v184, v184, v92
    v_mfma_f32_32x32x16_bf16 v[36:51], a[220:223], a[100:103], v[36:51]
    v_mul_f32 v152, 0xbfb8aa3b, v184
    v_add_f32_e64 v185, v185, v93
    v_mul_f32 v153, 0xbfb8aa3b, v185
    v_add_f32_e64 v186, v186, v94
    v_mul_f32 v154, 0xbfb8aa3b, v186
    s_waitcnt vmcnt(3)
    v_mfma_f32_32x32x16_bf16 v[20:35], a[224:227], a[104:107], v[20:35]
    v_add_f32 v187, v187, v95
    v_mul_f32 v155, 0xbfb8aa3b, v187
    v_exp_f32 v140, v140
    v_exp_f32 v141, v141
    v_exp_f32_e64 v142, v142
    v_mfma_f32_32x32x16_bf16 v[36:51], a[228:231], a[104:107], v[36:51]
    v_exp_f32 v143, v143
    v_exp_f32 v144, v144
    v_exp_f32 v145, v145
    v_exp_f32 v146, v146
    v_exp_f32 v147, v147
    s_waitcnt vmcnt(2)
    v_mfma_f32_32x32x16_bf16 v[20:35], a[232:235], a[108:111], v[20:35]
    v_exp_f32 v148, v148
    v_exp_f32 v149, v149
    v_exp_f32 v150, v150
    v_exp_f32 v151, v151
    v_exp_f32_e64 v152, v152
    v_mfma_f32_32x32x16_bf16 v[36:51], a[236:239], a[108:111], v[36:51]
    v_exp_f32 v153, v153
    v_exp_f32 v154, v154
    v_exp_f32 v155, v155
    v_add_f32 v140, 1.0, v140
    v_add_f32 v141, 1.0, v141
    s_waitcnt vmcnt(1)
    v_mfma_f32_32x32x16_bf16 v[20:35], a[240:243], a[56:59], v[20:35]
    v_add_f32 v142, 1.0, v142
    v_add_f32 v143, 1.0, v143
    v_add_f32 v144, 1.0, v144
    v_add_f32 v145, 1.0, v145
    v_add_f32_e64 v146, 1.0, v146
    v_mfma_f32_32x32x16_bf16 v[36:51], a[244:247], a[56:59], v[36:51]
    v_add_f32 v147, 1.0, v147
    v_add_f32 v148, 1.0, v148
    v_add_f32 v149, 1.0, v149
    v_add_f32 v150, 1.0, v150
    v_add_f32 v151, 1.0, v151
    s_waitcnt vmcnt(0)
    v_mfma_f32_32x32x16_bf16 v[20:35], a[248:251], a[60:63], v[20:35]
    v_add_f32 v152, 1.0, v152
    v_add_f32 v153, 1.0, v153
    v_add_f32 v154, 1.0, v154
    v_add_f32 v155, 1.0, v155
    v_mfma_f32_32x32x16_bf16 v[36:51], a[252:255], a[60:63], v[36:51]
    v_rcp_f32 v140, v140
    v_rcp_f32 v141, v141
    v_rcp_f32 v142, v142
    v_rcp_f32 v143, v143
    v_rcp_f32 v144, v144
    v_rcp_f32 v145, v145
    v_rcp_f32 v146, v146
    v_rcp_f32_e64 v147, v147
    s_nop 3
    ds_write_b128 v219, v[36:39] offset:0
    ds_write_b128 v219, v[40:43] offset:1024
    ds_write_b128 v219, v[44:47] offset:2048
    ds_write_b128 v219, v[48:51] offset:3072
    v_rcp_f32 v148, v148
    v_rcp_f32 v149, v149
    v_rcp_f32 v150, v150
    v_rcp_f32 v151, v151
    v_rcp_f32 v152, v152
    v_rcp_f32 v153, v153
    v_rcp_f32 v154, v154
    v_rcp_f32 v155, v155
    s_waitcnt lgkmcnt(0)
    s_barrier
    ds_read_b128 v[36:39], v224 offset:0
    ds_read_b128 v[40:43], v224 offset:1024
    ds_read_b128 v[44:47], v224 offset:2048
    ds_read_b128 v[48:51], v224 offset:3072
    v_pk_mul_f32 v[172:173], v[172:173], v[140:141]
    v_pk_mul_f32 v[174:175], v[174:175], v[142:143]
    v_pk_mul_f32 v[176:177], v[176:177], v[144:145]
    v_pk_mul_f32 v[178:179], v[178:179], v[146:147]
    v_pk_mul_f32 v[180:181], v[180:181], v[148:149]
    v_pk_mul_f32 v[182:183], v[182:183], v[150:151]
    v_pk_mul_f32 v[184:185], v[184:185], v[152:153]
    v_pk_mul_f32 v[186:187], v[186:187], v[154:155]
    v_pk_fma_f32 v[156:157], v[172:173], v[20:21], v[156:157]
    v_pk_fma_f32 v[158:159], v[174:175], v[22:23], v[158:159]
    v_pk_fma_f32 v[160:161], v[176:177], v[24:25], v[160:161]
    v_pk_fma_f32 v[162:163], v[178:179], v[26:27], v[162:163]
    v_pk_fma_f32 v[164:165], v[180:181], v[28:29], v[164:165]
    v_pk_fma_f32 v[166:167], v[182:183], v[30:31], v[166:167]
    v_pk_fma_f32 v[168:169], v[184:185], v[32:33], v[168:169]
    v_pk_fma_f32 v[170:171], v[186:187], v[34:35], v[170:171]
    s_waitcnt lgkmcnt(3)
    v_pk_fma_f32 v[156:157], v[172:173], v[36:37], v[156:157]
    v_pk_fma_f32 v[158:159], v[174:175], v[38:39], v[158:159]
    s_waitcnt lgkmcnt(2)
    v_pk_fma_f32 v[160:161], v[176:177], v[40:41], v[160:161]
    v_pk_fma_f32 v[162:163], v[178:179], v[42:43], v[162:163]
    v_cvt_pk_bf16_f32 v96, v156, v157
    v_cvt_pk_bf16_f32 v97, v158, v159
    v_cvt_pk_bf16_f32 v98, v160, v161
    v_cvt_pk_bf16_f32 v99, v162, v163
    s_nop 0
    v_permlane32_swap_b32 v96, v98
    v_permlane32_swap_b32 v97, v99
    buffer_store_dwordx4 v[96:99], v218, s[8:11], s48 offen offset:0
    s_waitcnt lgkmcnt(1)
    v_pk_fma_f32 v[164:165], v[180:181], v[44:45], v[164:165]
    v_pk_fma_f32 v[166:167], v[182:183], v[46:47], v[166:167]
    s_waitcnt lgkmcnt(0)
    s_nop 0
    v_pk_fma_f32 v[168:169], v[184:185], v[48:49], v[168:169]
    v_pk_fma_f32 v[170:171], v[186:187], v[50:51], v[170:171]
    v_cvt_pk_bf16_f32 v100, v164, v165
    v_cvt_pk_bf16_f32 v101, v166, v167
    v_cvt_pk_bf16_f32 v102, v168, v169
    v_cvt_pk_bf16_f32 v103, v170, v171
    s_nop 0
    v_permlane32_swap_b32 v100, v102
    v_permlane32_swap_b32 v101, v103
    buffer_store_dwordx4 v[100:103], v218, s[8:11], s48 offen offset:32
    s_branch .Ls4end72
.Lidle73:
    s_waitcnt vmcnt(8)
    s_barrier
    s_cmp_lg_u32 s3, 0
    s_cbranch_scc1 .Lpub98
    s_lshl_b32 s31, s39, 7
    s_add_u32 s31, s31, 6520832
    v_mov_b32 v10, s30
    v_mov_b32 v11, s31
    s_mov_b64 exec, 1
    buffer_store_dword v10, v11, s[12:15], 0 offen sc1
    s_mov_b64 exec, -1
.Lpub98:
    s_cmp_ge_u32 s50, 16
    s_cbranch_scc1 .Ls4end72
    s_nop 0
    v_mfma_f32_32x32x16_bf16 v[64:79], a[112:115], v[20:23], 0
    v_mfma_f32_32x32x16_bf16 v[64:79], a[116:119], v[24:27], v[64:79]
    v_mfma_f32_32x32x16_bf16 v[64:79], a[120:123], v[28:31], v[64:79]
    v_mfma_f32_32x32x16_bf16 v[64:79], a[124:127], v[32:35], v[64:79]
    v_mfma_f32_32x32x16_bf16 v[80:95], a[112:115], v[36:39], 0
    v_mfma_f32_32x32x16_bf16 v[80:95], a[116:119], v[40:43], v[80:95]
    v_mfma_f32_32x32x16_bf16 v[80:95], a[120:123], v[44:47], v[80:95]
    v_mfma_f32_32x32x16_bf16 v[80:95], a[124:127], v[48:51], v[80:95]
    s_nop 7
    v_mov_b32 v226, v76
    v_mov_b32_e64 v227, v76
    s_nop 1
    v_permlane32_swap_b32 v227, v226
    v_add_f32 v226, 0x358637bd, v226
    v_rcp_f32 v226, v226
    s_nop 0
    v_pk_mul_f32 v[64:65], v[64:65], v[226:227] op_sel_hi:[1,0]
    v_pk_mul_f32 v[66:67], v[66:67], v[226:227] op_sel_hi:[1,0]
    v_pk_mul_f32 v[68:69], v[68:69], v[226:227] op_sel_hi:[1,0]
    v_pk_mul_f32 v[70:71], v[70:71], v[226:227] op_sel_hi:[1,0]
    v_pk_mul_f32 v[72:73], v[72:73], v[226:227] op_sel_hi:[1,0]
    v_pk_mul_f32 v[74:75], v[74:75], v[226:227] op_sel_hi:[1,0]
    v_pk_mul_f32 v[76:77], v[76:77], v[226:227] op_sel_hi:[1,0]
    v_pk_mul_f32 v[78:79], v[78:79], v[226:227] op_sel_hi:[1,0]
    v_cvt_pk_bf16_f32 v20, v64, v65
    v_cvt_pk_bf16_f32 v21, v66, v67
    v_cvt_pk_bf16_f32 v22, v68, v69
    v_cvt_pk_bf16_f32 v23, v70, v71
    v_cvt_pk_bf16_f32 v24, v72, v73
    v_cvt_pk_bf16_f32 v25, v74, v75
    v_cvt_pk_bf16_f32 v26, v76, v77
    v_cvt_pk_bf16_f32 v27, v78, v79
    v_cndmask_b32 v26, 0, v26, s[56:57]
    v_cndmask_b32 v27, 0, v27, s[56:57]
    buffer_store_dwordx4 v[20:23], v3, s[12:15], s89 offen offset:0 sc1
    buffer_store_dwordx4 v[24:27], v3, s[12:15], s89 offen offset:1024 sc1
    v_mov_b32 v226, v92
    v_mov_b32 v227, v92
    s_nop 1
    v_permlane32_swap_b32 v227, v226
    v_add_f32 v226, 0x358637bd, v226
    v_rcp_f32 v226, v226
    s_nop 0
    v_pk_mul_f32 v[80:81], v[80:81], v[226:227] op_sel_hi:[1,0]
    v_pk_mul_f32 v[82:83], v[82:83], v[226:227] op_sel_hi:[1,0]
    v_pk_mul_f32 v[84:85], v[84:85], v[226:227] op_sel_hi:[1,0]
    v_pk_mul_f32 v[86:87], v[86:87], v[226:227] op_sel_hi:[1,0]
    v_pk_mul_f32 v[88:89], v[88:89], v[226:227] op_sel_hi:[1,0]
    v_pk_mul_f32 v[90:91], v[90:91], v[226:227] op_sel_hi:[1,0]
    v_pk_mul_f32 v[92:93], v[92:93], v[226:227] op_sel_hi:[1,0]
    v_pk_mul_f32 v[94:95], v[94:95], v[226:227] op_sel_hi:[1,0]
    v_cvt_pk_bf16_f32 v28, v80, v81
    v_cvt_pk_bf16_f32 v29, v82, v83
    v_cvt_pk_bf16_f32 v30, v84, v85
    v_cvt_pk_bf16_f32 v31, v86, v87
    v_cvt_pk_bf16_f32 v32, v88, v89
    v_cvt_pk_bf16_f32 v33, v90, v91
    v_cvt_pk_bf16_f32 v34, v92, v93
    v_cvt_pk_bf16_f32 v35, v94, v95
    v_cndmask_b32 v34, 0, v34, s[56:57]
    v_cndmask_b32 v35, 0, v35, s[56:57]
    s_add_u32 s89, s89, 32768
    buffer_store_dwordx4 v[28:31], v3, s[12:15], s89 offen offset:0 sc1
    buffer_store_dwordx4 v[32:35], v3, s[12:15], s89 offen offset:1024 sc1
    s_waitcnt vmcnt(0)
    s_barrier
    s_cmp_lg_u32 s3, 0
    s_cbranch_scc1 .Lpub99
    s_lshl_b32 s31, s53, 7
    s_add_u32 s31, s31, 6455296
    v_mov_b32 v10, s30
    v_mov_b32 v11, s31
    s_mov_b64 exec, 1
    buffer_store_dword v10, v11, s[12:15], 0 offen sc1
    s_mov_b64 exec, -1
.Lpub99:
.Ls4end72:
    s_nop 1
recurrent_scan__linear_kernel_hedgehog__mixer_s_mlp__prompt_kernel_done:
    s_endpgm
recurrent_scan__linear_kernel_hedgehog__mixer_s_mlp__prompt_kernel_end:

.section .rodata,"a"
.p2align 6
.amdhsa_kernel recurrent_scan__linear_kernel_hedgehog__mixer_s_mlp__prompt_kernel
  .amdhsa_next_free_vgpr 508
  .amdhsa_next_free_sgpr 94
  .amdhsa_accum_offset 252
  .amdhsa_group_segment_fixed_size 0
  .amdhsa_kernarg_size 96
  .amdhsa_user_sgpr_count 2
  .amdhsa_user_sgpr_kernarg_segment_ptr 1
  .amdhsa_system_sgpr_workgroup_id_x 1
.end_amdhsa_kernel
```
